```python
import torch

def _softmax(x, axis=-1):
    return torch.softmax(x, dim=axis)
def _gelu(x):
    return torch.nn.functional.gelu(x, approximate="tanh")
def _silu(x):
    return torch.nn.functional.silu(x)
def _sigmoid(x):
    return torch.sigmoid(x)
def _layernorm(x, axis=-1, eps=1e-5):
    m = x.mean(dim=axis, keepdim=True)
    v = x.var(dim=axis, keepdim=True, unbiased=False)
    return (x - m) / torch.sqrt(v + eps)
def _scatter_add(tgt, idx, src, axis=0):
    return tgt.clone().index_add_(axis, idx, src)
def _segment_sum(src, seg, n):
    out = torch.zeros((n,) + src.shape[1:], dtype=src.dtype)
    return out.index_add_(0, seg, src)
def _pad(x, pw):
    flat = tuple(v for pair in reversed(pw) for v in pair)
    return torch.nn.functional.pad(x, flat)

kernel_name = 'gated_mix__linear_kernel_hedgehog__geglu_ffn__prompt'

def setup_inputs():

    _w = (lambda a: (lambda t: t.to(torch.bfloat16) if t.is_floating_point() else t)(torch.as_tensor(a)))
    def _A_setup():
        B, S, D, H = 1, 2048, 640, 32
        Dh = D // H
        return {
            "x": _w((lambda *s: torch.randn(*s, dtype=torch.bfloat16) * 0.05)(B, S, D)),
            "wqkv": _w((lambda *s: torch.randn(*s, dtype=torch.bfloat16) * 0.8)(D, 3 * D)),
            "w_phi": _w((lambda *s: torch.randn(*s, dtype=torch.bfloat16) * 0.8)(H, Dh, Dh) * (Dh ** -0.5)),
            "wo": _w((lambda *s: torch.randn(*s, dtype=torch.bfloat16) * 0.05)(D, D)),
        }
    _A_in = _A_setup()

    def _B_setup():
        B, S, D, F = 1, 2048, 640, 1728
        return {
            "x": _w((lambda *s: torch.randn(*s, dtype=torch.bfloat16) * 0.05)(B, S, D)),
            "w_gate": _w((lambda *s: torch.randn(*s, dtype=torch.bfloat16) * 0.05)(D, F)),
            "w_up": _w((lambda *s: torch.randn(*s, dtype=torch.bfloat16) * 0.05)(D, F)),
            "w_down": _w((lambda *s: torch.randn(*s, dtype=torch.bfloat16) * 0.05)(F, D)),
        }
    _B_in = _B_setup()

    return {
        "A_x": _A_in["x"],
        "A_wqkv": _A_in["wqkv"],
        "A_w_phi": _A_in["w_phi"],
        "A_wo": _A_in["wo"],
        "B_x": _B_in["x"],
        "B_w_gate": _B_in["w_gate"],
        "B_w_up": _B_in["w_up"],
        "B_w_down": _B_in["w_down"],
        "gate_w": _w((lambda *s: torch.randn(*s, dtype=torch.bfloat16) * 0.05)(640) * 16.0),
    }

def reference(A_x, A_wqkv, A_w_phi, A_wo, B_x, B_w_gate, B_w_up, B_w_down, gate_w):
    def _A_ref(x, wqkv, w_phi, wo):
        B, S, D = x.shape
        H = 32; Dh = D // H
        qkv = (lambda x, *d: x.permute(*d))((x @ wqkv).reshape(B, S, 3, H, Dh), 2, 0, 3, 1, 4)
        q, k, v = qkv[0], qkv[1], qkv[2]
        pq = torch.einsum("bhsd,hdf->bhsf", q, w_phi)
        pk = torch.einsum("bhsd,hdf->bhsf", k, w_phi)
        phi_q = torch.concatenate([_softmax(pq, axis=-1), _softmax(-pq, axis=-1)], axis=-1)
        phi_k = torch.concatenate([_softmax(pk, axis=-1), _softmax(-pk, axis=-1)], axis=-1)
        kv = torch.einsum("bhsf,bhsd->bhfd", phi_k, v)
        z  = torch.einsum("bhsf->bhf", phi_k)
        num = torch.einsum("bhqf,bhfd->bhqd", phi_q, kv)
        den = torch.einsum("bhqf,bhf->bhq", phi_q, z)[..., None] + 1e-6
        o = num / den
        return (lambda x, *d: x.permute(*d))(o, 0, 2, 1, 3).reshape(B, S, D) @ wo

    def _B_ref(x, w_gate, w_up, w_down):
        return (_gelu(x @ w_gate) * (x @ w_up)) @ w_down

    x = A_x
    g = _sigmoid((x * gate_w).sum(-1, keepdims=True))
    a = _A_ref(x, A_wqkv, A_w_phi, A_wo)
    b = _B_ref(x, B_w_gate, B_w_up, B_w_down)
    return g * a + (1 - g) * b
```

```asm
; @launch kernel=k1_kernel grid=(256,1,1) block=(768,1,1) lds=160768
; @launch kernel=k2_kernel grid=(256,1,1) block=(256,1,1) lds=61440
.amdgcn_target "amdgcn-amd-amdhsa--gfx950"
.text
.globl k1_kernel
.p2align 8
.type k1_kernel,@function
k1_kernel:
    s_cmp_ge_u32 s2, 256
    s_cbranch_scc1 L_k1_exit
    s_load_dwordx16 s[16:31], s[0:1], 0
    s_load_dwordx8 s[32:39], s[0:1], 64
    s_and_b32 s4, s2, 1
    s_bfe_u32 s72, s2, 0x20001
    s_lshr_b32 s73, s2, 3
    s_lshl_b32 s72, s72, 5
    s_add_u32 s72, s72, s73
    s_lshl_b32 s73, s4, 2
    s_sub_u32 s74, 56, s73
    s_sub_u32 s14, s72, s74
    s_cmp_lt_u32 s72, 32
    s_cselect_b32 s14, s72, s14
    s_lshr_b32 s99, s14, 2
    s_and_b32 s5, s14, 3
    s_add_u32 s5, s5, s73
    s_mov_b32 s13, 2
    s_cmp_lt_u32 s72, s74
    s_cselect_b32 s13, 1, s13
    s_cmp_lt_u32 s72, 32
    s_cselect_b32 s13, 0, s13
    s_cmp_eq_u32 s13, 2
    s_cselect_b32 s73, s99, 0
    s_cmp_ge_u32 s73, 18
    s_cbranch_scc1 L_k1_exit
    s_sub_u32 s73, s72, 32
    s_cmp_eq_u32 s4, 0
    s_cselect_b32 s74, 43, 52
    s_mul_i32 s74, s73, s74
    s_lshr_b32 s74, s74, 8
    s_sub_u32 s8, 6, s4
    s_mul_i32 s8, s8, s74
    s_sub_u32 s8, s73, s8
    s_mul_i32 s9, s4, 6
    s_add_u32 s8, s8, s9
    s_cmp_eq_u32 s13, 1
    s_cselect_b32 s99, s74, s99
    s_cselect_b32 s5, s8, s5
    s_mul_i32 s3, s4, 96
    s_add_u32 s3, s3, s72
    s_add_u32 s3, s3, 32
    s_mov_b32 s4, s13
    s_lshr_b32 s14, s72, 2
    s_mul_i32 s14, s14, 3
    s_mul_i32 s74, s5, 3
    s_add_u32 s14, s14, s74
    s_mul_i32 s74, s14, 205
    s_lshr_b32 s74, s74, 11
    s_mul_i32 s74, s74, 10
    s_sub_u32 s14, s14, s74
    v_lshrrev_b32 v1, 6, v0
    s_nop 0
    v_readfirstlane_b32 s6, v1
    v_and_b32 v0, 63, v0
    v_and_b32 v10, 15, v0
    v_lshrrev_b32 v11, 4, v0
    v_bfe_u32 v12, v0, 2, 2
    v_and_b32 v13, 3, v0
    s_and_b32 s15, s6, 3
    s_lshr_b32 s7, s6, 2
    s_waitcnt lgkmcnt(0)
    s_mov_b32 s40, s16
    s_and_b32 s41, s17, 0xffff
    s_mov_b32 s42, 0x280000
    s_mov_b32 s43, 0x20000
    s_nop 7
    s_nop 3
    s_cmp_eq_u32 s4, 0
    s_cbranch_scc1 L_k1_kv
    s_cmp_eq_u32 s4, 1
    s_cbranch_scc1 L_k1_q
L_k1_gu:
    s_cmp_ge_u32 s6, 8
    s_cbranch_scc1 L_k1_ld_gu
    v_lshrrev_b32 v14, 1, v11
    v_lshlrev_b32 v14, 4, v14
    v_and_b32 v112, 1, v11
    v_lshl_add_u32 v14, v112, 2, v14
    v_add_u32 v14, v14, v12
    v_mul_u32_u24 v14, 192, v14
    v_mul_u32_u24 v15, 8, v13
    v_add3_u32 v14, v14, v15, 0
    v_add_u32 v14, 98304, v14
    s_cmp_eq_u32 s7, 0
    s_cselect_b32 s72, 0, 4
    v_xor_b32 v15, s72, v112
    v_lshl_add_u32 v5, v15, 5, v14
    s_cmp_eq_u32 s7, 0
    s_cselect_b32 s72, 1, 5
    v_xor_b32 v15, s72, v112
    v_lshl_add_u32 v6, v15, 5, v14
    s_cmp_eq_u32 s7, 0
    s_cselect_b32 s72, 2, 3
    v_xor_b32 v15, s72, v112
    v_lshl_add_u32 v7, v15, 5, v14
    v_lshrrev_b32 v14, 1, v10
    v_xor_b32 v15, v14, v11
    v_lshlrev_b32 v14, 7, v10
    v_lshl_add_u32 v14, v15, 4, v14
    s_mul_i32 s72, s15, 8192
    v_add_u32 v1, s72, v14
    v_xor_b32 v2, 64, v1
    v_mov_b32 v3, v1
    v_mov_b32 v8, v5
    v_mov_b32 v9, v6
    v_mov_b32 v10, v7
    s_mov_b32 s8, 12288
    s_mov_b32 s13, 0
    s_mov_b32 s12, 0
    v_mov_b32 v16, 0
    v_mov_b32 v17, 0
    v_mov_b32 v18, 0
    v_mov_b32 v19, 0
    v_mov_b32 v20, 0
    v_mov_b32 v21, 0
    v_mov_b32 v22, 0
    v_mov_b32 v23, 0
    v_mov_b32 v24, 0
    v_mov_b32 v25, 0
    v_mov_b32 v26, 0
    v_mov_b32 v27, 0
    v_mov_b32 v28, 0
    v_mov_b32 v29, 0
    v_mov_b32 v30, 0
    v_mov_b32 v31, 0
    v_mov_b32 v32, 0
    v_mov_b32 v33, 0
    v_mov_b32 v34, 0
    v_mov_b32 v35, 0
    v_mov_b32 v36, 0
    v_mov_b32 v37, 0
    v_mov_b32 v38, 0
    v_mov_b32 v39, 0
    v_mov_b32 v40, 0
    v_mov_b32 v41, 0
    v_mov_b32 v42, 0
    v_mov_b32 v43, 0
    v_mov_b32 v44, 0
    v_mov_b32 v45, 0
    v_mov_b32 v46, 0
    v_mov_b32 v47, 0
    v_mov_b32 v48, 0
    v_mov_b32 v49, 0
    v_mov_b32 v50, 0
    v_mov_b32 v51, 0
    v_mov_b32 v52, 0
    v_mov_b32 v53, 0
    v_mov_b32 v54, 0
    v_mov_b32 v55, 0
    v_mov_b32 v56, 0
    v_mov_b32 v57, 0
    v_mov_b32 v58, 0
    v_mov_b32 v59, 0
    v_mov_b32 v60, 0
    v_mov_b32 v61, 0
    v_mov_b32 v62, 0
    v_mov_b32 v63, 0
    v_mov_b32 v64, 0
    v_mov_b32 v65, 0
    v_mov_b32 v66, 0
    v_mov_b32 v67, 0
    v_mov_b32 v68, 0
    v_mov_b32 v69, 0
    v_mov_b32 v70, 0
    v_mov_b32 v71, 0
    v_mov_b32 v72, 0
    v_mov_b32 v73, 0
    v_mov_b32 v74, 0
    v_mov_b32 v75, 0
    v_mov_b32 v76, 0
    v_mov_b32 v77, 0
    v_mov_b32 v78, 0
    v_mov_b32 v79, 0
    v_mov_b32 v80, 0
    v_mov_b32 v81, 0
    v_mov_b32 v82, 0
    v_mov_b32 v83, 0
    v_mov_b32 v84, 0
    v_mov_b32 v85, 0
    v_mov_b32 v86, 0
    v_mov_b32 v87, 0
    v_mov_b32 v88, 0
    v_mov_b32 v89, 0
    v_mov_b32 v90, 0
    v_mov_b32 v91, 0
    v_mov_b32 v92, 0
    v_mov_b32 v93, 0
    v_mov_b32 v94, 0
    v_mov_b32 v95, 0
    v_mov_b32 v96, 0
    v_mov_b32 v97, 0
    v_mov_b32 v98, 0
    v_mov_b32 v99, 0
    v_mov_b32 v100, 0
    v_mov_b32 v101, 0
    v_mov_b32 v102, 0
    v_mov_b32 v103, 0
    v_mov_b32 v104, 0
    v_mov_b32 v105, 0
    v_mov_b32 v106, 0
    v_mov_b32 v107, 0
    v_mov_b32 v108, 0
    v_mov_b32 v109, 0
    v_mov_b32 v110, 0
    v_mov_b32 v111, 0
    s_mov_b32 s48, s38
    s_and_b32 s49, s39, 0xffff
    s_mov_b32 s50, 0x6c0000
    s_mov_b32 s51, 0x20000
    s_barrier
    ds_read_b128 v[112:115], v3 offset:0
    ds_read_b128 v[116:119], v3 offset:2048
    ds_read_b128 v[120:123], v3 offset:4096
    ds_read_b128 v[124:127], v3 offset:6144
    ds_read_b64_tr_b16 v[144:145], v8 offset:0
    ds_read_b64_tr_b16 v[146:147], v8 offset:1536
    ds_read_b64_tr_b16 v[148:149], v9 offset:0
    ds_read_b64_tr_b16 v[150:151], v9 offset:1536
    ds_read_b64_tr_b16 v[152:153], v10 offset:0
    ds_read_b64_tr_b16 v[154:155], v10 offset:1536
    ds_read_b64_tr_b16 v[156:157], v8 offset:6144
    ds_read_b64_tr_b16 v[158:159], v8 offset:7680
    s_waitcnt lgkmcnt(0)
    s_nop 7
    s_nop 3
L_k1_loop_gu:
    s_waitcnt lgkmcnt(6)
    v_mfma_f32_16x16x32_bf16 v[16:19], v[144:147], v[112:115], v[16:19]
    ds_read_b64_tr_b16 v[160:161], v9 offset:6144
    v_mfma_f32_16x16x32_bf16 v[40:43], v[144:147], v[116:119], v[40:43]
    ds_read_b64_tr_b16 v[162:163], v9 offset:7680
    v_mfma_f32_16x16x32_bf16 v[64:67], v[144:147], v[120:123], v[64:67]
    v_mfma_f32_16x16x32_bf16 v[88:91], v[144:147], v[124:127], v[88:91]
    s_waitcnt lgkmcnt(6)
    v_mfma_f32_16x16x32_bf16 v[20:23], v[148:151], v[112:115], v[20:23]
    ds_read_b64_tr_b16 v[164:165], v10 offset:6144
    v_mfma_f32_16x16x32_bf16 v[44:47], v[148:151], v[116:119], v[44:47]
    ds_read_b64_tr_b16 v[166:167], v10 offset:7680
    v_mfma_f32_16x16x32_bf16 v[68:71], v[148:151], v[120:123], v[68:71]
    s_barrier
    v_add_u32 v4, s13, v2
    v_add_u32 v11, s8, v5
    v_add_u32 v12, s8, v6
    v_add_u32 v13, s8, v7
    v_mfma_f32_16x16x32_bf16 v[92:95], v[148:151], v[124:127], v[92:95]
    s_add_u32 s8, s8, 12288
    s_cmp_eq_u32 s8, 61440
    s_cselect_b32 s8, 0, s8
    s_waitcnt lgkmcnt(6)
    v_mfma_f32_16x16x32_bf16 v[24:27], v[152:155], v[112:115], v[24:27]
    ds_read_b128 v[128:131], v4 offset:0
    v_mfma_f32_16x16x32_bf16 v[48:51], v[152:155], v[116:119], v[48:51]
    ds_read_b128 v[132:135], v4 offset:2048
    v_mfma_f32_16x16x32_bf16 v[72:75], v[152:155], v[120:123], v[72:75]
    ds_read_b64_tr_b16 v[144:145], v11 offset:0
    v_mfma_f32_16x16x32_bf16 v[96:99], v[152:155], v[124:127], v[96:99]
    ds_read_b64_tr_b16 v[146:147], v11 offset:1536
    s_waitcnt lgkmcnt(8)
    v_mfma_f32_16x16x32_bf16 v[28:31], v[156:159], v[112:115], v[28:31]
    ds_read_b128 v[136:139], v4 offset:4096
    v_mfma_f32_16x16x32_bf16 v[52:55], v[156:159], v[116:119], v[52:55]
    ds_read_b128 v[140:143], v4 offset:6144
    v_mfma_f32_16x16x32_bf16 v[76:79], v[156:159], v[120:123], v[76:79]
    ds_read_b64_tr_b16 v[148:149], v12 offset:0
    v_mfma_f32_16x16x32_bf16 v[100:103], v[156:159], v[124:127], v[100:103]
    ds_read_b64_tr_b16 v[150:151], v12 offset:1536
    s_waitcnt lgkmcnt(10)
    v_mfma_f32_16x16x32_bf16 v[32:35], v[160:163], v[112:115], v[32:35]
    ds_read_b64_tr_b16 v[152:153], v13 offset:0
    v_mfma_f32_16x16x32_bf16 v[56:59], v[160:163], v[116:119], v[56:59]
    ds_read_b64_tr_b16 v[154:155], v13 offset:1536
    v_mfma_f32_16x16x32_bf16 v[80:83], v[160:163], v[120:123], v[80:83]
    v_mfma_f32_16x16x32_bf16 v[104:107], v[160:163], v[124:127], v[104:107]
    s_waitcnt lgkmcnt(10)
    v_mfma_f32_16x16x32_bf16 v[36:39], v[164:167], v[112:115], v[36:39]
    ds_read_b64_tr_b16 v[156:157], v11 offset:6144
    v_mfma_f32_16x16x32_bf16 v[60:63], v[164:167], v[116:119], v[60:63]
    ds_read_b64_tr_b16 v[158:159], v11 offset:7680
    v_mfma_f32_16x16x32_bf16 v[84:87], v[164:167], v[120:123], v[84:87]
    v_mfma_f32_16x16x32_bf16 v[108:111], v[164:167], v[124:127], v[108:111]
    s_waitcnt lgkmcnt(6)
    v_mfma_f32_16x16x32_bf16 v[16:19], v[144:147], v[128:131], v[16:19]
    ds_read_b64_tr_b16 v[160:161], v12 offset:6144
    v_mfma_f32_16x16x32_bf16 v[40:43], v[144:147], v[132:135], v[40:43]
    ds_read_b64_tr_b16 v[162:163], v12 offset:7680
    v_mfma_f32_16x16x32_bf16 v[64:67], v[144:147], v[136:139], v[64:67]
    v_mfma_f32_16x16x32_bf16 v[88:91], v[144:147], v[140:143], v[88:91]
    s_waitcnt lgkmcnt(6)
    v_mfma_f32_16x16x32_bf16 v[20:23], v[148:151], v[128:131], v[20:23]
    ds_read_b64_tr_b16 v[164:165], v13 offset:6144
    v_mfma_f32_16x16x32_bf16 v[44:47], v[148:151], v[132:135], v[44:47]
    ds_read_b64_tr_b16 v[166:167], v13 offset:7680
    v_mfma_f32_16x16x32_bf16 v[68:71], v[148:151], v[136:139], v[68:71]
    s_add_u32 s13, s13, 32768
    s_cmp_eq_u32 s13, 98304
    s_cselect_b32 s13, 0, s13
    s_barrier
    v_add_u32 v3, s13, v1
    v_add_u32 v8, s8, v5
    v_add_u32 v9, s8, v6
    v_add_u32 v10, s8, v7
    v_mfma_f32_16x16x32_bf16 v[92:95], v[148:151], v[140:143], v[92:95]
    s_add_u32 s8, s8, 12288
    s_cmp_eq_u32 s8, 61440
    s_cselect_b32 s8, 0, s8
    s_waitcnt lgkmcnt(6)
    v_mfma_f32_16x16x32_bf16 v[24:27], v[152:155], v[128:131], v[24:27]
    ds_read_b128 v[112:115], v3 offset:0
    v_mfma_f32_16x16x32_bf16 v[48:51], v[152:155], v[132:135], v[48:51]
    ds_read_b128 v[116:119], v3 offset:2048
    v_mfma_f32_16x16x32_bf16 v[72:75], v[152:155], v[136:139], v[72:75]
    ds_read_b64_tr_b16 v[144:145], v8 offset:0
    v_mfma_f32_16x16x32_bf16 v[96:99], v[152:155], v[140:143], v[96:99]
    ds_read_b64_tr_b16 v[146:147], v8 offset:1536
    s_waitcnt lgkmcnt(8)
    v_mfma_f32_16x16x32_bf16 v[28:31], v[156:159], v[128:131], v[28:31]
    ds_read_b128 v[120:123], v3 offset:4096
    v_mfma_f32_16x16x32_bf16 v[52:55], v[156:159], v[132:135], v[52:55]
    ds_read_b128 v[124:127], v3 offset:6144
    v_mfma_f32_16x16x32_bf16 v[76:79], v[156:159], v[136:139], v[76:79]
    ds_read_b64_tr_b16 v[148:149], v9 offset:0
    v_mfma_f32_16x16x32_bf16 v[100:103], v[156:159], v[140:143], v[100:103]
    ds_read_b64_tr_b16 v[150:151], v9 offset:1536
    s_waitcnt lgkmcnt(10)
    v_mfma_f32_16x16x32_bf16 v[32:35], v[160:163], v[128:131], v[32:35]
    ds_read_b64_tr_b16 v[152:153], v10 offset:0
    v_mfma_f32_16x16x32_bf16 v[56:59], v[160:163], v[132:135], v[56:59]
    ds_read_b64_tr_b16 v[154:155], v10 offset:1536
    v_mfma_f32_16x16x32_bf16 v[80:83], v[160:163], v[136:139], v[80:83]
    v_mfma_f32_16x16x32_bf16 v[104:107], v[160:163], v[140:143], v[104:107]
    s_waitcnt lgkmcnt(10)
    v_mfma_f32_16x16x32_bf16 v[36:39], v[164:167], v[128:131], v[36:39]
    ds_read_b64_tr_b16 v[156:157], v8 offset:6144
    v_mfma_f32_16x16x32_bf16 v[60:63], v[164:167], v[132:135], v[60:63]
    ds_read_b64_tr_b16 v[158:159], v8 offset:7680
    v_mfma_f32_16x16x32_bf16 v[84:87], v[164:167], v[136:139], v[84:87]
    v_mfma_f32_16x16x32_bf16 v[108:111], v[164:167], v[140:143], v[108:111]
    s_add_u32 s12, s12, 1
    s_cmp_lt_u32 s12, 10
    s_cbranch_scc1 L_k1_loop_gu
    s_nop 7
    s_nop 3
    s_waitcnt vmcnt(0) lgkmcnt(0)
    s_mul_i32 s72, s5, 16
    s_mul_i32 s73, s15, 4
    s_add_u32 s72, s72, s73
    v_mov_b32 v14, 0xc0135761
    s_mov_b32 s98, 0xbdd2d3e8
    s_mul_i32 s72, s72, 54
    s_mul_i32 s73, s99, 3
    s_add_u32 s72, s72, s73
    s_lshl_b32 s72, s72, 10
    s_lshl_b32 s73, s7, 11
    s_add_u32 s73, s73, s72
    s_lshl_b32 s74, s7, 3
    s_add_u32 s74, s74, s72
    s_add_u32 s74, s74, 1024
    v_lshlrev_b32 v15, 4, v0
    v_pk_mul_f32 v[112:113], v[16:17], v[16:17]
    v_pk_mul_f32 v[114:115], v[18:19], v[18:19]
    v_pk_mul_f32 v[116:117], v[20:21], v[20:21]
    v_pk_mul_f32 v[118:119], v[22:23], v[22:23]
    v_pk_mul_f32 v[120:121], v[24:25], v[24:25]
    v_pk_mul_f32 v[122:123], v[26:27], v[26:27]
    v_pk_fma_f32 v[112:113], v[112:113], s[98:99], v[14:15] op_sel_hi:[1,0,0]
    v_pk_fma_f32 v[114:115], v[114:115], s[98:99], v[14:15] op_sel_hi:[1,0,0]
    v_pk_fma_f32 v[116:117], v[116:117], s[98:99], v[14:15] op_sel_hi:[1,0,0]
    v_pk_fma_f32 v[118:119], v[118:119], s[98:99], v[14:15] op_sel_hi:[1,0,0]
    v_pk_fma_f32 v[120:121], v[120:121], s[98:99], v[14:15] op_sel_hi:[1,0,0]
    v_pk_fma_f32 v[122:123], v[122:123], s[98:99], v[14:15] op_sel_hi:[1,0,0]
    v_pk_mul_f32 v[112:113], v[112:113], v[16:17]
    v_pk_mul_f32 v[114:115], v[114:115], v[18:19]
    v_pk_mul_f32 v[116:117], v[116:117], v[20:21]
    v_pk_mul_f32 v[118:119], v[118:119], v[22:23]
    v_pk_mul_f32 v[120:121], v[120:121], v[24:25]
    v_pk_mul_f32 v[122:123], v[122:123], v[26:27]
    v_exp_f32 v112, v112
    v_exp_f32 v113, v113
    v_pk_mul_f32 v[16:17], v[16:17], v[28:29]
    v_exp_f32 v114, v114
    v_exp_f32 v115, v115
    v_pk_mul_f32 v[18:19], v[18:19], v[30:31]
    v_exp_f32 v116, v116
    v_exp_f32 v117, v117
    v_pk_mul_f32 v[20:21], v[20:21], v[32:33]
    v_exp_f32 v118, v118
    v_exp_f32 v119, v119
    v_pk_mul_f32 v[22:23], v[22:23], v[34:35]
    v_exp_f32 v120, v120
    v_exp_f32 v121, v121
    v_pk_mul_f32 v[24:25], v[24:25], v[36:37]
    v_exp_f32 v122, v122
    v_exp_f32 v123, v123
    v_pk_mul_f32 v[26:27], v[26:27], v[38:39]
    v_pk_add_f32 v[112:113], v[112:113], 1.0 op_sel_hi:[1,0]
    v_pk_add_f32 v[114:115], v[114:115], 1.0 op_sel_hi:[1,0]
    v_pk_add_f32 v[116:117], v[116:117], 1.0 op_sel_hi:[1,0]
    v_pk_add_f32 v[118:119], v[118:119], 1.0 op_sel_hi:[1,0]
    v_pk_add_f32 v[120:121], v[120:121], 1.0 op_sel_hi:[1,0]
    v_pk_add_f32 v[122:123], v[122:123], 1.0 op_sel_hi:[1,0]
    v_rcp_f32 v112, v112
    v_rcp_f32 v113, v113
    v_rcp_f32 v114, v114
    v_rcp_f32 v115, v115
    v_rcp_f32 v116, v116
    v_rcp_f32 v117, v117
    v_rcp_f32 v118, v118
    v_rcp_f32 v119, v119
    v_rcp_f32 v120, v120
    v_rcp_f32 v121, v121
    v_rcp_f32 v122, v122
    v_rcp_f32 v123, v123
    v_pk_mul_f32 v[112:113], v[112:113], v[16:17]
    v_pk_mul_f32 v[114:115], v[114:115], v[18:19]
    v_pk_mul_f32 v[116:117], v[116:117], v[20:21]
    v_pk_mul_f32 v[118:119], v[118:119], v[22:23]
    v_pk_mul_f32 v[120:121], v[120:121], v[24:25]
    v_pk_mul_f32 v[122:123], v[122:123], v[26:27]
    v_cvt_pk_bf16_f32 v124, v112, v113
    v_cvt_pk_bf16_f32 v125, v114, v115
    v_cvt_pk_bf16_f32 v126, v116, v117
    v_cvt_pk_bf16_f32 v127, v118, v119
    v_cvt_pk_bf16_f32 v128, v120, v121
    v_cvt_pk_bf16_f32 v129, v122, v123
    buffer_store_dwordx4 v[124:127], v15, s[48:51], s73 offen sc1
    buffer_store_dwordx2 v[128:129], v15, s[48:51], s74 offen sc1
    s_add_u32 s73, s73, 55296
    s_add_u32 s74, s74, 55296
    v_pk_mul_f32 v[140:141], v[40:41], v[40:41]
    v_pk_mul_f32 v[142:143], v[42:43], v[42:43]
    v_pk_mul_f32 v[144:145], v[44:45], v[44:45]
    v_pk_mul_f32 v[146:147], v[46:47], v[46:47]
    v_pk_mul_f32 v[148:149], v[48:49], v[48:49]
    v_pk_mul_f32 v[150:151], v[50:51], v[50:51]
    v_pk_fma_f32 v[140:141], v[140:141], s[98:99], v[14:15] op_sel_hi:[1,0,0]
    v_pk_fma_f32 v[142:143], v[142:143], s[98:99], v[14:15] op_sel_hi:[1,0,0]
    v_pk_fma_f32 v[144:145], v[144:145], s[98:99], v[14:15] op_sel_hi:[1,0,0]
    v_pk_fma_f32 v[146:147], v[146:147], s[98:99], v[14:15] op_sel_hi:[1,0,0]
    v_pk_fma_f32 v[148:149], v[148:149], s[98:99], v[14:15] op_sel_hi:[1,0,0]
    v_pk_fma_f32 v[150:151], v[150:151], s[98:99], v[14:15] op_sel_hi:[1,0,0]
    v_pk_mul_f32 v[140:141], v[140:141], v[40:41]
    v_pk_mul_f32 v[142:143], v[142:143], v[42:43]
    v_pk_mul_f32 v[144:145], v[144:145], v[44:45]
    v_pk_mul_f32 v[146:147], v[146:147], v[46:47]
    v_pk_mul_f32 v[148:149], v[148:149], v[48:49]
    v_pk_mul_f32 v[150:151], v[150:151], v[50:51]
    v_exp_f32 v140, v140
    v_exp_f32 v141, v141
    v_pk_mul_f32 v[40:41], v[40:41], v[52:53]
    v_exp_f32 v142, v142
    v_exp_f32 v143, v143
    v_pk_mul_f32 v[42:43], v[42:43], v[54:55]
    v_exp_f32 v144, v144
    v_exp_f32 v145, v145
    v_pk_mul_f32 v[44:45], v[44:45], v[56:57]
    v_exp_f32 v146, v146
    v_exp_f32 v147, v147
    v_pk_mul_f32 v[46:47], v[46:47], v[58:59]
    v_exp_f32 v148, v148
    v_exp_f32 v149, v149
    v_pk_mul_f32 v[48:49], v[48:49], v[60:61]
    v_exp_f32 v150, v150
    v_exp_f32 v151, v151
    v_pk_mul_f32 v[50:51], v[50:51], v[62:63]
    v_pk_add_f32 v[140:141], v[140:141], 1.0 op_sel_hi:[1,0]
    v_pk_add_f32 v[142:143], v[142:143], 1.0 op_sel_hi:[1,0]
    v_pk_add_f32 v[144:145], v[144:145], 1.0 op_sel_hi:[1,0]
    v_pk_add_f32 v[146:147], v[146:147], 1.0 op_sel_hi:[1,0]
    v_pk_add_f32 v[148:149], v[148:149], 1.0 op_sel_hi:[1,0]
    v_pk_add_f32 v[150:151], v[150:151], 1.0 op_sel_hi:[1,0]
    v_rcp_f32 v140, v140
    v_rcp_f32 v141, v141
    v_rcp_f32 v142, v142
    v_rcp_f32 v143, v143
    v_rcp_f32 v144, v144
    v_rcp_f32 v145, v145
    v_rcp_f32 v146, v146
    v_rcp_f32 v147, v147
    v_rcp_f32 v148, v148
    v_rcp_f32 v149, v149
    v_rcp_f32 v150, v150
    v_rcp_f32 v151, v151
    v_pk_mul_f32 v[140:141], v[140:141], v[40:41]
    v_pk_mul_f32 v[142:143], v[142:143], v[42:43]
    v_pk_mul_f32 v[144:145], v[144:145], v[44:45]
    v_pk_mul_f32 v[146:147], v[146:147], v[46:47]
    v_pk_mul_f32 v[148:149], v[148:149], v[48:49]
    v_pk_mul_f32 v[150:151], v[150:151], v[50:51]
    v_cvt_pk_bf16_f32 v152, v140, v141
    v_cvt_pk_bf16_f32 v153, v142, v143
    v_cvt_pk_bf16_f32 v154, v144, v145
    v_cvt_pk_bf16_f32 v155, v146, v147
    v_cvt_pk_bf16_f32 v156, v148, v149
    v_cvt_pk_bf16_f32 v157, v150, v151
    buffer_store_dwordx4 v[152:155], v15, s[48:51], s73 offen sc1
    buffer_store_dwordx2 v[156:157], v15, s[48:51], s74 offen sc1
    s_add_u32 s73, s73, 55296
    s_add_u32 s74, s74, 55296
    v_pk_mul_f32 v[112:113], v[64:65], v[64:65]
    v_pk_mul_f32 v[114:115], v[66:67], v[66:67]
    v_pk_mul_f32 v[116:117], v[68:69], v[68:69]
    v_pk_mul_f32 v[118:119], v[70:71], v[70:71]
    v_pk_mul_f32 v[120:121], v[72:73], v[72:73]
    v_pk_mul_f32 v[122:123], v[74:75], v[74:75]
    v_pk_fma_f32 v[112:113], v[112:113], s[98:99], v[14:15] op_sel_hi:[1,0,0]
    v_pk_fma_f32 v[114:115], v[114:115], s[98:99], v[14:15] op_sel_hi:[1,0,0]
    v_pk_fma_f32 v[116:117], v[116:117], s[98:99], v[14:15] op_sel_hi:[1,0,0]
    v_pk_fma_f32 v[118:119], v[118:119], s[98:99], v[14:15] op_sel_hi:[1,0,0]
    v_pk_fma_f32 v[120:121], v[120:121], s[98:99], v[14:15] op_sel_hi:[1,0,0]
    v_pk_fma_f32 v[122:123], v[122:123], s[98:99], v[14:15] op_sel_hi:[1,0,0]
    v_pk_mul_f32 v[112:113], v[112:113], v[64:65]
    v_pk_mul_f32 v[114:115], v[114:115], v[66:67]
    v_pk_mul_f32 v[116:117], v[116:117], v[68:69]
    v_pk_mul_f32 v[118:119], v[118:119], v[70:71]
    v_pk_mul_f32 v[120:121], v[120:121], v[72:73]
    v_pk_mul_f32 v[122:123], v[122:123], v[74:75]
    v_exp_f32 v112, v112
    v_exp_f32 v113, v113
    v_pk_mul_f32 v[64:65], v[64:65], v[76:77]
    v_exp_f32 v114, v114
    v_exp_f32 v115, v115
    v_pk_mul_f32 v[66:67], v[66:67], v[78:79]
    v_exp_f32 v116, v116
    v_exp_f32 v117, v117
    v_pk_mul_f32 v[68:69], v[68:69], v[80:81]
    v_exp_f32 v118, v118
    v_exp_f32 v119, v119
    v_pk_mul_f32 v[70:71], v[70:71], v[82:83]
    v_exp_f32 v120, v120
    v_exp_f32 v121, v121
    v_pk_mul_f32 v[72:73], v[72:73], v[84:85]
    v_exp_f32 v122, v122
    v_exp_f32 v123, v123
    v_pk_mul_f32 v[74:75], v[74:75], v[86:87]
    v_pk_add_f32 v[112:113], v[112:113], 1.0 op_sel_hi:[1,0]
    v_pk_add_f32 v[114:115], v[114:115], 1.0 op_sel_hi:[1,0]
    v_pk_add_f32 v[116:117], v[116:117], 1.0 op_sel_hi:[1,0]
    v_pk_add_f32 v[118:119], v[118:119], 1.0 op_sel_hi:[1,0]
    v_pk_add_f32 v[120:121], v[120:121], 1.0 op_sel_hi:[1,0]
    v_pk_add_f32 v[122:123], v[122:123], 1.0 op_sel_hi:[1,0]
    v_rcp_f32 v112, v112
    v_rcp_f32 v113, v113
    v_rcp_f32 v114, v114
    v_rcp_f32 v115, v115
    v_rcp_f32 v116, v116
    v_rcp_f32 v117, v117
    v_rcp_f32 v118, v118
    v_rcp_f32 v119, v119
    v_rcp_f32 v120, v120
    v_rcp_f32 v121, v121
    v_rcp_f32 v122, v122
    v_rcp_f32 v123, v123
    v_pk_mul_f32 v[112:113], v[112:113], v[64:65]
    v_pk_mul_f32 v[114:115], v[114:115], v[66:67]
    v_pk_mul_f32 v[116:117], v[116:117], v[68:69]
    v_pk_mul_f32 v[118:119], v[118:119], v[70:71]
    v_pk_mul_f32 v[120:121], v[120:121], v[72:73]
    v_pk_mul_f32 v[122:123], v[122:123], v[74:75]
    v_cvt_pk_bf16_f32 v124, v112, v113
    v_cvt_pk_bf16_f32 v125, v114, v115
    v_cvt_pk_bf16_f32 v126, v116, v117
    v_cvt_pk_bf16_f32 v127, v118, v119
    v_cvt_pk_bf16_f32 v128, v120, v121
    v_cvt_pk_bf16_f32 v129, v122, v123
    buffer_store_dwordx4 v[124:127], v15, s[48:51], s73 offen sc1
    buffer_store_dwordx2 v[128:129], v15, s[48:51], s74 offen sc1
    s_add_u32 s73, s73, 55296
    s_add_u32 s74, s74, 55296
    v_pk_mul_f32 v[140:141], v[88:89], v[88:89]
    v_pk_mul_f32 v[142:143], v[90:91], v[90:91]
    v_pk_mul_f32 v[144:145], v[92:93], v[92:93]
    v_pk_mul_f32 v[146:147], v[94:95], v[94:95]
    v_pk_mul_f32 v[148:149], v[96:97], v[96:97]
    v_pk_mul_f32 v[150:151], v[98:99], v[98:99]
    v_pk_fma_f32 v[140:141], v[140:141], s[98:99], v[14:15] op_sel_hi:[1,0,0]
    v_pk_fma_f32 v[142:143], v[142:143], s[98:99], v[14:15] op_sel_hi:[1,0,0]
    v_pk_fma_f32 v[144:145], v[144:145], s[98:99], v[14:15] op_sel_hi:[1,0,0]
    v_pk_fma_f32 v[146:147], v[146:147], s[98:99], v[14:15] op_sel_hi:[1,0,0]
    v_pk_fma_f32 v[148:149], v[148:149], s[98:99], v[14:15] op_sel_hi:[1,0,0]
    v_pk_fma_f32 v[150:151], v[150:151], s[98:99], v[14:15] op_sel_hi:[1,0,0]
    v_pk_mul_f32 v[140:141], v[140:141], v[88:89]
    v_pk_mul_f32 v[142:143], v[142:143], v[90:91]
    v_pk_mul_f32 v[144:145], v[144:145], v[92:93]
    v_pk_mul_f32 v[146:147], v[146:147], v[94:95]
    v_pk_mul_f32 v[148:149], v[148:149], v[96:97]
    v_pk_mul_f32 v[150:151], v[150:151], v[98:99]
    v_exp_f32 v140, v140
    v_exp_f32 v141, v141
    v_pk_mul_f32 v[88:89], v[88:89], v[100:101]
    v_exp_f32 v142, v142
    v_exp_f32 v143, v143
    v_pk_mul_f32 v[90:91], v[90:91], v[102:103]
    v_exp_f32 v144, v144
    v_exp_f32 v145, v145
    v_pk_mul_f32 v[92:93], v[92:93], v[104:105]
    v_exp_f32 v146, v146
    v_exp_f32 v147, v147
    v_pk_mul_f32 v[94:95], v[94:95], v[106:107]
    v_exp_f32 v148, v148
    v_exp_f32 v149, v149
    v_pk_mul_f32 v[96:97], v[96:97], v[108:109]
    v_exp_f32 v150, v150
    v_exp_f32 v151, v151
    v_pk_mul_f32 v[98:99], v[98:99], v[110:111]
    v_pk_add_f32 v[140:141], v[140:141], 1.0 op_sel_hi:[1,0]
    v_pk_add_f32 v[142:143], v[142:143], 1.0 op_sel_hi:[1,0]
    v_pk_add_f32 v[144:145], v[144:145], 1.0 op_sel_hi:[1,0]
    v_pk_add_f32 v[146:147], v[146:147], 1.0 op_sel_hi:[1,0]
    v_pk_add_f32 v[148:149], v[148:149], 1.0 op_sel_hi:[1,0]
    v_pk_add_f32 v[150:151], v[150:151], 1.0 op_sel_hi:[1,0]
    v_rcp_f32 v140, v140
    v_rcp_f32 v141, v141
    v_rcp_f32 v142, v142
    v_rcp_f32 v143, v143
    v_rcp_f32 v144, v144
    v_rcp_f32 v145, v145
    v_rcp_f32 v146, v146
    v_rcp_f32 v147, v147
    v_rcp_f32 v148, v148
    v_rcp_f32 v149, v149
    v_rcp_f32 v150, v150
    v_rcp_f32 v151, v151
    v_pk_mul_f32 v[140:141], v[140:141], v[88:89]
    v_pk_mul_f32 v[142:143], v[142:143], v[90:91]
    v_pk_mul_f32 v[144:145], v[144:145], v[92:93]
    v_pk_mul_f32 v[146:147], v[146:147], v[94:95]
    v_pk_mul_f32 v[148:149], v[148:149], v[96:97]
    v_pk_mul_f32 v[150:151], v[150:151], v[98:99]
    v_cvt_pk_bf16_f32 v152, v140, v141
    v_cvt_pk_bf16_f32 v153, v142, v143
    v_cvt_pk_bf16_f32 v154, v144, v145
    v_cvt_pk_bf16_f32 v155, v146, v147
    v_cvt_pk_bf16_f32 v156, v148, v149
    v_cvt_pk_bf16_f32 v157, v150, v151
    buffer_store_dwordx4 v[152:155], v15, s[48:51], s73 offen sc1
    buffer_store_dwordx2 v[156:157], v15, s[48:51], s74 offen sc1
    s_endpgm
L_k1_ld_gu:
    s_setprio 3
    s_mov_b32 s9, 0
    s_mov_b32 s12, 0
    s_and_b32 s15, s6, 1
    s_cmp_ge_u32 s6, 10
    s_cbranch_scc1 L_k1_ldw_gu
    v_and_b32 v14, 7, v0
    v_xor_b32 v14, v14, v11
    v_lshrrev_b32 v15, 3, v0
    v_mul_u32_u24 v15, 1280, v15
    v_lshl_add_u32 v16, v14, 4, v15
    v_xor_b32 v14, 4, v14
    v_lshl_add_u32 v17, v14, 4, v15
    v_add_u32 v17, 10240, v17
    v_add_u32 v18, 20480, v16
    v_add_u32 v19, 20480, v17
    v_add_u32 v20, 40960, v16
    v_add_u32 v21, 40960, v17
    v_add_u32 v22, 61440, v16
    v_add_u32 v23, 61440, v17
    s_mul_i32 s10, s5, 327680
    s_mul_i32 s72, s15, 163840
    s_add_u32 s11, s10, s72
    s_lshl_b32 s8, s14, 7
    s_add_u32 s10, s11, s8
    s_mul_i32 s7, s15, 16384
    s_add_u32 m0, s9, s7
    s_mov_b32 s72, s10
    buffer_load_dwordx4 v16, s[40:43], s72 offen lds
    s_add_u32 m0, m0, 1024
    s_nop 0
    buffer_load_dwordx4 v17, s[40:43], s72 offen lds
    s_add_u32 m0, m0, 1024
    s_nop 0
    buffer_load_dwordx4 v18, s[40:43], s72 offen lds
    s_add_u32 m0, m0, 1024
    s_nop 0
    buffer_load_dwordx4 v19, s[40:43], s72 offen lds
    s_add_u32 m0, m0, 1024
    s_nop 0
    buffer_load_dwordx4 v20, s[40:43], s72 offen lds
    s_add_u32 m0, m0, 1024
    s_nop 0
    buffer_load_dwordx4 v21, s[40:43], s72 offen lds
    s_add_u32 m0, m0, 1024
    s_nop 0
    buffer_load_dwordx4 v22, s[40:43], s72 offen lds
    s_add_u32 m0, m0, 1024
    s_nop 0
    buffer_load_dwordx4 v23, s[40:43], s72 offen lds
    s_add_u32 m0, s9, s7
    s_add_u32 m0, m0, 8192
    s_add_u32 s72, s10, 81920
    buffer_load_dwordx4 v16, s[40:43], s72 offen lds
    s_add_u32 m0, m0, 1024
    s_nop 0
    buffer_load_dwordx4 v17, s[40:43], s72 offen lds
    s_add_u32 m0, m0, 1024
    s_nop 0
    buffer_load_dwordx4 v18, s[40:43], s72 offen lds
    s_add_u32 m0, m0, 1024
    s_nop 0
    buffer_load_dwordx4 v19, s[40:43], s72 offen lds
    s_add_u32 m0, m0, 1024
    s_nop 0
    buffer_load_dwordx4 v20, s[40:43], s72 offen lds
    s_add_u32 m0, m0, 1024
    s_nop 0
    buffer_load_dwordx4 v21, s[40:43], s72 offen lds
    s_add_u32 m0, m0, 1024
    s_nop 0
    buffer_load_dwordx4 v22, s[40:43], s72 offen lds
    s_add_u32 m0, m0, 1024
    s_nop 0
    buffer_load_dwordx4 v23, s[40:43], s72 offen lds
    s_add_u32 s8, s8, 128
    s_cmp_eq_u32 s8, 1280
    s_cselect_b32 s8, 0, s8
    s_add_u32 s10, s11, s8
    s_add_u32 s9, s9, 32768
    s_cmp_eq_u32 s9, 98304
    s_cselect_b32 s9, 0, s9
    s_mov_b32 s84, s30
    s_and_b32 s85, s31, 0xffff
    s_mov_b32 s86, 0x21c000
    s_mov_b32 s87, 0x20000
    s_mov_b32 s88, s22
    s_and_b32 s89, s23, 0xffff
    s_mov_b32 s90, 0xc8000
    s_mov_b32 s91, 0x20000
    s_add_u32 s92, s38, 0x1000000
    s_addc_u32 s93, s39, 0
    s_and_b32 s93, s93, 0xffff
    s_mov_b32 s94, 0x2e4000
    s_mov_b32 s95, 0x20000
    s_mov_b32 s56, s32
    s_and_b32 s57, s33, 0xffff
    s_mov_b32 s58, 0x500
    s_mov_b32 s59, 0x20000
    s_add_u32 s60, s38, 0xe30000
    s_addc_u32 s61, s39, 0
    s_and_b32 s61, s61, 0xffff
    s_mov_b32 s62, 0x2000
    s_mov_b32 s63, 0x20000
    s_add_u32 s64, s38, 0xe20000
    s_addc_u32 s65, s39, 0
    s_and_b32 s65, s65, 0xffff
    s_mov_b32 s66, 0x400
    s_mov_b32 s67, 0x20000
    v_add_u32 v15, 0, v0
    v_mul_u32_u24 v14, 205, v15
    v_lshrrev_b32 v14, 11, v14
    v_mul_u32_u24 v1, 10, v14
    v_sub_u32 v15, v15, v1
    v_lshlrev_b32 v15, 4, v15
    v_and_b32 v1, 7, v14
    v_and_b32 v2, 8, v14
    v_lshl_or_b32 v1, v2, 1, v1
    v_and_b32 v2, 16, v14
    v_lshrrev_b32 v2, 1, v2
    v_or_b32 v1, v1, v2
    v_mul_u32_u24 v1, 1280, v1
    v_add_u32 v32, v1, v15
    v_bfe_u32 v2, v14, 3, 1
    v_and_b32 v3, 3, v14
    v_lshl_add_u32 v2, v2, 2, v3
    v_mul_u32_u24 v2, 20, v2
    v_lshrrev_b32 v3, 4, v14
    v_bfe_u32 v4, v14, 2, 1
    v_lshl_add_u32 v3, v3, 1, v4
    v_bfe_u32 v4, v14, 3, 1
    v_mul_u32_u24 v4, 20, v4
    v_lshl_add_u32 v4, v3, 2, v4
    v_and_b32 v1, 3, v14
    v_add_u32 v4, v4, v1
    v_add3_u32 v3, v3, v2, 16
    v_mul_u32_u24 v4, 1280, v4
    v_mul_u32_u24 v3, 1280, v3
    v_add_u32 v37, v4, v15
    v_add_u32 v42, v3, v15
    v_add_u32 v15, 64, v0
    v_mul_u32_u24 v14, 205, v15
    v_lshrrev_b32 v14, 11, v14
    v_mul_u32_u24 v1, 10, v14
    v_sub_u32 v15, v15, v1
    v_lshlrev_b32 v15, 4, v15
    v_and_b32 v1, 7, v14
    v_and_b32 v2, 8, v14
    v_lshl_or_b32 v1, v2, 1, v1
    v_and_b32 v2, 16, v14
    v_lshrrev_b32 v2, 1, v2
    v_or_b32 v1, v1, v2
    v_mul_u32_u24 v1, 1280, v1
    v_add_u32 v33, v1, v15
    v_bfe_u32 v2, v14, 3, 1
    v_and_b32 v3, 3, v14
    v_lshl_add_u32 v2, v2, 2, v3
    v_mul_u32_u24 v2, 20, v2
    v_lshrrev_b32 v3, 4, v14
    v_bfe_u32 v4, v14, 2, 1
    v_lshl_add_u32 v3, v3, 1, v4
    v_bfe_u32 v4, v14, 3, 1
    v_mul_u32_u24 v4, 20, v4
    v_lshl_add_u32 v4, v3, 2, v4
    v_and_b32 v1, 3, v14
    v_add_u32 v4, v4, v1
    v_add3_u32 v3, v3, v2, 16
    v_mul_u32_u24 v4, 1280, v4
    v_mul_u32_u24 v3, 1280, v3
    v_add_u32 v38, v4, v15
    v_add_u32 v43, v3, v15
    v_add_u32 v15, 128, v0
    v_mul_u32_u24 v14, 205, v15
    v_lshrrev_b32 v14, 11, v14
    v_mul_u32_u24 v1, 10, v14
    v_sub_u32 v15, v15, v1
    v_lshlrev_b32 v15, 4, v15
    v_and_b32 v1, 7, v14
    v_and_b32 v2, 8, v14
    v_lshl_or_b32 v1, v2, 1, v1
    v_and_b32 v2, 16, v14
    v_lshrrev_b32 v2, 1, v2
    v_or_b32 v1, v1, v2
    v_mul_u32_u24 v1, 1280, v1
    v_add_u32 v34, v1, v15
    v_bfe_u32 v2, v14, 3, 1
    v_and_b32 v3, 3, v14
    v_lshl_add_u32 v2, v2, 2, v3
    v_mul_u32_u24 v2, 20, v2
    v_lshrrev_b32 v3, 4, v14
    v_bfe_u32 v4, v14, 2, 1
    v_lshl_add_u32 v3, v3, 1, v4
    v_bfe_u32 v4, v14, 3, 1
    v_mul_u32_u24 v4, 20, v4
    v_lshl_add_u32 v4, v3, 2, v4
    v_and_b32 v1, 3, v14
    v_add_u32 v4, v4, v1
    v_add3_u32 v3, v3, v2, 16
    v_mul_u32_u24 v4, 1280, v4
    v_mul_u32_u24 v3, 1280, v3
    v_add_u32 v39, v4, v15
    v_add_u32 v44, v3, v15
    v_add_u32 v15, 192, v0
    v_mul_u32_u24 v14, 205, v15
    v_lshrrev_b32 v14, 11, v14
    v_mul_u32_u24 v1, 10, v14
    v_sub_u32 v15, v15, v1
    v_lshlrev_b32 v15, 4, v15
    v_and_b32 v1, 7, v14
    v_and_b32 v2, 8, v14
    v_lshl_or_b32 v1, v2, 1, v1
    v_and_b32 v2, 16, v14
    v_lshrrev_b32 v2, 1, v2
    v_or_b32 v1, v1, v2
    v_mul_u32_u24 v1, 1280, v1
    v_add_u32 v35, v1, v15
    v_bfe_u32 v2, v14, 3, 1
    v_and_b32 v3, 3, v14
    v_lshl_add_u32 v2, v2, 2, v3
    v_mul_u32_u24 v2, 20, v2
    v_lshrrev_b32 v3, 4, v14
    v_bfe_u32 v4, v14, 2, 1
    v_lshl_add_u32 v3, v3, 1, v4
    v_bfe_u32 v4, v14, 3, 1
    v_mul_u32_u24 v4, 20, v4
    v_lshl_add_u32 v4, v3, 2, v4
    v_and_b32 v1, 3, v14
    v_add_u32 v4, v4, v1
    v_add3_u32 v3, v3, v2, 16
    v_mul_u32_u24 v4, 1280, v4
    v_mul_u32_u24 v3, 1280, v3
    v_add_u32 v40, v4, v15
    v_add_u32 v45, v3, v15
    v_add_u32 v15, 256, v0
    v_mul_u32_u24 v14, 205, v15
    v_lshrrev_b32 v14, 11, v14
    v_mul_u32_u24 v1, 10, v14
    v_sub_u32 v15, v15, v1
    v_lshlrev_b32 v15, 4, v15
    v_and_b32 v1, 7, v14
    v_and_b32 v2, 8, v14
    v_lshl_or_b32 v1, v2, 1, v1
    v_and_b32 v2, 16, v14
    v_lshrrev_b32 v2, 1, v2
    v_or_b32 v1, v1, v2
    v_mul_u32_u24 v1, 1280, v1
    v_add_u32 v36, v1, v15
    v_bfe_u32 v2, v14, 3, 1
    v_and_b32 v3, 3, v14
    v_lshl_add_u32 v2, v2, 2, v3
    v_mul_u32_u24 v2, 20, v2
    v_lshrrev_b32 v3, 4, v14
    v_bfe_u32 v4, v14, 2, 1
    v_lshl_add_u32 v3, v3, 1, v4
    v_bfe_u32 v4, v14, 3, 1
    v_mul_u32_u24 v4, 20, v4
    v_lshl_add_u32 v4, v3, 2, v4
    v_and_b32 v1, 3, v14
    v_add_u32 v4, v4, v1
    v_add3_u32 v3, v3, v2, 16
    v_mul_u32_u24 v4, 1280, v4
    v_mul_u32_u24 v3, 1280, v3
    v_add_u32 v41, v4, v15
    v_add_u32 v46, v3, v15
    s_and_b32 s81, s6, 3
    s_mul_i32 s81, s81, 5120
    s_add_u32 s81, s81, 32768
    v_lshrrev_b32 v14, 1, v11
    v_lshlrev_b32 v14, 4, v14
    v_and_b32 v15, 1, v11
    v_lshl_add_u32 v14, v15, 2, v14
    v_add_u32 v14, v14, v12
    v_mul_u32_u24 v14, 160, v14
    v_add_u32 v14, s81, v14
    v_lshl_add_u32 v47, v13, 4, v14
    v_lshl_add_u32 v31, v13, 3, v14
    v_lshlrev_b32 v48, 4, v0
    v_lshlrev_b32 v51, 4, v10
    v_mul_u32_u24 v49, 1280, v11
    v_add_u32 v49, v49, v51
    v_lshlrev_b32 v1, 2, v11
    v_mov_b32 v2, 0x40000000
    v_cmp_eq_u32 vcc, 0, v10
    s_nop 1
    v_cndmask_b32 v50, v2, v1, vcc
    v_mov_b32 v112, 0
    v_mov_b32 v113, 0
    v_mov_b32 v114, 0
    v_mov_b32 v115, 0
    s_lshl_b32 s76, s3, 2
    s_add_u32 s76, s76, s6
    s_sub_u32 s76, s76, 264
    s_lshl_b32 s82, s76, 10
    s_cmp_lt_u32 s76, 512
    s_cselect_b32 s80, s76, 0x20000
    s_and_b32 s72, s76, 7
    s_lshr_b32 s73, s76, 3
    s_mul_i32 s77, s72, 74
    s_add_u32 s77, s77, s73
    s_mul_i32 s77, s77, 5120
    s_mul_i32 s72, s72, 160
    s_mul_i32 s78, s73, 40960
    s_add_u32 s78, s78, s72
    s_mov_b32 s79, 0
    s_cmp_lt_u32 s73, 54
    s_cbranch_scc1 L_rps_done_925
    s_sub_u32 s73, s73, 54
    s_mul_i32 s74, s73, 52
    s_lshr_b32 s74, s74, 8
    s_mul_i32 s78, s74, 5
    s_sub_u32 s73, s73, s78
    s_mul_i32 s78, s74, 204800
    s_add_u32 s78, s78, s72
    s_mul_i32 s74, s73, 51200
    s_cmp_eq_u32 s73, 4
    s_cselect_b32 s74, 0, s74
    s_cselect_b32 s79, 2, 1
    s_add_u32 s78, s78, s74
L_rps_done_925:
    s_cmp_lt_u32 s76, 592
    s_cselect_b32 s78, s78, 0x40000000
    s_cselect_b32 s77, s77, 0x40000000
    s_waitcnt vmcnt(0)
    s_barrier
    s_add_u32 m0, s9, s7
    s_mov_b32 s72, s10
    buffer_load_dwordx4 v16, s[40:43], s72 offen lds
    s_add_u32 m0, m0, 1024
    s_nop 0
    buffer_load_dwordx4 v17, s[40:43], s72 offen lds
    s_add_u32 m0, m0, 1024
    s_nop 0
    buffer_load_dwordx4 v18, s[40:43], s72 offen lds
    s_add_u32 m0, m0, 1024
    s_nop 0
    buffer_load_dwordx4 v19, s[40:43], s72 offen lds
    s_add_u32 m0, m0, 1024
    s_nop 0
    buffer_load_dwordx4 v20, s[40:43], s72 offen lds
    s_add_u32 m0, m0, 1024
    s_nop 0
    buffer_load_dwordx4 v21, s[40:43], s72 offen lds
    s_add_u32 m0, m0, 1024
    s_nop 0
    buffer_load_dwordx4 v22, s[40:43], s72 offen lds
    s_add_u32 m0, m0, 1024
    s_nop 0
    buffer_load_dwordx4 v23, s[40:43], s72 offen lds
    s_add_u32 m0, s9, s7
    s_add_u32 m0, m0, 8192
    s_add_u32 s72, s10, 81920
    buffer_load_dwordx4 v16, s[40:43], s72 offen lds
    s_add_u32 m0, m0, 1024
    s_nop 0
    buffer_load_dwordx4 v17, s[40:43], s72 offen lds
    s_add_u32 m0, m0, 1024
    s_nop 0
    buffer_load_dwordx4 v18, s[40:43], s72 offen lds
    s_add_u32 m0, m0, 1024
    s_nop 0
    buffer_load_dwordx4 v19, s[40:43], s72 offen lds
    s_add_u32 m0, m0, 1024
    s_nop 0
    buffer_load_dwordx4 v20, s[40:43], s72 offen lds
    s_add_u32 m0, m0, 1024
    s_nop 0
    buffer_load_dwordx4 v21, s[40:43], s72 offen lds
    s_add_u32 m0, m0, 1024
    s_nop 0
    buffer_load_dwordx4 v22, s[40:43], s72 offen lds
    s_add_u32 m0, m0, 1024
    s_nop 0
    buffer_load_dwordx4 v23, s[40:43], s72 offen lds
    s_add_u32 s8, s8, 128
    s_cmp_eq_u32 s8, 1280
    s_cselect_b32 s8, 0, s8
    s_add_u32 s10, s11, s8
    s_add_u32 s9, s9, 32768
    s_cmp_eq_u32 s9, 98304
    s_cselect_b32 s9, 0, s9
L_k1_ldx_loop_gu:
    s_barrier
    s_add_u32 m0, s9, s7
    s_mov_b32 s72, s10
    buffer_load_dwordx4 v16, s[40:43], s72 offen lds
    s_add_u32 m0, m0, 1024
    s_nop 0
    buffer_load_dwordx4 v17, s[40:43], s72 offen lds
    s_add_u32 m0, m0, 1024
    s_nop 0
    buffer_load_dwordx4 v18, s[40:43], s72 offen lds
    s_add_u32 m0, m0, 1024
    s_nop 0
    buffer_load_dwordx4 v19, s[40:43], s72 offen lds
    s_add_u32 m0, m0, 1024
    s_nop 0
    buffer_load_dwordx4 v20, s[40:43], s72 offen lds
    s_add_u32 m0, m0, 1024
    s_nop 0
    buffer_load_dwordx4 v21, s[40:43], s72 offen lds
    s_add_u32 m0, m0, 1024
    s_nop 0
    buffer_load_dwordx4 v22, s[40:43], s72 offen lds
    s_add_u32 m0, m0, 1024
    s_nop 0
    buffer_load_dwordx4 v23, s[40:43], s72 offen lds
    s_waitcnt vmcnt(8)
    s_barrier
    s_add_u32 m0, s9, s7
    s_add_u32 m0, m0, 8192
    s_add_u32 s72, s10, 81920
    buffer_load_dwordx4 v16, s[40:43], s72 offen lds
    s_add_u32 m0, m0, 1024
    s_nop 0
    buffer_load_dwordx4 v17, s[40:43], s72 offen lds
    s_add_u32 m0, m0, 1024
    s_nop 0
    buffer_load_dwordx4 v18, s[40:43], s72 offen lds
    s_add_u32 m0, m0, 1024
    s_nop 0
    buffer_load_dwordx4 v19, s[40:43], s72 offen lds
    s_add_u32 m0, m0, 1024
    s_nop 0
    buffer_load_dwordx4 v20, s[40:43], s72 offen lds
    s_add_u32 m0, m0, 1024
    s_nop 0
    buffer_load_dwordx4 v21, s[40:43], s72 offen lds
    s_add_u32 m0, m0, 1024
    s_nop 0
    buffer_load_dwordx4 v22, s[40:43], s72 offen lds
    s_add_u32 m0, m0, 1024
    s_nop 0
    buffer_load_dwordx4 v23, s[40:43], s72 offen lds
    s_add_u32 s8, s8, 128
    s_cmp_eq_u32 s8, 1280
    s_cselect_b32 s8, 0, s8
    s_add_u32 s10, s11, s8
    s_add_u32 s9, s9, 32768
    s_cmp_eq_u32 s9, 98304
    s_cselect_b32 s9, 0, s9
    s_add_u32 s12, s12, 1
    s_cmp_lt_u32 s12, 8
    s_cbranch_scc1 L_k1_ldx_loop_gu
    s_barrier
    s_branch L_k1_rp
L_k1_ldw_gu:
    s_cmp_eq_u32 s15, 0
    s_cselect_b32 s72, s26, s28
    s_cselect_b32 s73, s27, s29
    s_mov_b32 s44, s72
    s_and_b32 s45, s73, 0xffff
    s_mov_b32 s46, 0x21c000
    s_mov_b32 s47, 0x20000
    s_mul_i32 s72, s99, 192
    v_add_u32 v14, 0, v0
    v_mul_u32_u24 v15, 171, v14
    v_lshrrev_b32 v15, 11, v15
    v_mul_u32_u24 v1, 12, v15
    v_sub_u32 v14, v14, v1
    v_and_b32 v2, 4, v15
    v_lshrrev_b32 v1, 1, v2
    v_xor_b32 v14, v14, v1
    v_and_b32 v1, 0x13, v15
    v_lshl_or_b32 v1, v2, 1, v1
    v_and_b32 v2, 8, v15
    v_lshrrev_b32 v2, 1, v2
    v_or_b32 v1, v1, v2
    v_mul_u32_u24 v1, 3456, v1
    v_add_u32 v1, s72, v1
    v_lshl_add_u32 v16, v14, 4, v1
    v_add_u32 v14, 64, v0
    v_mul_u32_u24 v15, 171, v14
    v_lshrrev_b32 v15, 11, v15
    v_mul_u32_u24 v1, 12, v15
    v_sub_u32 v14, v14, v1
    v_and_b32 v2, 4, v15
    v_lshrrev_b32 v1, 1, v2
    v_xor_b32 v14, v14, v1
    v_and_b32 v1, 0x13, v15
    v_lshl_or_b32 v1, v2, 1, v1
    v_and_b32 v2, 8, v15
    v_lshrrev_b32 v2, 1, v2
    v_or_b32 v1, v1, v2
    v_mul_u32_u24 v1, 3456, v1
    v_add_u32 v1, s72, v1
    v_lshl_add_u32 v17, v14, 4, v1
    v_add_u32 v14, 128, v0
    v_mul_u32_u24 v15, 171, v14
    v_lshrrev_b32 v15, 11, v15
    v_mul_u32_u24 v1, 12, v15
    v_sub_u32 v14, v14, v1
    v_and_b32 v2, 4, v15
    v_lshrrev_b32 v1, 1, v2
    v_xor_b32 v14, v14, v1
    v_and_b32 v1, 0x13, v15
    v_lshl_or_b32 v1, v2, 1, v1
    v_and_b32 v2, 8, v15
    v_lshrrev_b32 v2, 1, v2
    v_or_b32 v1, v1, v2
    v_mul_u32_u24 v1, 3456, v1
    v_add_u32 v1, s72, v1
    v_lshl_add_u32 v18, v14, 4, v1
    v_add_u32 v14, 192, v0
    v_mul_u32_u24 v15, 171, v14
    v_lshrrev_b32 v15, 11, v15
    v_mul_u32_u24 v1, 12, v15
    v_sub_u32 v14, v14, v1
    v_and_b32 v2, 4, v15
    v_lshrrev_b32 v1, 1, v2
    v_xor_b32 v14, v14, v1
    v_and_b32 v1, 0x13, v15
    v_lshl_or_b32 v1, v2, 1, v1
    v_and_b32 v2, 8, v15
    v_lshrrev_b32 v2, 1, v2
    v_or_b32 v1, v1, v2
    v_mul_u32_u24 v1, 3456, v1
    v_add_u32 v1, s72, v1
    v_lshl_add_u32 v19, v14, 4, v1
    v_add_u32 v14, 256, v0
    v_mul_u32_u24 v15, 171, v14
    v_lshrrev_b32 v15, 11, v15
    v_mul_u32_u24 v1, 12, v15
    v_sub_u32 v14, v14, v1
    v_and_b32 v2, 4, v15
    v_lshrrev_b32 v1, 1, v2
    v_xor_b32 v14, v14, v1
    v_and_b32 v1, 0x13, v15
    v_lshl_or_b32 v1, v2, 1, v1
    v_and_b32 v2, 8, v15
    v_lshrrev_b32 v2, 1, v2
    v_or_b32 v1, v1, v2
    v_mul_u32_u24 v1, 3456, v1
    v_add_u32 v1, s72, v1
    v_lshl_add_u32 v20, v14, 4, v1
    v_add_u32 v14, 320, v0
    v_mul_u32_u24 v15, 171, v14
    v_lshrrev_b32 v15, 11, v15
    v_mul_u32_u24 v1, 12, v15
    v_sub_u32 v14, v14, v1
    v_and_b32 v2, 4, v15
    v_lshrrev_b32 v1, 1, v2
    v_xor_b32 v14, v14, v1
    v_and_b32 v1, 0x13, v15
    v_lshl_or_b32 v1, v2, 1, v1
    v_and_b32 v2, 8, v15
    v_lshrrev_b32 v2, 1, v2
    v_or_b32 v1, v1, v2
    v_mul_u32_u24 v1, 3456, v1
    v_add_u32 v1, s72, v1
    v_lshl_add_u32 v21, v14, 4, v1
    s_mul_i32 s11, s14, 221184
    s_mul_i32 s7, s15, 6144
    s_add_u32 s7, s7, 98304
    s_add_u32 m0, s9, s7
    s_nop 0
    buffer_load_dwordx4 v16, s[44:47], s11 offen lds
    s_add_u32 m0, m0, 1024
    s_nop 0
    buffer_load_dwordx4 v17, s[44:47], s11 offen lds
    s_add_u32 m0, m0, 1024
    s_nop 0
    buffer_load_dwordx4 v18, s[44:47], s11 offen lds
    s_add_u32 m0, m0, 1024
    s_nop 0
    buffer_load_dwordx4 v19, s[44:47], s11 offen lds
    s_add_u32 m0, m0, 1024
    s_nop 0
    buffer_load_dwordx4 v20, s[44:47], s11 offen lds
    s_add_u32 m0, m0, 1024
    s_nop 0
    buffer_load_dwordx4 v21, s[44:47], s11 offen lds
    s_add_u32 s11, s11, 110592
    s_cmp_eq_u32 s11, 2211840
    s_cselect_b32 s11, 0, s11
    s_add_u32 s9, s9, 12288
    s_cmp_eq_u32 s9, 61440
    s_cselect_b32 s9, 0, s9
    s_add_u32 m0, s9, s7
    s_nop 0
    buffer_load_dwordx4 v16, s[44:47], s11 offen lds
    s_add_u32 m0, m0, 1024
    s_nop 0
    buffer_load_dwordx4 v17, s[44:47], s11 offen lds
    s_add_u32 m0, m0, 1024
    s_nop 0
    buffer_load_dwordx4 v18, s[44:47], s11 offen lds
    s_add_u32 m0, m0, 1024
    s_nop 0
    buffer_load_dwordx4 v19, s[44:47], s11 offen lds
    s_add_u32 m0, m0, 1024
    s_nop 0
    buffer_load_dwordx4 v20, s[44:47], s11 offen lds
    s_add_u32 m0, m0, 1024
    s_nop 0
    buffer_load_dwordx4 v21, s[44:47], s11 offen lds
    s_add_u32 s11, s11, 110592
    s_cmp_eq_u32 s11, 2211840
    s_cselect_b32 s11, 0, s11
    s_add_u32 s9, s9, 12288
    s_cmp_eq_u32 s9, 61440
    s_cselect_b32 s9, 0, s9
    s_mov_b32 s84, s30
    s_and_b32 s85, s31, 0xffff
    s_mov_b32 s86, 0x21c000
    s_mov_b32 s87, 0x20000
    s_mov_b32 s88, s22
    s_and_b32 s89, s23, 0xffff
    s_mov_b32 s90, 0xc8000
    s_mov_b32 s91, 0x20000
    s_add_u32 s92, s38, 0x1000000
    s_addc_u32 s93, s39, 0
    s_and_b32 s93, s93, 0xffff
    s_mov_b32 s94, 0x2e4000
    s_mov_b32 s95, 0x20000
    s_mov_b32 s56, s32
    s_and_b32 s57, s33, 0xffff
    s_mov_b32 s58, 0x500
    s_mov_b32 s59, 0x20000
    s_add_u32 s60, s38, 0xe30000
    s_addc_u32 s61, s39, 0
    s_and_b32 s61, s61, 0xffff
    s_mov_b32 s62, 0x2000
    s_mov_b32 s63, 0x20000
    s_add_u32 s64, s38, 0xe20000
    s_addc_u32 s65, s39, 0
    s_and_b32 s65, s65, 0xffff
    s_mov_b32 s66, 0x400
    s_mov_b32 s67, 0x20000
    v_add_u32 v15, 0, v0
    v_mul_u32_u24 v14, 205, v15
    v_lshrrev_b32 v14, 11, v14
    v_mul_u32_u24 v1, 10, v14
    v_sub_u32 v15, v15, v1
    v_lshlrev_b32 v15, 4, v15
    v_and_b32 v1, 7, v14
    v_and_b32 v2, 8, v14
    v_lshl_or_b32 v1, v2, 1, v1
    v_and_b32 v2, 16, v14
    v_lshrrev_b32 v2, 1, v2
    v_or_b32 v1, v1, v2
    v_mul_u32_u24 v1, 1280, v1
    v_add_u32 v32, v1, v15
    v_bfe_u32 v2, v14, 3, 1
    v_and_b32 v3, 3, v14
    v_lshl_add_u32 v2, v2, 2, v3
    v_mul_u32_u24 v2, 20, v2
    v_lshrrev_b32 v3, 4, v14
    v_bfe_u32 v4, v14, 2, 1
    v_lshl_add_u32 v3, v3, 1, v4
    v_bfe_u32 v4, v14, 3, 1
    v_mul_u32_u24 v4, 20, v4
    v_lshl_add_u32 v4, v3, 2, v4
    v_and_b32 v1, 3, v14
    v_add_u32 v4, v4, v1
    v_add3_u32 v3, v3, v2, 16
    v_mul_u32_u24 v4, 1280, v4
    v_mul_u32_u24 v3, 1280, v3
    v_add_u32 v37, v4, v15
    v_add_u32 v42, v3, v15
    v_add_u32 v15, 64, v0
    v_mul_u32_u24 v14, 205, v15
    v_lshrrev_b32 v14, 11, v14
    v_mul_u32_u24 v1, 10, v14
    v_sub_u32 v15, v15, v1
    v_lshlrev_b32 v15, 4, v15
    v_and_b32 v1, 7, v14
    v_and_b32 v2, 8, v14
    v_lshl_or_b32 v1, v2, 1, v1
    v_and_b32 v2, 16, v14
    v_lshrrev_b32 v2, 1, v2
    v_or_b32 v1, v1, v2
    v_mul_u32_u24 v1, 1280, v1
    v_add_u32 v33, v1, v15
    v_bfe_u32 v2, v14, 3, 1
    v_and_b32 v3, 3, v14
    v_lshl_add_u32 v2, v2, 2, v3
    v_mul_u32_u24 v2, 20, v2
    v_lshrrev_b32 v3, 4, v14
    v_bfe_u32 v4, v14, 2, 1
    v_lshl_add_u32 v3, v3, 1, v4
    v_bfe_u32 v4, v14, 3, 1
    v_mul_u32_u24 v4, 20, v4
    v_lshl_add_u32 v4, v3, 2, v4
    v_and_b32 v1, 3, v14
    v_add_u32 v4, v4, v1
    v_add3_u32 v3, v3, v2, 16
    v_mul_u32_u24 v4, 1280, v4
    v_mul_u32_u24 v3, 1280, v3
    v_add_u32 v38, v4, v15
    v_add_u32 v43, v3, v15
    v_add_u32 v15, 128, v0
    v_mul_u32_u24 v14, 205, v15
    v_lshrrev_b32 v14, 11, v14
    v_mul_u32_u24 v1, 10, v14
    v_sub_u32 v15, v15, v1
    v_lshlrev_b32 v15, 4, v15
    v_and_b32 v1, 7, v14
    v_and_b32 v2, 8, v14
    v_lshl_or_b32 v1, v2, 1, v1
    v_and_b32 v2, 16, v14
    v_lshrrev_b32 v2, 1, v2
    v_or_b32 v1, v1, v2
    v_mul_u32_u24 v1, 1280, v1
    v_add_u32 v34, v1, v15
    v_bfe_u32 v2, v14, 3, 1
    v_and_b32 v3, 3, v14
    v_lshl_add_u32 v2, v2, 2, v3
    v_mul_u32_u24 v2, 20, v2
    v_lshrrev_b32 v3, 4, v14
    v_bfe_u32 v4, v14, 2, 1
    v_lshl_add_u32 v3, v3, 1, v4
    v_bfe_u32 v4, v14, 3, 1
    v_mul_u32_u24 v4, 20, v4
    v_lshl_add_u32 v4, v3, 2, v4
    v_and_b32 v1, 3, v14
    v_add_u32 v4, v4, v1
    v_add3_u32 v3, v3, v2, 16
    v_mul_u32_u24 v4, 1280, v4
    v_mul_u32_u24 v3, 1280, v3
    v_add_u32 v39, v4, v15
    v_add_u32 v44, v3, v15
    v_add_u32 v15, 192, v0
    v_mul_u32_u24 v14, 205, v15
    v_lshrrev_b32 v14, 11, v14
    v_mul_u32_u24 v1, 10, v14
    v_sub_u32 v15, v15, v1
    v_lshlrev_b32 v15, 4, v15
    v_and_b32 v1, 7, v14
    v_and_b32 v2, 8, v14
    v_lshl_or_b32 v1, v2, 1, v1
    v_and_b32 v2, 16, v14
    v_lshrrev_b32 v2, 1, v2
    v_or_b32 v1, v1, v2
    v_mul_u32_u24 v1, 1280, v1
    v_add_u32 v35, v1, v15
    v_bfe_u32 v2, v14, 3, 1
    v_and_b32 v3, 3, v14
    v_lshl_add_u32 v2, v2, 2, v3
    v_mul_u32_u24 v2, 20, v2
    v_lshrrev_b32 v3, 4, v14
    v_bfe_u32 v4, v14, 2, 1
    v_lshl_add_u32 v3, v3, 1, v4
    v_bfe_u32 v4, v14, 3, 1
    v_mul_u32_u24 v4, 20, v4
    v_lshl_add_u32 v4, v3, 2, v4
    v_and_b32 v1, 3, v14
    v_add_u32 v4, v4, v1
    v_add3_u32 v3, v3, v2, 16
    v_mul_u32_u24 v4, 1280, v4
    v_mul_u32_u24 v3, 1280, v3
    v_add_u32 v40, v4, v15
    v_add_u32 v45, v3, v15
    v_add_u32 v15, 256, v0
    v_mul_u32_u24 v14, 205, v15
    v_lshrrev_b32 v14, 11, v14
    v_mul_u32_u24 v1, 10, v14
    v_sub_u32 v15, v15, v1
    v_lshlrev_b32 v15, 4, v15
    v_and_b32 v1, 7, v14
    v_and_b32 v2, 8, v14
    v_lshl_or_b32 v1, v2, 1, v1
    v_and_b32 v2, 16, v14
    v_lshrrev_b32 v2, 1, v2
    v_or_b32 v1, v1, v2
    v_mul_u32_u24 v1, 1280, v1
    v_add_u32 v36, v1, v15
    v_bfe_u32 v2, v14, 3, 1
    v_and_b32 v3, 3, v14
    v_lshl_add_u32 v2, v2, 2, v3
    v_mul_u32_u24 v2, 20, v2
    v_lshrrev_b32 v3, 4, v14
    v_bfe_u32 v4, v14, 2, 1
    v_lshl_add_u32 v3, v3, 1, v4
    v_bfe_u32 v4, v14, 3, 1
    v_mul_u32_u24 v4, 20, v4
    v_lshl_add_u32 v4, v3, 2, v4
    v_and_b32 v1, 3, v14
    v_add_u32 v4, v4, v1
    v_add3_u32 v3, v3, v2, 16
    v_mul_u32_u24 v4, 1280, v4
    v_mul_u32_u24 v3, 1280, v3
    v_add_u32 v41, v4, v15
    v_add_u32 v46, v3, v15
    s_and_b32 s81, s6, 3
    s_mul_i32 s81, s81, 5120
    s_add_u32 s81, s81, 32768
    v_lshrrev_b32 v14, 1, v11
    v_lshlrev_b32 v14, 4, v14
    v_and_b32 v15, 1, v11
    v_lshl_add_u32 v14, v15, 2, v14
    v_add_u32 v14, v14, v12
    v_mul_u32_u24 v14, 160, v14
    v_add_u32 v14, s81, v14
    v_lshl_add_u32 v47, v13, 4, v14
    v_lshl_add_u32 v31, v13, 3, v14
    v_lshlrev_b32 v48, 4, v0
    v_lshlrev_b32 v51, 4, v10
    v_mul_u32_u24 v49, 1280, v11
    v_add_u32 v49, v49, v51
    v_lshlrev_b32 v1, 2, v11
    v_mov_b32 v2, 0x40000000
    v_cmp_eq_u32 vcc, 0, v10
    s_nop 1
    v_cndmask_b32 v50, v2, v1, vcc
    v_mov_b32 v112, 0
    v_mov_b32 v113, 0
    v_mov_b32 v114, 0
    v_mov_b32 v115, 0
    s_lshl_b32 s76, s3, 2
    s_add_u32 s76, s76, s6
    s_sub_u32 s76, s76, 264
    s_lshl_b32 s82, s76, 10
    s_cmp_lt_u32 s76, 512
    s_cselect_b32 s80, s76, 0x20000
    s_and_b32 s72, s76, 7
    s_lshr_b32 s73, s76, 3
    s_mul_i32 s77, s72, 74
    s_add_u32 s77, s77, s73
    s_mul_i32 s77, s77, 5120
    s_mul_i32 s72, s72, 160
    s_mul_i32 s78, s73, 40960
    s_add_u32 s78, s78, s72
    s_mov_b32 s79, 0
    s_cmp_lt_u32 s73, 54
    s_cbranch_scc1 L_rps_done_1400
    s_sub_u32 s73, s73, 54
    s_mul_i32 s74, s73, 52
    s_lshr_b32 s74, s74, 8
    s_mul_i32 s78, s74, 5
    s_sub_u32 s73, s73, s78
    s_mul_i32 s78, s74, 204800
    s_add_u32 s78, s78, s72
    s_mul_i32 s74, s73, 51200
    s_cmp_eq_u32 s73, 4
    s_cselect_b32 s74, 0, s74
    s_cselect_b32 s79, 2, 1
    s_add_u32 s78, s78, s74
L_rps_done_1400:
    s_cmp_lt_u32 s76, 592
    s_cselect_b32 s78, s78, 0x40000000
    s_cselect_b32 s77, s77, 0x40000000
    s_waitcnt vmcnt(6)
    s_barrier
    s_add_u32 m0, s9, s7
    s_nop 0
    buffer_load_dwordx4 v16, s[44:47], s11 offen lds
    s_add_u32 m0, m0, 1024
    s_nop 0
    buffer_load_dwordx4 v17, s[44:47], s11 offen lds
    s_add_u32 m0, m0, 1024
    s_nop 0
    buffer_load_dwordx4 v18, s[44:47], s11 offen lds
    s_add_u32 m0, m0, 1024
    s_nop 0
    buffer_load_dwordx4 v19, s[44:47], s11 offen lds
    s_add_u32 m0, m0, 1024
    s_nop 0
    buffer_load_dwordx4 v20, s[44:47], s11 offen lds
    s_add_u32 m0, m0, 1024
    s_nop 0
    buffer_load_dwordx4 v21, s[44:47], s11 offen lds
    s_add_u32 s11, s11, 110592
    s_cmp_eq_u32 s11, 2211840
    s_cselect_b32 s11, 0, s11
    s_add_u32 s9, s9, 12288
    s_cmp_eq_u32 s9, 61440
    s_cselect_b32 s9, 0, s9
    s_add_u32 m0, s9, s7
    s_nop 0
    buffer_load_dwordx4 v16, s[44:47], s11 offen lds
    s_add_u32 m0, m0, 1024
    s_nop 0
    buffer_load_dwordx4 v17, s[44:47], s11 offen lds
    s_add_u32 m0, m0, 1024
    s_nop 0
    buffer_load_dwordx4 v18, s[44:47], s11 offen lds
    s_add_u32 m0, m0, 1024
    s_nop 0
    buffer_load_dwordx4 v19, s[44:47], s11 offen lds
    s_add_u32 m0, m0, 1024
    s_nop 0
    buffer_load_dwordx4 v20, s[44:47], s11 offen lds
    s_add_u32 m0, m0, 1024
    s_nop 0
    buffer_load_dwordx4 v21, s[44:47], s11 offen lds
    s_add_u32 s11, s11, 110592
    s_cmp_eq_u32 s11, 2211840
    s_cselect_b32 s11, 0, s11
    s_add_u32 s9, s9, 12288
    s_cmp_eq_u32 s9, 61440
    s_cselect_b32 s9, 0, s9
L_k1_ldw_loop_gu:
    s_waitcnt vmcnt(12)
    s_barrier
    s_add_u32 m0, s9, s7
    s_nop 0
    buffer_load_dwordx4 v16, s[44:47], s11 offen lds
    s_add_u32 m0, m0, 1024
    s_nop 0
    buffer_load_dwordx4 v17, s[44:47], s11 offen lds
    s_add_u32 m0, m0, 1024
    s_nop 0
    buffer_load_dwordx4 v18, s[44:47], s11 offen lds
    s_add_u32 m0, m0, 1024
    s_nop 0
    buffer_load_dwordx4 v19, s[44:47], s11 offen lds
    s_add_u32 m0, m0, 1024
    s_nop 0
    buffer_load_dwordx4 v20, s[44:47], s11 offen lds
    s_add_u32 m0, m0, 1024
    s_nop 0
    buffer_load_dwordx4 v21, s[44:47], s11 offen lds
    s_add_u32 s11, s11, 110592
    s_cmp_eq_u32 s11, 2211840
    s_cselect_b32 s11, 0, s11
    s_add_u32 s9, s9, 12288
    s_cmp_eq_u32 s9, 61440
    s_cselect_b32 s9, 0, s9
    s_add_u32 s12, s12, 1
    s_cmp_lt_u32 s12, 16
    s_cbranch_scc1 L_k1_ldw_loop_gu
    s_waitcnt vmcnt(12)
    s_barrier
    s_branch L_k1_rp
L_k1_q:
    s_cmp_ge_u32 s6, 8
    s_cbranch_scc1 L_k1_ld_q
    v_lshrrev_b32 v14, 1, v11
    v_lshlrev_b32 v14, 4, v14
    v_and_b32 v96, 1, v11
    v_lshl_add_u32 v14, v96, 2, v14
    v_add_u32 v14, v14, v12
    v_mul_u32_u24 v14, 160, v14
    v_mul_u32_u24 v15, 40, v13
    s_mul_i32 s72, s7, 5120
    s_add_u32 s72, s72, 98304
    v_add3_u32 v5, v14, v15, s72
    v_lshrrev_b32 v14, 1, v10
    v_xor_b32 v15, v14, v11
    v_lshlrev_b32 v14, 7, v10
    v_lshl_add_u32 v14, v15, 4, v14
    s_mul_i32 s72, s15, 6144
    v_add_u32 v1, s72, v14
    v_xor_b32 v2, 64, v1
    v_mov_b32 v3, v1
    v_mov_b32 v8, v5
    s_mov_b32 s8, 10240
    s_mov_b32 s13, 0
    s_mov_b32 s12, 0
    v_mov_b32 v16, 0
    v_mov_b32 v17, 0
    v_mov_b32 v18, 0
    v_mov_b32 v19, 0
    v_mov_b32 v20, 0
    v_mov_b32 v21, 0
    v_mov_b32 v22, 0
    v_mov_b32 v23, 0
    v_mov_b32 v24, 0
    v_mov_b32 v25, 0
    v_mov_b32 v26, 0
    v_mov_b32 v27, 0
    v_mov_b32 v28, 0
    v_mov_b32 v29, 0
    v_mov_b32 v30, 0
    v_mov_b32 v31, 0
    v_mov_b32 v32, 0
    v_mov_b32 v33, 0
    v_mov_b32 v34, 0
    v_mov_b32 v35, 0
    v_mov_b32 v36, 0
    v_mov_b32 v37, 0
    v_mov_b32 v38, 0
    v_mov_b32 v39, 0
    v_mov_b32 v40, 0
    v_mov_b32 v41, 0
    v_mov_b32 v42, 0
    v_mov_b32 v43, 0
    v_mov_b32 v44, 0
    v_mov_b32 v45, 0
    v_mov_b32 v46, 0
    v_mov_b32 v47, 0
    v_mov_b32 v48, 0
    v_mov_b32 v49, 0
    v_mov_b32 v50, 0
    v_mov_b32 v51, 0
    v_mov_b32 v52, 0
    v_mov_b32 v53, 0
    v_mov_b32 v54, 0
    v_mov_b32 v55, 0
    v_mov_b32 v56, 0
    v_mov_b32 v57, 0
    v_mov_b32 v58, 0
    v_mov_b32 v59, 0
    v_mov_b32 v60, 0
    v_mov_b32 v61, 0
    v_mov_b32 v62, 0
    v_mov_b32 v63, 0
    v_mov_b32 v64, 0
    v_mov_b32 v65, 0
    v_mov_b32 v66, 0
    v_mov_b32 v67, 0
    v_mov_b32 v68, 0
    v_mov_b32 v69, 0
    v_mov_b32 v70, 0
    v_mov_b32 v71, 0
    v_mov_b32 v72, 0
    v_mov_b32 v73, 0
    v_mov_b32 v74, 0
    v_mov_b32 v75, 0
    s_add_u32 s48, s38, 0x700000
    s_addc_u32 s49, s39, 0
    s_and_b32 s49, s49, 0xffff
    s_mov_b32 s50, 0x500000
    s_mov_b32 s51, 0x20000
    s_barrier
    ds_read_b128 v[96:99], v3 offset:0
    ds_read_b128 v[100:103], v3 offset:2048
    ds_read_b128 v[104:107], v3 offset:4096
    ds_read_b64_tr_b16 v[128:129], v8 offset:0
    ds_read_b64_tr_b16 v[130:131], v8 offset:1280
    ds_read_b64_tr_b16 v[132:133], v8 offset:8
    ds_read_b64_tr_b16 v[134:135], v8 offset:1288
    ds_read_b64_tr_b16 v[136:137], v8 offset:16
    ds_read_b64_tr_b16 v[138:139], v8 offset:1296
    ds_read_b64_tr_b16 v[140:141], v8 offset:24
    ds_read_b64_tr_b16 v[142:143], v8 offset:1304
    s_waitcnt lgkmcnt(0)
    s_nop 7
    s_nop 3
L_k1_loop_q:
    s_waitcnt lgkmcnt(6)
    v_mfma_f32_16x16x32_bf16 v[16:19], v[128:131], v[96:99], v[16:19]
    ds_read_b64_tr_b16 v[144:145], v8 offset:32
    ds_read_b64_tr_b16 v[146:147], v8 offset:1312
    v_mfma_f32_16x16x32_bf16 v[36:39], v[128:131], v[100:103], v[36:39]
    s_barrier
    v_add_u32 v4, s13, v2
    v_add_u32 v9, s8, v5
    v_mfma_f32_16x16x32_bf16 v[56:59], v[128:131], v[104:107], v[56:59]
    s_add_u32 s8, s8, 10240
    s_cmp_eq_u32 s8, 51200
    s_cselect_b32 s8, 0, s8
    s_waitcnt lgkmcnt(6)
    v_mfma_f32_16x16x32_bf16 v[20:23], v[132:135], v[96:99], v[20:23]
    ds_read_b128 v[108:111], v4 offset:0
    ds_read_b128 v[112:115], v4 offset:2048
    v_mfma_f32_16x16x32_bf16 v[40:43], v[132:135], v[100:103], v[40:43]
    ds_read_b64_tr_b16 v[128:129], v9 offset:0
    v_mfma_f32_16x16x32_bf16 v[60:63], v[132:135], v[104:107], v[60:63]
    ds_read_b64_tr_b16 v[130:131], v9 offset:1280
    s_waitcnt lgkmcnt(8)
    v_mfma_f32_16x16x32_bf16 v[24:27], v[136:139], v[96:99], v[24:27]
    ds_read_b128 v[116:119], v4 offset:4096
    v_mfma_f32_16x16x32_bf16 v[44:47], v[136:139], v[100:103], v[44:47]
    ds_read_b64_tr_b16 v[132:133], v9 offset:8
    v_mfma_f32_16x16x32_bf16 v[64:67], v[136:139], v[104:107], v[64:67]
    ds_read_b64_tr_b16 v[134:135], v9 offset:1288
    s_waitcnt lgkmcnt(9)
    v_mfma_f32_16x16x32_bf16 v[28:31], v[140:143], v[96:99], v[28:31]
    ds_read_b64_tr_b16 v[136:137], v9 offset:16
    v_mfma_f32_16x16x32_bf16 v[48:51], v[140:143], v[100:103], v[48:51]
    ds_read_b64_tr_b16 v[138:139], v9 offset:1296
    v_mfma_f32_16x16x32_bf16 v[68:71], v[140:143], v[104:107], v[68:71]
    s_waitcnt lgkmcnt(9)
    v_mfma_f32_16x16x32_bf16 v[32:35], v[144:147], v[96:99], v[32:35]
    ds_read_b64_tr_b16 v[140:141], v9 offset:24
    v_mfma_f32_16x16x32_bf16 v[52:55], v[144:147], v[100:103], v[52:55]
    ds_read_b64_tr_b16 v[142:143], v9 offset:1304
    v_mfma_f32_16x16x32_bf16 v[72:75], v[144:147], v[104:107], v[72:75]
    s_waitcnt lgkmcnt(6)
    v_mfma_f32_16x16x32_bf16 v[16:19], v[128:131], v[108:111], v[16:19]
    ds_read_b64_tr_b16 v[144:145], v9 offset:32
    ds_read_b64_tr_b16 v[146:147], v9 offset:1312
    v_mfma_f32_16x16x32_bf16 v[36:39], v[128:131], v[112:115], v[36:39]
    s_add_u32 s13, s13, 32768
    s_cmp_eq_u32 s13, 98304
    s_cselect_b32 s13, 0, s13
    s_barrier
    v_add_u32 v3, s13, v1
    v_add_u32 v8, s8, v5
    v_mfma_f32_16x16x32_bf16 v[56:59], v[128:131], v[116:119], v[56:59]
    s_add_u32 s8, s8, 10240
    s_cmp_eq_u32 s8, 51200
    s_cselect_b32 s8, 0, s8
    s_waitcnt lgkmcnt(6)
    v_mfma_f32_16x16x32_bf16 v[20:23], v[132:135], v[108:111], v[20:23]
    ds_read_b128 v[96:99], v3 offset:0
    ds_read_b128 v[100:103], v3 offset:2048
    v_mfma_f32_16x16x32_bf16 v[40:43], v[132:135], v[112:115], v[40:43]
    ds_read_b64_tr_b16 v[128:129], v8 offset:0
    v_mfma_f32_16x16x32_bf16 v[60:63], v[132:135], v[116:119], v[60:63]
    ds_read_b64_tr_b16 v[130:131], v8 offset:1280
    s_waitcnt lgkmcnt(8)
    v_mfma_f32_16x16x32_bf16 v[24:27], v[136:139], v[108:111], v[24:27]
    ds_read_b128 v[104:107], v3 offset:4096
    v_mfma_f32_16x16x32_bf16 v[44:47], v[136:139], v[112:115], v[44:47]
    ds_read_b64_tr_b16 v[132:133], v8 offset:8
    v_mfma_f32_16x16x32_bf16 v[64:67], v[136:139], v[116:119], v[64:67]
    ds_read_b64_tr_b16 v[134:135], v8 offset:1288
    s_waitcnt lgkmcnt(9)
    v_mfma_f32_16x16x32_bf16 v[28:31], v[140:143], v[108:111], v[28:31]
    ds_read_b64_tr_b16 v[136:137], v8 offset:16
    v_mfma_f32_16x16x32_bf16 v[48:51], v[140:143], v[112:115], v[48:51]
    ds_read_b64_tr_b16 v[138:139], v8 offset:1296
    v_mfma_f32_16x16x32_bf16 v[68:71], v[140:143], v[116:119], v[68:71]
    s_waitcnt lgkmcnt(9)
    v_mfma_f32_16x16x32_bf16 v[32:35], v[144:147], v[108:111], v[32:35]
    ds_read_b64_tr_b16 v[140:141], v8 offset:24
    v_mfma_f32_16x16x32_bf16 v[52:55], v[144:147], v[112:115], v[52:55]
    ds_read_b64_tr_b16 v[142:143], v8 offset:1304
    v_mfma_f32_16x16x32_bf16 v[72:75], v[144:147], v[116:119], v[72:75]
    s_add_u32 s12, s12, 1
    s_cmp_lt_u32 s12, 10
    s_cbranch_scc1 L_k1_loop_q
    s_nop 7
    s_nop 3
    s_waitcnt vmcnt(0) lgkmcnt(0)
    s_mul_i32 s72, s5, 12
    s_mul_i32 s73, s15, 3
    s_add_u32 s72, s72, s73
    s_mov_b32 s98, 0x3fb8aa3b
    v_mul_u32_u24 v14, 800, v11
    v_mul_u32_u24 v15, 40, v12
    s_mul_i32 s73, s7, 3200
    s_add_u32 s73, s73, 151552
    v_add3_u32 v14, v14, v15, s73
    v_mov_b32 v15, 157952
    v_cmp_eq_u32 vcc, v13, v11
    s_nop 1
    v_cndmask_b32 v14, v15, v14, vcc
    ds_read_b64_tr_b16 v[96:97], v14 offset:0
    ds_read_b64_tr_b16 v[98:99], v14 offset:160
    ds_read_b64_tr_b16 v[100:101], v14 offset:8
    ds_read_b64_tr_b16 v[102:103], v14 offset:168
    ds_read_b64_tr_b16 v[104:105], v14 offset:16
    ds_read_b64_tr_b16 v[106:107], v14 offset:176
    ds_read_b64_tr_b16 v[108:109], v14 offset:24
    ds_read_b64_tr_b16 v[110:111], v14 offset:184
    ds_read_b64_tr_b16 v[112:113], v14 offset:32
    ds_read_b64_tr_b16 v[114:115], v14 offset:192
    v_mul_u32_u24 v162, 1280, v11
    v_lshl_add_u32 v162, v10, 4, v162
    s_lshl_b32 s72, s72, 5
    s_lshl_b32 s73, s99, 3
    s_add_u32 s72, s72, s73
    s_lshl_b32 s73, s7, 2
    s_add_u32 s72, s72, s73
    s_mul_i32 s72, s72, 1280
    v_cvt_pk_bf16_f32 v16, v16, v17
    v_cvt_pk_bf16_f32 v17, v18, v19
    v_cvt_pk_bf16_f32 v18, v20, v21
    v_cvt_pk_bf16_f32 v19, v22, v23
    v_cvt_pk_bf16_f32 v20, v24, v25
    v_cvt_pk_bf16_f32 v21, v26, v27
    v_cvt_pk_bf16_f32 v22, v28, v29
    v_cvt_pk_bf16_f32 v23, v30, v31
    v_cvt_pk_bf16_f32 v24, v32, v33
    v_cvt_pk_bf16_f32 v25, v34, v35
    v_cvt_pk_bf16_f32 v28, v36, v37
    v_cvt_pk_bf16_f32 v29, v38, v39
    v_cvt_pk_bf16_f32 v30, v40, v41
    v_cvt_pk_bf16_f32 v31, v42, v43
    v_cvt_pk_bf16_f32 v32, v44, v45
    v_cvt_pk_bf16_f32 v33, v46, v47
    v_cvt_pk_bf16_f32 v34, v48, v49
    v_cvt_pk_bf16_f32 v35, v50, v51
    v_cvt_pk_bf16_f32 v36, v52, v53
    v_cvt_pk_bf16_f32 v37, v54, v55
    v_cvt_pk_bf16_f32 v40, v56, v57
    v_cvt_pk_bf16_f32 v41, v58, v59
    v_cvt_pk_bf16_f32 v42, v60, v61
    v_cvt_pk_bf16_f32 v43, v62, v63
    v_cvt_pk_bf16_f32 v44, v64, v65
    v_cvt_pk_bf16_f32 v45, v66, v67
    v_cvt_pk_bf16_f32 v46, v68, v69
    v_cvt_pk_bf16_f32 v47, v70, v71
    v_cvt_pk_bf16_f32 v48, v72, v73
    v_cvt_pk_bf16_f32 v49, v74, v75
    v_mov_b32 v26, 0
    v_mov_b32 v27, 0
    v_mov_b32 v38, 0
    v_mov_b32 v39, 0
    v_mov_b32 v50, 0
    v_mov_b32 v51, 0
    s_waitcnt lgkmcnt(8)
    v_mfma_f32_16x16x32_bf16 v[116:119], v[96:99], v[16:19], 0
    ds_read_b64_tr_b16 v[96:97], v14 offset:320
    ds_read_b64_tr_b16 v[98:99], v14 offset:480
    s_waitcnt lgkmcnt(8)
    v_mfma_f32_16x16x32_bf16 v[120:123], v[100:103], v[16:19], 0
    ds_read_b64_tr_b16 v[100:101], v14 offset:328
    ds_read_b64_tr_b16 v[102:103], v14 offset:488
    s_waitcnt lgkmcnt(8)
    v_mfma_f32_16x16x32_bf16 v[124:127], v[104:107], v[16:19], 0
    ds_read_b64_tr_b16 v[104:105], v14 offset:336
    ds_read_b64_tr_b16 v[106:107], v14 offset:496
    s_waitcnt lgkmcnt(8)
    v_mfma_f32_16x16x32_bf16 v[128:131], v[108:111], v[16:19], 0
    ds_read_b64_tr_b16 v[108:109], v14 offset:344
    ds_read_b64_tr_b16 v[110:111], v14 offset:504
    s_waitcnt lgkmcnt(8)
    v_mfma_f32_16x16x32_bf16 v[132:135], v[112:115], v[16:19], 0
    ds_read_b64_tr_b16 v[112:113], v14 offset:352
    ds_read_b64_tr_b16 v[114:115], v14 offset:512
    s_waitcnt lgkmcnt(8)
    v_mfma_f32_16x16x32_bf16 v[116:119], v[96:99], v[20:23], v[116:119]
    ds_read_b64_tr_b16 v[96:97], v14 offset:640
    s_waitcnt lgkmcnt(7)
    v_mfma_f32_16x16x32_bf16 v[120:123], v[100:103], v[20:23], v[120:123]
    ds_read_b64_tr_b16 v[100:101], v14 offset:648
    s_waitcnt lgkmcnt(6)
    v_mfma_f32_16x16x32_bf16 v[124:127], v[104:107], v[20:23], v[124:127]
    ds_read_b64_tr_b16 v[104:105], v14 offset:656
    s_waitcnt lgkmcnt(5)
    v_mfma_f32_16x16x32_bf16 v[128:131], v[108:111], v[20:23], v[128:131]
    ds_read_b64_tr_b16 v[108:109], v14 offset:664
    s_waitcnt lgkmcnt(4)
    v_mfma_f32_16x16x32_bf16 v[132:135], v[112:115], v[20:23], v[132:135]
    ds_read_b64_tr_b16 v[112:113], v14 offset:672
    s_waitcnt lgkmcnt(4)
    v_mfma_f32_16x16x32_bf16 v[116:119], v[96:99], v[24:27], v[116:119]
    ds_read_b64_tr_b16 v[96:97], v14 offset:0
    ds_read_b64_tr_b16 v[98:99], v14 offset:160
    s_waitcnt lgkmcnt(5)
    v_mfma_f32_16x16x32_bf16 v[120:123], v[100:103], v[24:27], v[120:123]
    ds_read_b64_tr_b16 v[100:101], v14 offset:8
    ds_read_b64_tr_b16 v[102:103], v14 offset:168
    s_waitcnt lgkmcnt(6)
    v_mfma_f32_16x16x32_bf16 v[124:127], v[104:107], v[24:27], v[124:127]
    ds_read_b64_tr_b16 v[104:105], v14 offset:16
    ds_read_b64_tr_b16 v[106:107], v14 offset:176
    s_waitcnt lgkmcnt(7)
    v_mfma_f32_16x16x32_bf16 v[128:131], v[108:111], v[24:27], v[128:131]
    ds_read_b64_tr_b16 v[108:109], v14 offset:24
    ds_read_b64_tr_b16 v[110:111], v14 offset:184
    s_waitcnt lgkmcnt(8)
    v_mfma_f32_16x16x32_bf16 v[132:135], v[112:115], v[24:27], v[132:135]
    ds_read_b64_tr_b16 v[112:113], v14 offset:32
    ds_read_b64_tr_b16 v[114:115], v14 offset:192
    v_max3_f32 v156, v116, v117, v118
    v_min3_f32 v158, v116, v117, v118
    v_max3_f32 v157, v119, v120, v121
    v_min3_f32 v159, v119, v120, v121
    v_max3_f32 v156, v156, v122, v123
    s_waitcnt lgkmcnt(8)
    v_mfma_f32_16x16x32_bf16 v[64:67], v[96:99], v[28:31], 0
    ds_read_b64_tr_b16 v[96:97], v14 offset:320
    ds_read_b64_tr_b16 v[98:99], v14 offset:480
    v_min3_f32 v158, v158, v122, v123
    v_max3_f32 v157, v157, v124, v125
    v_min3_f32 v159, v159, v124, v125
    v_max3_f32 v156, v156, v126, v127
    v_min3_f32 v158, v158, v126, v127
    v_max3_f32 v157, v157, v128, v129
    v_min3_f32 v159, v159, v128, v129
    s_waitcnt lgkmcnt(8)
    v_mfma_f32_16x16x32_bf16 v[68:71], v[100:103], v[28:31], 0
    ds_read_b64_tr_b16 v[100:101], v14 offset:328
    ds_read_b64_tr_b16 v[102:103], v14 offset:488
    v_max3_f32 v156, v156, v130, v131
    v_min3_f32 v158, v158, v130, v131
    v_max3_f32 v157, v157, v132, v133
    v_min3_f32 v159, v159, v132, v133
    v_max3_f32 v156, v156, v134, v135
    v_min3_f32 v158, v158, v134, v135
    v_max_f32 v156, v156, v157
    s_waitcnt lgkmcnt(8)
    v_mfma_f32_16x16x32_bf16 v[72:75], v[104:107], v[28:31], 0
    ds_read_b64_tr_b16 v[104:105], v14 offset:336
    ds_read_b64_tr_b16 v[106:107], v14 offset:496
    v_min_f32 v158, v158, v159
    v_mul_f32 v156, s98, v156
    v_mul_f32 v158, s98, v158
    v_pk_fma_f32 v[136:137], v[116:117], s[98:99], v[156:157] op_sel_hi:[1,0,0] neg_lo:[0,0,1] neg_hi:[0,0,1]
    v_pk_fma_f32 v[138:139], v[118:119], s[98:99], v[156:157] op_sel_hi:[1,0,0] neg_lo:[0,0,1] neg_hi:[0,0,1]
    v_pk_fma_f32 v[140:141], v[120:121], s[98:99], v[156:157] op_sel_hi:[1,0,0] neg_lo:[0,0,1] neg_hi:[0,0,1]
    v_pk_fma_f32 v[142:143], v[122:123], s[98:99], v[156:157] op_sel_hi:[1,0,0] neg_lo:[0,0,1] neg_hi:[0,0,1]
    s_waitcnt lgkmcnt(8)
    v_mfma_f32_16x16x32_bf16 v[76:79], v[108:111], v[28:31], 0
    ds_read_b64_tr_b16 v[108:109], v14 offset:344
    ds_read_b64_tr_b16 v[110:111], v14 offset:504
    v_pk_fma_f32 v[144:145], v[124:125], s[98:99], v[156:157] op_sel_hi:[1,0,0] neg_lo:[0,0,1] neg_hi:[0,0,1]
    v_pk_fma_f32 v[146:147], v[126:127], s[98:99], v[156:157] op_sel_hi:[1,0,0] neg_lo:[0,0,1] neg_hi:[0,0,1]
    v_pk_fma_f32 v[148:149], v[128:129], s[98:99], v[156:157] op_sel_hi:[1,0,0] neg_lo:[0,0,1] neg_hi:[0,0,1]
    v_pk_fma_f32 v[150:151], v[130:131], s[98:99], v[156:157] op_sel_hi:[1,0,0] neg_lo:[0,0,1] neg_hi:[0,0,1]
    v_pk_fma_f32 v[152:153], v[132:133], s[98:99], v[156:157] op_sel_hi:[1,0,0] neg_lo:[0,0,1] neg_hi:[0,0,1]
    v_pk_fma_f32 v[154:155], v[134:135], s[98:99], v[156:157] op_sel_hi:[1,0,0] neg_lo:[0,0,1] neg_hi:[0,0,1]
    v_exp_f32 v136, v136
    s_waitcnt lgkmcnt(8)
    v_mfma_f32_16x16x32_bf16 v[80:83], v[112:115], v[28:31], 0
    ds_read_b64_tr_b16 v[112:113], v14 offset:352
    ds_read_b64_tr_b16 v[114:115], v14 offset:512
    v_exp_f32 v137, v137
    v_exp_f32 v138, v138
    v_exp_f32 v139, v139
    v_exp_f32 v140, v140
    v_pk_add_f32 v[160:161], v[136:137], v[138:139]
    v_exp_f32 v141, v141
    v_exp_f32 v142, v142
    s_waitcnt lgkmcnt(8)
    v_mfma_f32_16x16x32_bf16 v[64:67], v[96:99], v[32:35], v[64:67]
    ds_read_b64_tr_b16 v[96:97], v14 offset:640
    v_pk_add_f32 v[160:161], v[160:161], v[140:141]
    v_exp_f32 v143, v143
    v_exp_f32 v144, v144
    v_pk_add_f32 v[160:161], v[160:161], v[142:143]
    v_exp_f32 v145, v145
    v_exp_f32 v146, v146
    v_pk_add_f32 v[160:161], v[160:161], v[144:145]
    s_waitcnt lgkmcnt(7)
    v_mfma_f32_16x16x32_bf16 v[68:71], v[100:103], v[32:35], v[68:71]
    ds_read_b64_tr_b16 v[100:101], v14 offset:648
    v_exp_f32 v147, v147
    v_exp_f32 v148, v148
    v_pk_add_f32 v[160:161], v[160:161], v[146:147]
    v_exp_f32 v149, v149
    v_exp_f32 v150, v150
    v_pk_add_f32 v[160:161], v[160:161], v[148:149]
    v_exp_f32 v151, v151
    s_waitcnt lgkmcnt(6)
    v_mfma_f32_16x16x32_bf16 v[72:75], v[104:107], v[32:35], v[72:75]
    ds_read_b64_tr_b16 v[104:105], v14 offset:656
    v_exp_f32 v152, v152
    v_pk_add_f32 v[160:161], v[160:161], v[150:151]
    v_exp_f32 v153, v153
    v_exp_f32 v154, v154
    v_pk_add_f32 v[160:161], v[160:161], v[152:153]
    v_exp_f32 v155, v155
    s_nop 0
    v_pk_add_f32 v[160:161], v[160:161], v[154:155]
    s_waitcnt lgkmcnt(5)
    v_mfma_f32_16x16x32_bf16 v[76:79], v[108:111], v[32:35], v[76:79]
    ds_read_b64_tr_b16 v[108:109], v14 offset:664
    v_add_f32 v160, v160, v161
    v_rcp_f32 v160, v160
    s_nop 0
    v_pk_mul_f32 v[136:137], v[136:137], v[160:161] op_sel_hi:[1,0]
    v_pk_mul_f32 v[138:139], v[138:139], v[160:161] op_sel_hi:[1,0]
    v_pk_mul_f32 v[140:141], v[140:141], v[160:161] op_sel_hi:[1,0]
    v_pk_mul_f32 v[142:143], v[142:143], v[160:161] op_sel_hi:[1,0]
    v_pk_mul_f32 v[144:145], v[144:145], v[160:161] op_sel_hi:[1,0]
    s_waitcnt lgkmcnt(4)
    v_mfma_f32_16x16x32_bf16 v[80:83], v[112:115], v[32:35], v[80:83]
    ds_read_b64_tr_b16 v[112:113], v14 offset:672
    v_pk_mul_f32 v[146:147], v[146:147], v[160:161] op_sel_hi:[1,0]
    v_pk_mul_f32 v[148:149], v[148:149], v[160:161] op_sel_hi:[1,0]
    v_pk_mul_f32 v[150:151], v[150:151], v[160:161] op_sel_hi:[1,0]
    v_pk_mul_f32 v[152:153], v[152:153], v[160:161] op_sel_hi:[1,0]
    v_pk_mul_f32 v[154:155], v[154:155], v[160:161] op_sel_hi:[1,0]
    v_cvt_pk_bf16_f32 v16, v136, v137
    v_cvt_pk_bf16_f32 v17, v138, v139
    s_waitcnt lgkmcnt(4)
    v_mfma_f32_16x16x32_bf16 v[64:67], v[96:99], v[36:39], v[64:67]
    ds_read_b64_tr_b16 v[96:97], v14 offset:0
    ds_read_b64_tr_b16 v[98:99], v14 offset:160
    v_cvt_pk_bf16_f32 v18, v140, v141
    v_cvt_pk_bf16_f32 v19, v142, v143
    v_cvt_pk_bf16_f32 v20, v144, v145
    v_cvt_pk_bf16_f32 v21, v146, v147
    v_cvt_pk_bf16_f32 v22, v148, v149
    v_cvt_pk_bf16_f32 v23, v150, v151
    v_cvt_pk_bf16_f32 v24, v152, v153
    s_waitcnt lgkmcnt(5)
    v_mfma_f32_16x16x32_bf16 v[68:71], v[100:103], v[36:39], v[68:71]
    ds_read_b64_tr_b16 v[100:101], v14 offset:8
    ds_read_b64_tr_b16 v[102:103], v14 offset:168
    v_cvt_pk_bf16_f32 v25, v154, v155
    v_pk_fma_f32 v[136:137], v[116:117], s[98:99], v[158:159] op_sel_hi:[1,0,0] neg_lo:[1,0,0] neg_hi:[1,0,0]
    v_pk_fma_f32 v[138:139], v[118:119], s[98:99], v[158:159] op_sel_hi:[1,0,0] neg_lo:[1,0,0] neg_hi:[1,0,0]
    v_pk_fma_f32 v[140:141], v[120:121], s[98:99], v[158:159] op_sel_hi:[1,0,0] neg_lo:[1,0,0] neg_hi:[1,0,0]
    v_pk_fma_f32 v[142:143], v[122:123], s[98:99], v[158:159] op_sel_hi:[1,0,0] neg_lo:[1,0,0] neg_hi:[1,0,0]
    v_pk_fma_f32 v[144:145], v[124:125], s[98:99], v[158:159] op_sel_hi:[1,0,0] neg_lo:[1,0,0] neg_hi:[1,0,0]
    v_pk_fma_f32 v[146:147], v[126:127], s[98:99], v[158:159] op_sel_hi:[1,0,0] neg_lo:[1,0,0] neg_hi:[1,0,0]
    s_waitcnt lgkmcnt(6)
    v_mfma_f32_16x16x32_bf16 v[72:75], v[104:107], v[36:39], v[72:75]
    ds_read_b64_tr_b16 v[104:105], v14 offset:16
    ds_read_b64_tr_b16 v[106:107], v14 offset:176
    v_pk_fma_f32 v[148:149], v[128:129], s[98:99], v[158:159] op_sel_hi:[1,0,0] neg_lo:[1,0,0] neg_hi:[1,0,0]
    v_pk_fma_f32 v[150:151], v[130:131], s[98:99], v[158:159] op_sel_hi:[1,0,0] neg_lo:[1,0,0] neg_hi:[1,0,0]
    v_pk_fma_f32 v[152:153], v[132:133], s[98:99], v[158:159] op_sel_hi:[1,0,0] neg_lo:[1,0,0] neg_hi:[1,0,0]
    v_pk_fma_f32 v[154:155], v[134:135], s[98:99], v[158:159] op_sel_hi:[1,0,0] neg_lo:[1,0,0] neg_hi:[1,0,0]
    v_exp_f32 v136, v136
    v_exp_f32 v137, v137
    v_exp_f32 v138, v138
    s_waitcnt lgkmcnt(7)
    v_mfma_f32_16x16x32_bf16 v[76:79], v[108:111], v[36:39], v[76:79]
    ds_read_b64_tr_b16 v[108:109], v14 offset:24
    ds_read_b64_tr_b16 v[110:111], v14 offset:184
    v_exp_f32 v139, v139
    v_exp_f32 v140, v140
    v_pk_add_f32 v[160:161], v[136:137], v[138:139]
    v_exp_f32 v141, v141
    v_exp_f32 v142, v142
    v_pk_add_f32 v[160:161], v[160:161], v[140:141]
    v_exp_f32 v143, v143
    s_waitcnt lgkmcnt(8)
    v_mfma_f32_16x16x32_bf16 v[80:83], v[112:115], v[36:39], v[80:83]
    ds_read_b64_tr_b16 v[112:113], v14 offset:32
    ds_read_b64_tr_b16 v[114:115], v14 offset:192
    v_exp_f32 v144, v144
    v_pk_add_f32 v[160:161], v[160:161], v[142:143]
    v_exp_f32 v145, v145
    v_exp_f32 v146, v146
    v_pk_add_f32 v[160:161], v[160:161], v[144:145]
    v_exp_f32 v147, v147
    v_exp_f32 v148, v148
    v_pk_add_f32 v[160:161], v[160:161], v[146:147]
    v_exp_f32 v149, v149
    v_exp_f32 v150, v150
    v_pk_add_f32 v[160:161], v[160:161], v[148:149]
    v_exp_f32 v151, v151
    v_exp_f32 v152, v152
    v_pk_add_f32 v[160:161], v[160:161], v[150:151]
    v_exp_f32 v153, v153
    v_exp_f32 v154, v154
    v_pk_add_f32 v[160:161], v[160:161], v[152:153]
    v_exp_f32 v155, v155
    s_nop 0
    v_pk_add_f32 v[160:161], v[160:161], v[154:155]
    v_add_f32 v160, v160, v161
    v_rcp_f32 v160, v160
    s_nop 0
    v_pk_mul_f32 v[136:137], v[136:137], v[160:161] op_sel_hi:[1,0]
    v_pk_mul_f32 v[138:139], v[138:139], v[160:161] op_sel_hi:[1,0]
    v_pk_mul_f32 v[140:141], v[140:141], v[160:161] op_sel_hi:[1,0]
    v_pk_mul_f32 v[142:143], v[142:143], v[160:161] op_sel_hi:[1,0]
    v_pk_mul_f32 v[144:145], v[144:145], v[160:161] op_sel_hi:[1,0]
    v_pk_mul_f32 v[146:147], v[146:147], v[160:161] op_sel_hi:[1,0]
    v_pk_mul_f32 v[148:149], v[148:149], v[160:161] op_sel_hi:[1,0]
    v_pk_mul_f32 v[150:151], v[150:151], v[160:161] op_sel_hi:[1,0]
    v_pk_mul_f32 v[152:153], v[152:153], v[160:161] op_sel_hi:[1,0]
    v_pk_mul_f32 v[154:155], v[154:155], v[160:161] op_sel_hi:[1,0]
    v_cvt_pk_bf16_f32 v26, v136, v137
    v_cvt_pk_bf16_f32 v27, v138, v139
    v_cvt_pk_bf16_f32 v84, v140, v141
    v_cvt_pk_bf16_f32 v85, v142, v143
    v_cvt_pk_bf16_f32 v86, v144, v145
    v_cvt_pk_bf16_f32 v87, v146, v147
    v_cvt_pk_bf16_f32 v88, v148, v149
    v_cvt_pk_bf16_f32 v89, v150, v151
    v_cvt_pk_bf16_f32 v90, v152, v153
    v_cvt_pk_bf16_f32 v91, v154, v155
    buffer_store_dwordx4 v[16:19], v162, s[48:51], s72 offen offset:0 sc1
    buffer_store_dwordx4 v[20:23], v162, s[48:51], s72 offen offset:256 sc1
    buffer_store_dwordx4 v[24:27], v162, s[48:51], s72 offen offset:512 sc1
    buffer_store_dwordx4 v[84:87], v162, s[48:51], s72 offen offset:768 sc1
    buffer_store_dwordx4 v[88:91], v162, s[48:51], s72 offen offset:1024 sc1
    s_add_u32 s72, s72, 40960
    v_max3_f32 v156, v64, v65, v66
    v_min3_f32 v158, v64, v65, v66
    v_max3_f32 v157, v67, v68, v69
    v_min3_f32 v159, v67, v68, v69
    v_max3_f32 v156, v156, v70, v71
    s_waitcnt lgkmcnt(8)
    v_mfma_f32_16x16x32_bf16 v[116:119], v[96:99], v[40:43], 0
    ds_read_b64_tr_b16 v[96:97], v14 offset:320
    ds_read_b64_tr_b16 v[98:99], v14 offset:480
    v_min3_f32 v158, v158, v70, v71
    v_max3_f32 v157, v157, v72, v73
    v_min3_f32 v159, v159, v72, v73
    v_max3_f32 v156, v156, v74, v75
    v_min3_f32 v158, v158, v74, v75
    v_max3_f32 v157, v157, v76, v77
    v_min3_f32 v159, v159, v76, v77
    s_waitcnt lgkmcnt(8)
    v_mfma_f32_16x16x32_bf16 v[120:123], v[100:103], v[40:43], 0
    ds_read_b64_tr_b16 v[100:101], v14 offset:328
    ds_read_b64_tr_b16 v[102:103], v14 offset:488
    v_max3_f32 v156, v156, v78, v79
    v_min3_f32 v158, v158, v78, v79
    v_max3_f32 v157, v157, v80, v81
    v_min3_f32 v159, v159, v80, v81
    v_max3_f32 v156, v156, v82, v83
    v_min3_f32 v158, v158, v82, v83
    v_max_f32 v156, v156, v157
    s_waitcnt lgkmcnt(8)
    v_mfma_f32_16x16x32_bf16 v[124:127], v[104:107], v[40:43], 0
    ds_read_b64_tr_b16 v[104:105], v14 offset:336
    ds_read_b64_tr_b16 v[106:107], v14 offset:496
    v_min_f32 v158, v158, v159
    v_mul_f32 v156, s98, v156
    v_mul_f32 v158, s98, v158
    v_pk_fma_f32 v[136:137], v[64:65], s[98:99], v[156:157] op_sel_hi:[1,0,0] neg_lo:[0,0,1] neg_hi:[0,0,1]
    v_pk_fma_f32 v[138:139], v[66:67], s[98:99], v[156:157] op_sel_hi:[1,0,0] neg_lo:[0,0,1] neg_hi:[0,0,1]
    v_pk_fma_f32 v[140:141], v[68:69], s[98:99], v[156:157] op_sel_hi:[1,0,0] neg_lo:[0,0,1] neg_hi:[0,0,1]
    v_pk_fma_f32 v[142:143], v[70:71], s[98:99], v[156:157] op_sel_hi:[1,0,0] neg_lo:[0,0,1] neg_hi:[0,0,1]
    s_waitcnt lgkmcnt(8)
    v_mfma_f32_16x16x32_bf16 v[128:131], v[108:111], v[40:43], 0
    ds_read_b64_tr_b16 v[108:109], v14 offset:344
    ds_read_b64_tr_b16 v[110:111], v14 offset:504
    v_pk_fma_f32 v[144:145], v[72:73], s[98:99], v[156:157] op_sel_hi:[1,0,0] neg_lo:[0,0,1] neg_hi:[0,0,1]
    v_pk_fma_f32 v[146:147], v[74:75], s[98:99], v[156:157] op_sel_hi:[1,0,0] neg_lo:[0,0,1] neg_hi:[0,0,1]
    v_pk_fma_f32 v[148:149], v[76:77], s[98:99], v[156:157] op_sel_hi:[1,0,0] neg_lo:[0,0,1] neg_hi:[0,0,1]
    v_pk_fma_f32 v[150:151], v[78:79], s[98:99], v[156:157] op_sel_hi:[1,0,0] neg_lo:[0,0,1] neg_hi:[0,0,1]
    v_pk_fma_f32 v[152:153], v[80:81], s[98:99], v[156:157] op_sel_hi:[1,0,0] neg_lo:[0,0,1] neg_hi:[0,0,1]
    v_pk_fma_f32 v[154:155], v[82:83], s[98:99], v[156:157] op_sel_hi:[1,0,0] neg_lo:[0,0,1] neg_hi:[0,0,1]
    v_exp_f32 v136, v136
    s_waitcnt lgkmcnt(8)
    v_mfma_f32_16x16x32_bf16 v[132:135], v[112:115], v[40:43], 0
    ds_read_b64_tr_b16 v[112:113], v14 offset:352
    ds_read_b64_tr_b16 v[114:115], v14 offset:512
    v_exp_f32 v137, v137
    v_exp_f32 v138, v138
    v_exp_f32 v139, v139
    v_exp_f32 v140, v140
    v_pk_add_f32 v[160:161], v[136:137], v[138:139]
    v_exp_f32 v141, v141
    v_exp_f32 v142, v142
    s_waitcnt lgkmcnt(8)
    v_mfma_f32_16x16x32_bf16 v[116:119], v[96:99], v[44:47], v[116:119]
    ds_read_b64_tr_b16 v[96:97], v14 offset:640
    v_pk_add_f32 v[160:161], v[160:161], v[140:141]
    v_exp_f32 v143, v143
    v_exp_f32 v144, v144
    v_pk_add_f32 v[160:161], v[160:161], v[142:143]
    v_exp_f32 v145, v145
    v_exp_f32 v146, v146
    v_pk_add_f32 v[160:161], v[160:161], v[144:145]
    s_waitcnt lgkmcnt(7)
    v_mfma_f32_16x16x32_bf16 v[120:123], v[100:103], v[44:47], v[120:123]
    ds_read_b64_tr_b16 v[100:101], v14 offset:648
    v_exp_f32 v147, v147
    v_exp_f32 v148, v148
    v_pk_add_f32 v[160:161], v[160:161], v[146:147]
    v_exp_f32 v149, v149
    v_exp_f32 v150, v150
    v_pk_add_f32 v[160:161], v[160:161], v[148:149]
    v_exp_f32 v151, v151
    s_waitcnt lgkmcnt(6)
    v_mfma_f32_16x16x32_bf16 v[124:127], v[104:107], v[44:47], v[124:127]
    ds_read_b64_tr_b16 v[104:105], v14 offset:656
    v_exp_f32 v152, v152
    v_pk_add_f32 v[160:161], v[160:161], v[150:151]
    v_exp_f32 v153, v153
    v_exp_f32 v154, v154
    v_pk_add_f32 v[160:161], v[160:161], v[152:153]
    v_exp_f32 v155, v155
    s_nop 0
    v_pk_add_f32 v[160:161], v[160:161], v[154:155]
    s_waitcnt lgkmcnt(5)
    v_mfma_f32_16x16x32_bf16 v[128:131], v[108:111], v[44:47], v[128:131]
    ds_read_b64_tr_b16 v[108:109], v14 offset:664
    v_add_f32 v160, v160, v161
    v_rcp_f32 v160, v160
    s_nop 0
    v_pk_mul_f32 v[136:137], v[136:137], v[160:161] op_sel_hi:[1,0]
    v_pk_mul_f32 v[138:139], v[138:139], v[160:161] op_sel_hi:[1,0]
    v_pk_mul_f32 v[140:141], v[140:141], v[160:161] op_sel_hi:[1,0]
    v_pk_mul_f32 v[142:143], v[142:143], v[160:161] op_sel_hi:[1,0]
    v_pk_mul_f32 v[144:145], v[144:145], v[160:161] op_sel_hi:[1,0]
    s_waitcnt lgkmcnt(4)
    v_mfma_f32_16x16x32_bf16 v[132:135], v[112:115], v[44:47], v[132:135]
    ds_read_b64_tr_b16 v[112:113], v14 offset:672
    v_pk_mul_f32 v[146:147], v[146:147], v[160:161] op_sel_hi:[1,0]
    v_pk_mul_f32 v[148:149], v[148:149], v[160:161] op_sel_hi:[1,0]
    v_pk_mul_f32 v[150:151], v[150:151], v[160:161] op_sel_hi:[1,0]
    v_pk_mul_f32 v[152:153], v[152:153], v[160:161] op_sel_hi:[1,0]
    v_pk_mul_f32 v[154:155], v[154:155], v[160:161] op_sel_hi:[1,0]
    v_cvt_pk_bf16_f32 v28, v136, v137
    v_cvt_pk_bf16_f32 v29, v138, v139
    s_waitcnt lgkmcnt(4)
    v_mfma_f32_16x16x32_bf16 v[116:119], v[96:99], v[48:51], v[116:119]
    v_cvt_pk_bf16_f32 v30, v140, v141
    v_cvt_pk_bf16_f32 v31, v142, v143
    v_cvt_pk_bf16_f32 v32, v144, v145
    v_cvt_pk_bf16_f32 v33, v146, v147
    v_cvt_pk_bf16_f32 v34, v148, v149
    v_cvt_pk_bf16_f32 v35, v150, v151
    v_cvt_pk_bf16_f32 v36, v152, v153
    s_waitcnt lgkmcnt(3)
    v_mfma_f32_16x16x32_bf16 v[120:123], v[100:103], v[48:51], v[120:123]
    v_cvt_pk_bf16_f32 v37, v154, v155
    v_pk_fma_f32 v[136:137], v[64:65], s[98:99], v[158:159] op_sel_hi:[1,0,0] neg_lo:[1,0,0] neg_hi:[1,0,0]
    v_pk_fma_f32 v[138:139], v[66:67], s[98:99], v[158:159] op_sel_hi:[1,0,0] neg_lo:[1,0,0] neg_hi:[1,0,0]
    v_pk_fma_f32 v[140:141], v[68:69], s[98:99], v[158:159] op_sel_hi:[1,0,0] neg_lo:[1,0,0] neg_hi:[1,0,0]
    v_pk_fma_f32 v[142:143], v[70:71], s[98:99], v[158:159] op_sel_hi:[1,0,0] neg_lo:[1,0,0] neg_hi:[1,0,0]
    v_pk_fma_f32 v[144:145], v[72:73], s[98:99], v[158:159] op_sel_hi:[1,0,0] neg_lo:[1,0,0] neg_hi:[1,0,0]
    v_pk_fma_f32 v[146:147], v[74:75], s[98:99], v[158:159] op_sel_hi:[1,0,0] neg_lo:[1,0,0] neg_hi:[1,0,0]
    s_waitcnt lgkmcnt(2)
    v_mfma_f32_16x16x32_bf16 v[124:127], v[104:107], v[48:51], v[124:127]
    v_pk_fma_f32 v[148:149], v[76:77], s[98:99], v[158:159] op_sel_hi:[1,0,0] neg_lo:[1,0,0] neg_hi:[1,0,0]
    v_pk_fma_f32 v[150:151], v[78:79], s[98:99], v[158:159] op_sel_hi:[1,0,0] neg_lo:[1,0,0] neg_hi:[1,0,0]
    v_pk_fma_f32 v[152:153], v[80:81], s[98:99], v[158:159] op_sel_hi:[1,0,0] neg_lo:[1,0,0] neg_hi:[1,0,0]
    v_pk_fma_f32 v[154:155], v[82:83], s[98:99], v[158:159] op_sel_hi:[1,0,0] neg_lo:[1,0,0] neg_hi:[1,0,0]
    v_exp_f32 v136, v136
    v_exp_f32 v137, v137
    v_exp_f32 v138, v138
    s_waitcnt lgkmcnt(1)
    v_mfma_f32_16x16x32_bf16 v[128:131], v[108:111], v[48:51], v[128:131]
    v_exp_f32 v139, v139
    v_exp_f32 v140, v140
    v_pk_add_f32 v[160:161], v[136:137], v[138:139]
    v_exp_f32 v141, v141
    v_exp_f32 v142, v142
    v_pk_add_f32 v[160:161], v[160:161], v[140:141]
    v_exp_f32 v143, v143
    s_waitcnt lgkmcnt(0)
    v_mfma_f32_16x16x32_bf16 v[132:135], v[112:115], v[48:51], v[132:135]
    v_exp_f32 v144, v144
    v_pk_add_f32 v[160:161], v[160:161], v[142:143]
    v_exp_f32 v145, v145
    v_exp_f32 v146, v146
    v_pk_add_f32 v[160:161], v[160:161], v[144:145]
    v_exp_f32 v147, v147
    v_exp_f32 v148, v148
    v_pk_add_f32 v[160:161], v[160:161], v[146:147]
    v_exp_f32 v149, v149
    v_exp_f32 v150, v150
    v_pk_add_f32 v[160:161], v[160:161], v[148:149]
    v_exp_f32 v151, v151
    v_exp_f32 v152, v152
    v_pk_add_f32 v[160:161], v[160:161], v[150:151]
    v_exp_f32 v153, v153
    v_exp_f32 v154, v154
    v_pk_add_f32 v[160:161], v[160:161], v[152:153]
    v_exp_f32 v155, v155
    s_nop 0
    v_pk_add_f32 v[160:161], v[160:161], v[154:155]
    v_add_f32 v160, v160, v161
    v_rcp_f32 v160, v160
    s_nop 0
    v_pk_mul_f32 v[136:137], v[136:137], v[160:161] op_sel_hi:[1,0]
    v_pk_mul_f32 v[138:139], v[138:139], v[160:161] op_sel_hi:[1,0]
    v_pk_mul_f32 v[140:141], v[140:141], v[160:161] op_sel_hi:[1,0]
    v_pk_mul_f32 v[142:143], v[142:143], v[160:161] op_sel_hi:[1,0]
    v_pk_mul_f32 v[144:145], v[144:145], v[160:161] op_sel_hi:[1,0]
    v_pk_mul_f32 v[146:147], v[146:147], v[160:161] op_sel_hi:[1,0]
    v_pk_mul_f32 v[148:149], v[148:149], v[160:161] op_sel_hi:[1,0]
    v_pk_mul_f32 v[150:151], v[150:151], v[160:161] op_sel_hi:[1,0]
    v_pk_mul_f32 v[152:153], v[152:153], v[160:161] op_sel_hi:[1,0]
    v_pk_mul_f32 v[154:155], v[154:155], v[160:161] op_sel_hi:[1,0]
    v_cvt_pk_bf16_f32 v38, v136, v137
    v_cvt_pk_bf16_f32 v39, v138, v139
    v_cvt_pk_bf16_f32 v84, v140, v141
    v_cvt_pk_bf16_f32 v85, v142, v143
    v_cvt_pk_bf16_f32 v86, v144, v145
    v_cvt_pk_bf16_f32 v87, v146, v147
    v_cvt_pk_bf16_f32 v88, v148, v149
    v_cvt_pk_bf16_f32 v89, v150, v151
    v_cvt_pk_bf16_f32 v90, v152, v153
    v_cvt_pk_bf16_f32 v91, v154, v155
    buffer_store_dwordx4 v[28:31], v162, s[48:51], s72 offen offset:0 sc1
    buffer_store_dwordx4 v[32:35], v162, s[48:51], s72 offen offset:256 sc1
    buffer_store_dwordx4 v[36:39], v162, s[48:51], s72 offen offset:512 sc1
    buffer_store_dwordx4 v[84:87], v162, s[48:51], s72 offen offset:768 sc1
    buffer_store_dwordx4 v[88:91], v162, s[48:51], s72 offen offset:1024 sc1
    s_add_u32 s72, s72, 40960
    v_max3_f32 v156, v116, v117, v118
    v_min3_f32 v158, v116, v117, v118
    v_max3_f32 v157, v119, v120, v121
    v_min3_f32 v159, v119, v120, v121
    v_max3_f32 v156, v156, v122, v123
    v_min3_f32 v158, v158, v122, v123
    v_max3_f32 v157, v157, v124, v125
    v_min3_f32 v159, v159, v124, v125
    v_max3_f32 v156, v156, v126, v127
    v_min3_f32 v158, v158, v126, v127
    v_max3_f32 v157, v157, v128, v129
    v_min3_f32 v159, v159, v128, v129
    v_max3_f32 v156, v156, v130, v131
    v_min3_f32 v158, v158, v130, v131
    v_max3_f32 v157, v157, v132, v133
    v_min3_f32 v159, v159, v132, v133
    v_max3_f32 v156, v156, v134, v135
    v_min3_f32 v158, v158, v134, v135
    v_max_f32 v156, v156, v157
    v_min_f32 v158, v158, v159
    v_mul_f32 v156, s98, v156
    v_mul_f32 v158, s98, v158
    v_pk_fma_f32 v[136:137], v[116:117], s[98:99], v[156:157] op_sel_hi:[1,0,0] neg_lo:[0,0,1] neg_hi:[0,0,1]
    v_pk_fma_f32 v[138:139], v[118:119], s[98:99], v[156:157] op_sel_hi:[1,0,0] neg_lo:[0,0,1] neg_hi:[0,0,1]
    v_pk_fma_f32 v[140:141], v[120:121], s[98:99], v[156:157] op_sel_hi:[1,0,0] neg_lo:[0,0,1] neg_hi:[0,0,1]
    v_pk_fma_f32 v[142:143], v[122:123], s[98:99], v[156:157] op_sel_hi:[1,0,0] neg_lo:[0,0,1] neg_hi:[0,0,1]
    v_pk_fma_f32 v[144:145], v[124:125], s[98:99], v[156:157] op_sel_hi:[1,0,0] neg_lo:[0,0,1] neg_hi:[0,0,1]
    v_pk_fma_f32 v[146:147], v[126:127], s[98:99], v[156:157] op_sel_hi:[1,0,0] neg_lo:[0,0,1] neg_hi:[0,0,1]
    v_pk_fma_f32 v[148:149], v[128:129], s[98:99], v[156:157] op_sel_hi:[1,0,0] neg_lo:[0,0,1] neg_hi:[0,0,1]
    v_pk_fma_f32 v[150:151], v[130:131], s[98:99], v[156:157] op_sel_hi:[1,0,0] neg_lo:[0,0,1] neg_hi:[0,0,1]
    v_pk_fma_f32 v[152:153], v[132:133], s[98:99], v[156:157] op_sel_hi:[1,0,0] neg_lo:[0,0,1] neg_hi:[0,0,1]
    v_pk_fma_f32 v[154:155], v[134:135], s[98:99], v[156:157] op_sel_hi:[1,0,0] neg_lo:[0,0,1] neg_hi:[0,0,1]
    v_exp_f32 v136, v136
    v_exp_f32 v137, v137
    v_exp_f32 v138, v138
    v_exp_f32 v139, v139
    v_exp_f32 v140, v140
    v_pk_add_f32 v[160:161], v[136:137], v[138:139]
    v_exp_f32 v141, v141
    v_exp_f32 v142, v142
    v_pk_add_f32 v[160:161], v[160:161], v[140:141]
    v_exp_f32 v143, v143
    v_exp_f32 v144, v144
    v_pk_add_f32 v[160:161], v[160:161], v[142:143]
    v_exp_f32 v145, v145
    v_exp_f32 v146, v146
    v_pk_add_f32 v[160:161], v[160:161], v[144:145]
    v_exp_f32 v147, v147
    v_exp_f32 v148, v148
    v_pk_add_f32 v[160:161], v[160:161], v[146:147]
    v_exp_f32 v149, v149
    v_exp_f32 v150, v150
    v_pk_add_f32 v[160:161], v[160:161], v[148:149]
    v_exp_f32 v151, v151
    v_exp_f32 v152, v152
    v_pk_add_f32 v[160:161], v[160:161], v[150:151]
    v_exp_f32 v153, v153
    v_exp_f32 v154, v154
    v_pk_add_f32 v[160:161], v[160:161], v[152:153]
    v_exp_f32 v155, v155
    s_nop 0
    v_pk_add_f32 v[160:161], v[160:161], v[154:155]
    v_add_f32 v160, v160, v161
    v_rcp_f32 v160, v160
    s_nop 0
    v_pk_mul_f32 v[136:137], v[136:137], v[160:161] op_sel_hi:[1,0]
    v_pk_mul_f32 v[138:139], v[138:139], v[160:161] op_sel_hi:[1,0]
    v_pk_mul_f32 v[140:141], v[140:141], v[160:161] op_sel_hi:[1,0]
    v_pk_mul_f32 v[142:143], v[142:143], v[160:161] op_sel_hi:[1,0]
    v_pk_mul_f32 v[144:145], v[144:145], v[160:161] op_sel_hi:[1,0]
    v_pk_mul_f32 v[146:147], v[146:147], v[160:161] op_sel_hi:[1,0]
    v_pk_mul_f32 v[148:149], v[148:149], v[160:161] op_sel_hi:[1,0]
    v_pk_mul_f32 v[150:151], v[150:151], v[160:161] op_sel_hi:[1,0]
    v_pk_mul_f32 v[152:153], v[152:153], v[160:161] op_sel_hi:[1,0]
    v_pk_mul_f32 v[154:155], v[154:155], v[160:161] op_sel_hi:[1,0]
    v_cvt_pk_bf16_f32 v40, v136, v137
    v_cvt_pk_bf16_f32 v41, v138, v139
    v_cvt_pk_bf16_f32 v42, v140, v141
    v_cvt_pk_bf16_f32 v43, v142, v143
    v_cvt_pk_bf16_f32 v44, v144, v145
    v_cvt_pk_bf16_f32 v45, v146, v147
    v_cvt_pk_bf16_f32 v46, v148, v149
    v_cvt_pk_bf16_f32 v47, v150, v151
    v_cvt_pk_bf16_f32 v48, v152, v153
    v_cvt_pk_bf16_f32 v49, v154, v155
    v_pk_fma_f32 v[136:137], v[116:117], s[98:99], v[158:159] op_sel_hi:[1,0,0] neg_lo:[1,0,0] neg_hi:[1,0,0]
    v_pk_fma_f32 v[138:139], v[118:119], s[98:99], v[158:159] op_sel_hi:[1,0,0] neg_lo:[1,0,0] neg_hi:[1,0,0]
    v_pk_fma_f32 v[140:141], v[120:121], s[98:99], v[158:159] op_sel_hi:[1,0,0] neg_lo:[1,0,0] neg_hi:[1,0,0]
    v_pk_fma_f32 v[142:143], v[122:123], s[98:99], v[158:159] op_sel_hi:[1,0,0] neg_lo:[1,0,0] neg_hi:[1,0,0]
    v_pk_fma_f32 v[144:145], v[124:125], s[98:99], v[158:159] op_sel_hi:[1,0,0] neg_lo:[1,0,0] neg_hi:[1,0,0]
    v_pk_fma_f32 v[146:147], v[126:127], s[98:99], v[158:159] op_sel_hi:[1,0,0] neg_lo:[1,0,0] neg_hi:[1,0,0]
    v_pk_fma_f32 v[148:149], v[128:129], s[98:99], v[158:159] op_sel_hi:[1,0,0] neg_lo:[1,0,0] neg_hi:[1,0,0]
    v_pk_fma_f32 v[150:151], v[130:131], s[98:99], v[158:159] op_sel_hi:[1,0,0] neg_lo:[1,0,0] neg_hi:[1,0,0]
    v_pk_fma_f32 v[152:153], v[132:133], s[98:99], v[158:159] op_sel_hi:[1,0,0] neg_lo:[1,0,0] neg_hi:[1,0,0]
    v_pk_fma_f32 v[154:155], v[134:135], s[98:99], v[158:159] op_sel_hi:[1,0,0] neg_lo:[1,0,0] neg_hi:[1,0,0]
    v_exp_f32 v136, v136
    v_exp_f32 v137, v137
    v_exp_f32 v138, v138
    v_exp_f32 v139, v139
    v_exp_f32 v140, v140
    v_pk_add_f32 v[160:161], v[136:137], v[138:139]
    v_exp_f32 v141, v141
    v_exp_f32 v142, v142
    v_pk_add_f32 v[160:161], v[160:161], v[140:141]
    v_exp_f32 v143, v143
    v_exp_f32 v144, v144
    v_pk_add_f32 v[160:161], v[160:161], v[142:143]
    v_exp_f32 v145, v145
    v_exp_f32 v146, v146
    v_pk_add_f32 v[160:161], v[160:161], v[144:145]
    v_exp_f32 v147, v147
    v_exp_f32 v148, v148
    v_pk_add_f32 v[160:161], v[160:161], v[146:147]
    v_exp_f32 v149, v149
    v_exp_f32 v150, v150
    v_pk_add_f32 v[160:161], v[160:161], v[148:149]
    v_exp_f32 v151, v151
    v_exp_f32 v152, v152
    v_pk_add_f32 v[160:161], v[160:161], v[150:151]
    v_exp_f32 v153, v153
    v_exp_f32 v154, v154
    v_pk_add_f32 v[160:161], v[160:161], v[152:153]
    v_exp_f32 v155, v155
    s_nop 0
    v_pk_add_f32 v[160:161], v[160:161], v[154:155]
    v_add_f32 v160, v160, v161
    v_rcp_f32 v160, v160
    s_nop 0
    v_pk_mul_f32 v[136:137], v[136:137], v[160:161] op_sel_hi:[1,0]
    v_pk_mul_f32 v[138:139], v[138:139], v[160:161] op_sel_hi:[1,0]
    v_pk_mul_f32 v[140:141], v[140:141], v[160:161] op_sel_hi:[1,0]
    v_pk_mul_f32 v[142:143], v[142:143], v[160:161] op_sel_hi:[1,0]
    v_pk_mul_f32 v[144:145], v[144:145], v[160:161] op_sel_hi:[1,0]
    v_pk_mul_f32 v[146:147], v[146:147], v[160:161] op_sel_hi:[1,0]
    v_pk_mul_f32 v[148:149], v[148:149], v[160:161] op_sel_hi:[1,0]
    v_pk_mul_f32 v[150:151], v[150:151], v[160:161] op_sel_hi:[1,0]
    v_pk_mul_f32 v[152:153], v[152:153], v[160:161] op_sel_hi:[1,0]
    v_pk_mul_f32 v[154:155], v[154:155], v[160:161] op_sel_hi:[1,0]
    v_cvt_pk_bf16_f32 v50, v136, v137
    v_cvt_pk_bf16_f32 v51, v138, v139
    v_cvt_pk_bf16_f32 v84, v140, v141
    v_cvt_pk_bf16_f32 v85, v142, v143
    v_cvt_pk_bf16_f32 v86, v144, v145
    v_cvt_pk_bf16_f32 v87, v146, v147
    v_cvt_pk_bf16_f32 v88, v148, v149
    v_cvt_pk_bf16_f32 v89, v150, v151
    v_cvt_pk_bf16_f32 v90, v152, v153
    v_cvt_pk_bf16_f32 v91, v154, v155
    buffer_store_dwordx4 v[40:43], v162, s[48:51], s72 offen offset:0 sc1
    buffer_store_dwordx4 v[44:47], v162, s[48:51], s72 offen offset:256 sc1
    buffer_store_dwordx4 v[48:51], v162, s[48:51], s72 offen offset:512 sc1
    buffer_store_dwordx4 v[84:87], v162, s[48:51], s72 offen offset:768 sc1
    buffer_store_dwordx4 v[88:91], v162, s[48:51], s72 offen offset:1024 sc1
    s_endpgm
L_k1_ld_q:
    s_setprio 3
    s_mov_b32 s9, 0
    s_mov_b32 s12, 0
    s_and_b32 s15, s6, 1
    s_cmp_ge_u32 s6, 10
    s_cbranch_scc1 L_k1_ldw_q
    v_and_b32 v14, 7, v0
    v_xor_b32 v14, v14, v11
    v_lshrrev_b32 v15, 3, v0
    v_mul_u32_u24 v15, 1280, v15
    v_lshl_add_u32 v16, v14, 4, v15
    v_xor_b32 v14, 4, v14
    v_lshl_add_u32 v17, v14, 4, v15
    v_add_u32 v17, 10240, v17
    v_add_u32 v18, 20480, v16
    v_add_u32 v19, 20480, v17
    v_add_u32 v20, 40960, v16
    v_add_u32 v21, 40960, v17
    s_mul_i32 s10, s5, 245760
    s_mul_i32 s72, s15, 122880
    s_add_u32 s11, s10, s72
    s_lshl_b32 s8, s14, 7
    s_add_u32 s10, s11, s8
    s_mul_i32 s7, s15, 12288
    s_add_u32 m0, s9, s7
    s_mov_b32 s72, s10
    buffer_load_dwordx4 v16, s[40:43], s72 offen lds
    s_add_u32 m0, m0, 1024
    s_nop 0
    buffer_load_dwordx4 v17, s[40:43], s72 offen lds
    s_add_u32 m0, m0, 1024
    s_nop 0
    buffer_load_dwordx4 v18, s[40:43], s72 offen lds
    s_add_u32 m0, m0, 1024
    s_nop 0
    buffer_load_dwordx4 v19, s[40:43], s72 offen lds
    s_add_u32 m0, m0, 1024
    s_nop 0
    buffer_load_dwordx4 v20, s[40:43], s72 offen lds
    s_add_u32 m0, m0, 1024
    s_nop 0
    buffer_load_dwordx4 v21, s[40:43], s72 offen lds
    s_add_u32 m0, s9, s7
    s_add_u32 m0, m0, 6144
    s_add_u32 s72, s10, 61440
    buffer_load_dwordx4 v16, s[40:43], s72 offen lds
    s_add_u32 m0, m0, 1024
    s_nop 0
    buffer_load_dwordx4 v17, s[40:43], s72 offen lds
    s_add_u32 m0, m0, 1024
    s_nop 0
    buffer_load_dwordx4 v18, s[40:43], s72 offen lds
    s_add_u32 m0, m0, 1024
    s_nop 0
    buffer_load_dwordx4 v19, s[40:43], s72 offen lds
    s_add_u32 m0, m0, 1024
    s_nop 0
    buffer_load_dwordx4 v20, s[40:43], s72 offen lds
    s_add_u32 m0, m0, 1024
    s_nop 0
    buffer_load_dwordx4 v21, s[40:43], s72 offen lds
    s_add_u32 s8, s8, 128
    s_cmp_eq_u32 s8, 1280
    s_cselect_b32 s8, 0, s8
    s_add_u32 s10, s11, s8
    s_add_u32 s9, s9, 32768
    s_cmp_eq_u32 s9, 98304
    s_cselect_b32 s9, 0, s9
    s_mov_b32 s84, s30
    s_and_b32 s85, s31, 0xffff
    s_mov_b32 s86, 0x21c000
    s_mov_b32 s87, 0x20000
    s_mov_b32 s88, s22
    s_and_b32 s89, s23, 0xffff
    s_mov_b32 s90, 0xc8000
    s_mov_b32 s91, 0x20000
    s_add_u32 s92, s38, 0x1000000
    s_addc_u32 s93, s39, 0
    s_and_b32 s93, s93, 0xffff
    s_mov_b32 s94, 0x2e4000
    s_mov_b32 s95, 0x20000
    s_mov_b32 s56, s32
    s_and_b32 s57, s33, 0xffff
    s_mov_b32 s58, 0x500
    s_mov_b32 s59, 0x20000
    s_add_u32 s60, s38, 0xe30000
    s_addc_u32 s61, s39, 0
    s_and_b32 s61, s61, 0xffff
    s_mov_b32 s62, 0x2000
    s_mov_b32 s63, 0x20000
    s_add_u32 s64, s38, 0xe20000
    s_addc_u32 s65, s39, 0
    s_and_b32 s65, s65, 0xffff
    s_mov_b32 s66, 0x400
    s_mov_b32 s67, 0x20000
    v_add_u32 v15, 0, v0
    v_mul_u32_u24 v14, 205, v15
    v_lshrrev_b32 v14, 11, v14
    v_mul_u32_u24 v1, 10, v14
    v_sub_u32 v15, v15, v1
    v_lshlrev_b32 v15, 4, v15
    v_and_b32 v1, 7, v14
    v_and_b32 v2, 8, v14
    v_lshl_or_b32 v1, v2, 1, v1
    v_and_b32 v2, 16, v14
    v_lshrrev_b32 v2, 1, v2
    v_or_b32 v1, v1, v2
    v_mul_u32_u24 v1, 1280, v1
    v_add_u32 v32, v1, v15
    v_bfe_u32 v2, v14, 3, 1
    v_and_b32 v3, 3, v14
    v_lshl_add_u32 v2, v2, 2, v3
    v_mul_u32_u24 v2, 20, v2
    v_lshrrev_b32 v3, 4, v14
    v_bfe_u32 v4, v14, 2, 1
    v_lshl_add_u32 v3, v3, 1, v4
    v_bfe_u32 v4, v14, 3, 1
    v_mul_u32_u24 v4, 20, v4
    v_lshl_add_u32 v4, v3, 2, v4
    v_and_b32 v1, 3, v14
    v_add_u32 v4, v4, v1
    v_add3_u32 v3, v3, v2, 16
    v_mul_u32_u24 v4, 1280, v4
    v_mul_u32_u24 v3, 1280, v3
    v_add_u32 v37, v4, v15
    v_add_u32 v42, v3, v15
    v_add_u32 v15, 64, v0
    v_mul_u32_u24 v14, 205, v15
    v_lshrrev_b32 v14, 11, v14
    v_mul_u32_u24 v1, 10, v14
    v_sub_u32 v15, v15, v1
    v_lshlrev_b32 v15, 4, v15
    v_and_b32 v1, 7, v14
    v_and_b32 v2, 8, v14
    v_lshl_or_b32 v1, v2, 1, v1
    v_and_b32 v2, 16, v14
    v_lshrrev_b32 v2, 1, v2
    v_or_b32 v1, v1, v2
    v_mul_u32_u24 v1, 1280, v1
    v_add_u32 v33, v1, v15
    v_bfe_u32 v2, v14, 3, 1
    v_and_b32 v3, 3, v14
    v_lshl_add_u32 v2, v2, 2, v3
    v_mul_u32_u24 v2, 20, v2
    v_lshrrev_b32 v3, 4, v14
    v_bfe_u32 v4, v14, 2, 1
    v_lshl_add_u32 v3, v3, 1, v4
    v_bfe_u32 v4, v14, 3, 1
    v_mul_u32_u24 v4, 20, v4
    v_lshl_add_u32 v4, v3, 2, v4
    v_and_b32 v1, 3, v14
    v_add_u32 v4, v4, v1
    v_add3_u32 v3, v3, v2, 16
    v_mul_u32_u24 v4, 1280, v4
    v_mul_u32_u24 v3, 1280, v3
    v_add_u32 v38, v4, v15
    v_add_u32 v43, v3, v15
    v_add_u32 v15, 128, v0
    v_mul_u32_u24 v14, 205, v15
    v_lshrrev_b32 v14, 11, v14
    v_mul_u32_u24 v1, 10, v14
    v_sub_u32 v15, v15, v1
    v_lshlrev_b32 v15, 4, v15
    v_and_b32 v1, 7, v14
    v_and_b32 v2, 8, v14
    v_lshl_or_b32 v1, v2, 1, v1
    v_and_b32 v2, 16, v14
    v_lshrrev_b32 v2, 1, v2
    v_or_b32 v1, v1, v2
    v_mul_u32_u24 v1, 1280, v1
    v_add_u32 v34, v1, v15
    v_bfe_u32 v2, v14, 3, 1
    v_and_b32 v3, 3, v14
    v_lshl_add_u32 v2, v2, 2, v3
    v_mul_u32_u24 v2, 20, v2
    v_lshrrev_b32 v3, 4, v14
    v_bfe_u32 v4, v14, 2, 1
    v_lshl_add_u32 v3, v3, 1, v4
    v_bfe_u32 v4, v14, 3, 1
    v_mul_u32_u24 v4, 20, v4
    v_lshl_add_u32 v4, v3, 2, v4
    v_and_b32 v1, 3, v14
    v_add_u32 v4, v4, v1
    v_add3_u32 v3, v3, v2, 16
    v_mul_u32_u24 v4, 1280, v4
    v_mul_u32_u24 v3, 1280, v3
    v_add_u32 v39, v4, v15
    v_add_u32 v44, v3, v15
    v_add_u32 v15, 192, v0
    v_mul_u32_u24 v14, 205, v15
    v_lshrrev_b32 v14, 11, v14
    v_mul_u32_u24 v1, 10, v14
    v_sub_u32 v15, v15, v1
    v_lshlrev_b32 v15, 4, v15
    v_and_b32 v1, 7, v14
    v_and_b32 v2, 8, v14
    v_lshl_or_b32 v1, v2, 1, v1
    v_and_b32 v2, 16, v14
    v_lshrrev_b32 v2, 1, v2
    v_or_b32 v1, v1, v2
    v_mul_u32_u24 v1, 1280, v1
    v_add_u32 v35, v1, v15
    v_bfe_u32 v2, v14, 3, 1
    v_and_b32 v3, 3, v14
    v_lshl_add_u32 v2, v2, 2, v3
    v_mul_u32_u24 v2, 20, v2
    v_lshrrev_b32 v3, 4, v14
    v_bfe_u32 v4, v14, 2, 1
    v_lshl_add_u32 v3, v3, 1, v4
    v_bfe_u32 v4, v14, 3, 1
    v_mul_u32_u24 v4, 20, v4
    v_lshl_add_u32 v4, v3, 2, v4
    v_and_b32 v1, 3, v14
    v_add_u32 v4, v4, v1
    v_add3_u32 v3, v3, v2, 16
    v_mul_u32_u24 v4, 1280, v4
    v_mul_u32_u24 v3, 1280, v3
    v_add_u32 v40, v4, v15
    v_add_u32 v45, v3, v15
    v_add_u32 v15, 256, v0
    v_mul_u32_u24 v14, 205, v15
    v_lshrrev_b32 v14, 11, v14
    v_mul_u32_u24 v1, 10, v14
    v_sub_u32 v15, v15, v1
    v_lshlrev_b32 v15, 4, v15
    v_and_b32 v1, 7, v14
    v_and_b32 v2, 8, v14
    v_lshl_or_b32 v1, v2, 1, v1
    v_and_b32 v2, 16, v14
    v_lshrrev_b32 v2, 1, v2
    v_or_b32 v1, v1, v2
    v_mul_u32_u24 v1, 1280, v1
    v_add_u32 v36, v1, v15
    v_bfe_u32 v2, v14, 3, 1
    v_and_b32 v3, 3, v14
    v_lshl_add_u32 v2, v2, 2, v3
    v_mul_u32_u24 v2, 20, v2
    v_lshrrev_b32 v3, 4, v14
    v_bfe_u32 v4, v14, 2, 1
    v_lshl_add_u32 v3, v3, 1, v4
    v_bfe_u32 v4, v14, 3, 1
    v_mul_u32_u24 v4, 20, v4
    v_lshl_add_u32 v4, v3, 2, v4
    v_and_b32 v1, 3, v14
    v_add_u32 v4, v4, v1
    v_add3_u32 v3, v3, v2, 16
    v_mul_u32_u24 v4, 1280, v4
    v_mul_u32_u24 v3, 1280, v3
    v_add_u32 v41, v4, v15
    v_add_u32 v46, v3, v15
    s_and_b32 s81, s6, 3
    s_mul_i32 s81, s81, 5120
    s_add_u32 s81, s81, 32768
    v_lshrrev_b32 v14, 1, v11
    v_lshlrev_b32 v14, 4, v14
    v_and_b32 v15, 1, v11
    v_lshl_add_u32 v14, v15, 2, v14
    v_add_u32 v14, v14, v12
    v_mul_u32_u24 v14, 160, v14
    v_add_u32 v14, s81, v14
    v_lshl_add_u32 v47, v13, 4, v14
    v_lshl_add_u32 v31, v13, 3, v14
    v_lshlrev_b32 v48, 4, v0
    v_lshlrev_b32 v51, 4, v10
    v_mul_u32_u24 v49, 1280, v11
    v_add_u32 v49, v49, v51
    v_lshlrev_b32 v1, 2, v11
    v_mov_b32 v2, 0x40000000
    v_cmp_eq_u32 vcc, 0, v10
    s_nop 1
    v_cndmask_b32 v50, v2, v1, vcc
    v_mov_b32 v112, 0
    v_mov_b32 v113, 0
    v_mov_b32 v114, 0
    v_mov_b32 v115, 0
    s_lshl_b32 s76, s3, 2
    s_add_u32 s76, s76, s6
    s_sub_u32 s76, s76, 264
    s_lshl_b32 s82, s76, 10
    s_cmp_lt_u32 s76, 512
    s_cselect_b32 s80, s76, 0x20000
    s_and_b32 s72, s76, 7
    s_lshr_b32 s73, s76, 3
    s_mul_i32 s77, s72, 74
    s_add_u32 s77, s77, s73
    s_mul_i32 s77, s77, 5120
    s_mul_i32 s72, s72, 160
    s_mul_i32 s78, s73, 40960
    s_add_u32 s78, s78, s72
    s_mov_b32 s79, 0
    s_cmp_lt_u32 s73, 54
    s_cbranch_scc1 L_rps_done_2622
    s_sub_u32 s73, s73, 54
    s_mul_i32 s74, s73, 52
    s_lshr_b32 s74, s74, 8
    s_mul_i32 s78, s74, 5
    s_sub_u32 s73, s73, s78
    s_mul_i32 s78, s74, 204800
    s_add_u32 s78, s78, s72
    s_mul_i32 s74, s73, 51200
    s_cmp_eq_u32 s73, 4
    s_cselect_b32 s74, 0, s74
    s_cselect_b32 s79, 2, 1
    s_add_u32 s78, s78, s74
L_rps_done_2622:
    s_cmp_lt_u32 s76, 592
    s_cselect_b32 s78, s78, 0x40000000
    s_cselect_b32 s77, s77, 0x40000000
    s_waitcnt vmcnt(0)
    s_barrier
    s_add_u32 m0, s9, s7
    s_mov_b32 s72, s10
    buffer_load_dwordx4 v16, s[40:43], s72 offen lds
    s_add_u32 m0, m0, 1024
    s_nop 0
    buffer_load_dwordx4 v17, s[40:43], s72 offen lds
    s_add_u32 m0, m0, 1024
    s_nop 0
    buffer_load_dwordx4 v18, s[40:43], s72 offen lds
    s_add_u32 m0, m0, 1024
    s_nop 0
    buffer_load_dwordx4 v19, s[40:43], s72 offen lds
    s_add_u32 m0, m0, 1024
    s_nop 0
    buffer_load_dwordx4 v20, s[40:43], s72 offen lds
    s_add_u32 m0, m0, 1024
    s_nop 0
    buffer_load_dwordx4 v21, s[40:43], s72 offen lds
    s_add_u32 m0, s9, s7
    s_add_u32 m0, m0, 6144
    s_add_u32 s72, s10, 61440
    buffer_load_dwordx4 v16, s[40:43], s72 offen lds
    s_add_u32 m0, m0, 1024
    s_nop 0
    buffer_load_dwordx4 v17, s[40:43], s72 offen lds
    s_add_u32 m0, m0, 1024
    s_nop 0
    buffer_load_dwordx4 v18, s[40:43], s72 offen lds
    s_add_u32 m0, m0, 1024
    s_nop 0
    buffer_load_dwordx4 v19, s[40:43], s72 offen lds
    s_add_u32 m0, m0, 1024
    s_nop 0
    buffer_load_dwordx4 v20, s[40:43], s72 offen lds
    s_add_u32 m0, m0, 1024
    s_nop 0
    buffer_load_dwordx4 v21, s[40:43], s72 offen lds
    s_add_u32 s8, s8, 128
    s_cmp_eq_u32 s8, 1280
    s_cselect_b32 s8, 0, s8
    s_add_u32 s10, s11, s8
    s_add_u32 s9, s9, 32768
    s_cmp_eq_u32 s9, 98304
    s_cselect_b32 s9, 0, s9
L_k1_ldx_loop_q:
    s_barrier
    s_add_u32 m0, s9, s7
    s_mov_b32 s72, s10
    buffer_load_dwordx4 v16, s[40:43], s72 offen lds
    s_add_u32 m0, m0, 1024
    s_nop 0
    buffer_load_dwordx4 v17, s[40:43], s72 offen lds
    s_add_u32 m0, m0, 1024
    s_nop 0
    buffer_load_dwordx4 v18, s[40:43], s72 offen lds
    s_add_u32 m0, m0, 1024
    s_nop 0
    buffer_load_dwordx4 v19, s[40:43], s72 offen lds
    s_add_u32 m0, m0, 1024
    s_nop 0
    buffer_load_dwordx4 v20, s[40:43], s72 offen lds
    s_add_u32 m0, m0, 1024
    s_nop 0
    buffer_load_dwordx4 v21, s[40:43], s72 offen lds
    s_waitcnt vmcnt(6)
    s_barrier
    s_add_u32 m0, s9, s7
    s_add_u32 m0, m0, 6144
    s_add_u32 s72, s10, 61440
    buffer_load_dwordx4 v16, s[40:43], s72 offen lds
    s_add_u32 m0, m0, 1024
    s_nop 0
    buffer_load_dwordx4 v17, s[40:43], s72 offen lds
    s_add_u32 m0, m0, 1024
    s_nop 0
    buffer_load_dwordx4 v18, s[40:43], s72 offen lds
    s_add_u32 m0, m0, 1024
    s_nop 0
    buffer_load_dwordx4 v19, s[40:43], s72 offen lds
    s_add_u32 m0, m0, 1024
    s_nop 0
    buffer_load_dwordx4 v20, s[40:43], s72 offen lds
    s_add_u32 m0, m0, 1024
    s_nop 0
    buffer_load_dwordx4 v21, s[40:43], s72 offen lds
    s_add_u32 s8, s8, 128
    s_cmp_eq_u32 s8, 1280
    s_cselect_b32 s8, 0, s8
    s_add_u32 s10, s11, s8
    s_add_u32 s9, s9, 32768
    s_cmp_eq_u32 s9, 98304
    s_cselect_b32 s9, 0, s9
    s_add_u32 s12, s12, 1
    s_cmp_lt_u32 s12, 8
    s_cbranch_scc1 L_k1_ldx_loop_q
    s_barrier
    s_branch L_k1_rp
L_k1_ldw_q:
    s_mov_b32 s44, s18
    s_and_b32 s45, s19, 0xffff
    s_mov_b32 s46, 0x258000
    s_mov_b32 s47, 0x20000
    s_mul_i32 s72, s99, 320
    s_mul_i32 s74, s15, 160
    s_add_u32 s72, s72, s74
    s_mul_i32 s74, s99, 6400
    s_add_u32 s52, s20, s74
    s_addc_u32 s53, s21, 0
    s_and_b32 s53, s53, 0xffff
    s_mov_b32 s54, 6400
    s_mov_b32 s55, 0x20000
    v_add_u32 v14, 0, v0
    v_mul_u32_u24 v15, 205, v14
    v_lshrrev_b32 v15, 11, v15
    v_mul_u32_u24 v1, 10, v15
    v_sub_u32 v14, v14, v1
    v_and_b32 v2, 4, v15
    v_and_b32 v1, 0x13, v15
    v_lshl_or_b32 v1, v2, 1, v1
    v_and_b32 v2, 8, v15
    v_lshrrev_b32 v2, 1, v2
    v_or_b32 v1, v1, v2
    v_mul_u32_u24 v1, 3840, v1
    v_add_u32 v1, s72, v1
    v_lshl_add_u32 v16, v14, 4, v1
    v_add_u32 v14, 64, v0
    v_mul_u32_u24 v15, 205, v14
    v_lshrrev_b32 v15, 11, v15
    v_mul_u32_u24 v1, 10, v15
    v_sub_u32 v14, v14, v1
    v_and_b32 v2, 4, v15
    v_and_b32 v1, 0x13, v15
    v_lshl_or_b32 v1, v2, 1, v1
    v_and_b32 v2, 8, v15
    v_lshrrev_b32 v2, 1, v2
    v_or_b32 v1, v1, v2
    v_mul_u32_u24 v1, 3840, v1
    v_add_u32 v1, s72, v1
    v_lshl_add_u32 v17, v14, 4, v1
    v_add_u32 v14, 128, v0
    v_mul_u32_u24 v15, 205, v14
    v_lshrrev_b32 v15, 11, v15
    v_mul_u32_u24 v1, 10, v15
    v_sub_u32 v14, v14, v1
    v_and_b32 v2, 4, v15
    v_and_b32 v1, 0x13, v15
    v_lshl_or_b32 v1, v2, 1, v1
    v_and_b32 v2, 8, v15
    v_lshrrev_b32 v2, 1, v2
    v_or_b32 v1, v1, v2
    v_mul_u32_u24 v1, 3840, v1
    v_add_u32 v1, s72, v1
    v_lshl_add_u32 v18, v14, 4, v1
    v_add_u32 v14, 192, v0
    v_mul_u32_u24 v15, 205, v14
    v_lshrrev_b32 v15, 11, v15
    v_mul_u32_u24 v1, 10, v15
    v_sub_u32 v14, v14, v1
    v_and_b32 v2, 4, v15
    v_and_b32 v1, 0x13, v15
    v_lshl_or_b32 v1, v2, 1, v1
    v_and_b32 v2, 8, v15
    v_lshrrev_b32 v2, 1, v2
    v_or_b32 v1, v1, v2
    v_mul_u32_u24 v1, 3840, v1
    v_add_u32 v1, s72, v1
    v_lshl_add_u32 v19, v14, 4, v1
    v_add_u32 v14, 256, v0
    v_mul_u32_u24 v15, 205, v14
    v_lshrrev_b32 v15, 11, v15
    v_mul_u32_u24 v1, 10, v15
    v_sub_u32 v14, v14, v1
    v_and_b32 v2, 4, v15
    v_and_b32 v1, 0x13, v15
    v_lshl_or_b32 v1, v2, 1, v1
    v_and_b32 v2, 8, v15
    v_lshrrev_b32 v2, 1, v2
    v_or_b32 v1, v1, v2
    v_mul_u32_u24 v1, 3840, v1
    v_add_u32 v1, s72, v1
    v_lshl_add_u32 v20, v14, 4, v1
    s_mul_i32 s11, s14, 245760
    s_mul_i32 s7, s15, 5120
    s_add_u32 s7, s7, 98304
    s_add_u32 m0, s9, s7
    s_nop 0
    buffer_load_dwordx4 v16, s[44:47], s11 offen lds
    s_add_u32 m0, m0, 1024
    s_nop 0
    buffer_load_dwordx4 v17, s[44:47], s11 offen lds
    s_add_u32 m0, m0, 1024
    s_nop 0
    buffer_load_dwordx4 v18, s[44:47], s11 offen lds
    s_add_u32 m0, m0, 1024
    s_nop 0
    buffer_load_dwordx4 v19, s[44:47], s11 offen lds
    s_add_u32 m0, m0, 1024
    s_nop 0
    buffer_load_dwordx4 v20, s[44:47], s11 offen lds
    s_add_u32 s11, s11, 122880
    s_cmp_eq_u32 s11, 2457600
    s_cselect_b32 s11, 0, s11
    s_add_u32 s9, s9, 10240
    s_cmp_eq_u32 s9, 51200
    s_cselect_b32 s9, 0, s9
    v_lshlrev_b32 v14, 4, v0
    s_lshl_b32 s73, s15, 12
    s_add_u32 m0, s73, 151552
    s_nop 0
    buffer_load_dwordx4 v14, s[52:55], s73 offen lds
    s_add_u32 m0, m0, 1024
    s_add_u32 s73, s73, 1024
    buffer_load_dwordx4 v14, s[52:55], s73 offen lds
    s_add_u32 m0, m0, 1024
    s_add_u32 s73, s73, 1024
    buffer_load_dwordx4 v14, s[52:55], s73 offen lds
    s_add_u32 m0, m0, 1024
    s_add_u32 s73, s73, 1024
    buffer_load_dwordx4 v14, s[52:55], s73 offen lds
    s_add_u32 m0, m0, 1024
    s_add_u32 s73, s73, 1024
    s_add_u32 m0, s9, s7
    s_nop 0
    buffer_load_dwordx4 v16, s[44:47], s11 offen lds
    s_add_u32 m0, m0, 1024
    s_nop 0
    buffer_load_dwordx4 v17, s[44:47], s11 offen lds
    s_add_u32 m0, m0, 1024
    s_nop 0
    buffer_load_dwordx4 v18, s[44:47], s11 offen lds
    s_add_u32 m0, m0, 1024
    s_nop 0
    buffer_load_dwordx4 v19, s[44:47], s11 offen lds
    s_add_u32 m0, m0, 1024
    s_nop 0
    buffer_load_dwordx4 v20, s[44:47], s11 offen lds
    s_add_u32 s11, s11, 122880
    s_cmp_eq_u32 s11, 2457600
    s_cselect_b32 s11, 0, s11
    s_add_u32 s9, s9, 10240
    s_cmp_eq_u32 s9, 51200
    s_cselect_b32 s9, 0, s9
    s_mov_b32 s84, s30
    s_and_b32 s85, s31, 0xffff
    s_mov_b32 s86, 0x21c000
    s_mov_b32 s87, 0x20000
    s_mov_b32 s88, s22
    s_and_b32 s89, s23, 0xffff
    s_mov_b32 s90, 0xc8000
    s_mov_b32 s91, 0x20000
    s_add_u32 s92, s38, 0x1000000
    s_addc_u32 s93, s39, 0
    s_and_b32 s93, s93, 0xffff
    s_mov_b32 s94, 0x2e4000
    s_mov_b32 s95, 0x20000
    s_mov_b32 s56, s32
    s_and_b32 s57, s33, 0xffff
    s_mov_b32 s58, 0x500
    s_mov_b32 s59, 0x20000
    s_add_u32 s60, s38, 0xe30000
    s_addc_u32 s61, s39, 0
    s_and_b32 s61, s61, 0xffff
    s_mov_b32 s62, 0x2000
    s_mov_b32 s63, 0x20000
    s_add_u32 s64, s38, 0xe20000
    s_addc_u32 s65, s39, 0
    s_and_b32 s65, s65, 0xffff
    s_mov_b32 s66, 0x400
    s_mov_b32 s67, 0x20000
    v_add_u32 v15, 0, v0
    v_mul_u32_u24 v14, 205, v15
    v_lshrrev_b32 v14, 11, v14
    v_mul_u32_u24 v1, 10, v14
    v_sub_u32 v15, v15, v1
    v_lshlrev_b32 v15, 4, v15
    v_and_b32 v1, 7, v14
    v_and_b32 v2, 8, v14
    v_lshl_or_b32 v1, v2, 1, v1
    v_and_b32 v2, 16, v14
    v_lshrrev_b32 v2, 1, v2
    v_or_b32 v1, v1, v2
    v_mul_u32_u24 v1, 1280, v1
    v_add_u32 v32, v1, v15
    v_bfe_u32 v2, v14, 3, 1
    v_and_b32 v3, 3, v14
    v_lshl_add_u32 v2, v2, 2, v3
    v_mul_u32_u24 v2, 20, v2
    v_lshrrev_b32 v3, 4, v14
    v_bfe_u32 v4, v14, 2, 1
    v_lshl_add_u32 v3, v3, 1, v4
    v_bfe_u32 v4, v14, 3, 1
    v_mul_u32_u24 v4, 20, v4
    v_lshl_add_u32 v4, v3, 2, v4
    v_and_b32 v1, 3, v14
    v_add_u32 v4, v4, v1
    v_add3_u32 v3, v3, v2, 16
    v_mul_u32_u24 v4, 1280, v4
    v_mul_u32_u24 v3, 1280, v3
    v_add_u32 v37, v4, v15
    v_add_u32 v42, v3, v15
    v_add_u32 v15, 64, v0
    v_mul_u32_u24 v14, 205, v15
    v_lshrrev_b32 v14, 11, v14
    v_mul_u32_u24 v1, 10, v14
    v_sub_u32 v15, v15, v1
    v_lshlrev_b32 v15, 4, v15
    v_and_b32 v1, 7, v14
    v_and_b32 v2, 8, v14
    v_lshl_or_b32 v1, v2, 1, v1
    v_and_b32 v2, 16, v14
    v_lshrrev_b32 v2, 1, v2
    v_or_b32 v1, v1, v2
    v_mul_u32_u24 v1, 1280, v1
    v_add_u32 v33, v1, v15
    v_bfe_u32 v2, v14, 3, 1
    v_and_b32 v3, 3, v14
    v_lshl_add_u32 v2, v2, 2, v3
    v_mul_u32_u24 v2, 20, v2
    v_lshrrev_b32 v3, 4, v14
    v_bfe_u32 v4, v14, 2, 1
    v_lshl_add_u32 v3, v3, 1, v4
    v_bfe_u32 v4, v14, 3, 1
    v_mul_u32_u24 v4, 20, v4
    v_lshl_add_u32 v4, v3, 2, v4
    v_and_b32 v1, 3, v14
    v_add_u32 v4, v4, v1
    v_add3_u32 v3, v3, v2, 16
    v_mul_u32_u24 v4, 1280, v4
    v_mul_u32_u24 v3, 1280, v3
    v_add_u32 v38, v4, v15
    v_add_u32 v43, v3, v15
    v_add_u32 v15, 128, v0
    v_mul_u32_u24 v14, 205, v15
    v_lshrrev_b32 v14, 11, v14
    v_mul_u32_u24 v1, 10, v14
    v_sub_u32 v15, v15, v1
    v_lshlrev_b32 v15, 4, v15
    v_and_b32 v1, 7, v14
    v_and_b32 v2, 8, v14
    v_lshl_or_b32 v1, v2, 1, v1
    v_and_b32 v2, 16, v14
    v_lshrrev_b32 v2, 1, v2
    v_or_b32 v1, v1, v2
    v_mul_u32_u24 v1, 1280, v1
    v_add_u32 v34, v1, v15
    v_bfe_u32 v2, v14, 3, 1
    v_and_b32 v3, 3, v14
    v_lshl_add_u32 v2, v2, 2, v3
    v_mul_u32_u24 v2, 20, v2
    v_lshrrev_b32 v3, 4, v14
    v_bfe_u32 v4, v14, 2, 1
    v_lshl_add_u32 v3, v3, 1, v4
    v_bfe_u32 v4, v14, 3, 1
    v_mul_u32_u24 v4, 20, v4
    v_lshl_add_u32 v4, v3, 2, v4
    v_and_b32 v1, 3, v14
    v_add_u32 v4, v4, v1
    v_add3_u32 v3, v3, v2, 16
    v_mul_u32_u24 v4, 1280, v4
    v_mul_u32_u24 v3, 1280, v3
    v_add_u32 v39, v4, v15
    v_add_u32 v44, v3, v15
    v_add_u32 v15, 192, v0
    v_mul_u32_u24 v14, 205, v15
    v_lshrrev_b32 v14, 11, v14
    v_mul_u32_u24 v1, 10, v14
    v_sub_u32 v15, v15, v1
    v_lshlrev_b32 v15, 4, v15
    v_and_b32 v1, 7, v14
    v_and_b32 v2, 8, v14
    v_lshl_or_b32 v1, v2, 1, v1
    v_and_b32 v2, 16, v14
    v_lshrrev_b32 v2, 1, v2
    v_or_b32 v1, v1, v2
    v_mul_u32_u24 v1, 1280, v1
    v_add_u32 v35, v1, v15
    v_bfe_u32 v2, v14, 3, 1
    v_and_b32 v3, 3, v14
    v_lshl_add_u32 v2, v2, 2, v3
    v_mul_u32_u24 v2, 20, v2
    v_lshrrev_b32 v3, 4, v14
    v_bfe_u32 v4, v14, 2, 1
    v_lshl_add_u32 v3, v3, 1, v4
    v_bfe_u32 v4, v14, 3, 1
    v_mul_u32_u24 v4, 20, v4
    v_lshl_add_u32 v4, v3, 2, v4
    v_and_b32 v1, 3, v14
    v_add_u32 v4, v4, v1
    v_add3_u32 v3, v3, v2, 16
    v_mul_u32_u24 v4, 1280, v4
    v_mul_u32_u24 v3, 1280, v3
    v_add_u32 v40, v4, v15
    v_add_u32 v45, v3, v15
    v_add_u32 v15, 256, v0
    v_mul_u32_u24 v14, 205, v15
    v_lshrrev_b32 v14, 11, v14
    v_mul_u32_u24 v1, 10, v14
    v_sub_u32 v15, v15, v1
    v_lshlrev_b32 v15, 4, v15
    v_and_b32 v1, 7, v14
    v_and_b32 v2, 8, v14
    v_lshl_or_b32 v1, v2, 1, v1
    v_and_b32 v2, 16, v14
    v_lshrrev_b32 v2, 1, v2
    v_or_b32 v1, v1, v2
    v_mul_u32_u24 v1, 1280, v1
    v_add_u32 v36, v1, v15
    v_bfe_u32 v2, v14, 3, 1
    v_and_b32 v3, 3, v14
    v_lshl_add_u32 v2, v2, 2, v3
    v_mul_u32_u24 v2, 20, v2
    v_lshrrev_b32 v3, 4, v14
    v_bfe_u32 v4, v14, 2, 1
    v_lshl_add_u32 v3, v3, 1, v4
    v_bfe_u32 v4, v14, 3, 1
    v_mul_u32_u24 v4, 20, v4
    v_lshl_add_u32 v4, v3, 2, v4
    v_and_b32 v1, 3, v14
    v_add_u32 v4, v4, v1
    v_add3_u32 v3, v3, v2, 16
    v_mul_u32_u24 v4, 1280, v4
    v_mul_u32_u24 v3, 1280, v3
    v_add_u32 v41, v4, v15
    v_add_u32 v46, v3, v15
    s_and_b32 s81, s6, 3
    s_mul_i32 s81, s81, 5120
    s_add_u32 s81, s81, 32768
    v_lshrrev_b32 v14, 1, v11
    v_lshlrev_b32 v14, 4, v14
    v_and_b32 v15, 1, v11
    v_lshl_add_u32 v14, v15, 2, v14
    v_add_u32 v14, v14, v12
    v_mul_u32_u24 v14, 160, v14
    v_add_u32 v14, s81, v14
    v_lshl_add_u32 v47, v13, 4, v14
    v_lshl_add_u32 v31, v13, 3, v14
    v_lshlrev_b32 v48, 4, v0
    v_lshlrev_b32 v51, 4, v10
    v_mul_u32_u24 v49, 1280, v11
    v_add_u32 v49, v49, v51
    v_lshlrev_b32 v1, 2, v11
    v_mov_b32 v2, 0x40000000
    v_cmp_eq_u32 vcc, 0, v10
    s_nop 1
    v_cndmask_b32 v50, v2, v1, vcc
    v_mov_b32 v112, 0
    v_mov_b32 v113, 0
    v_mov_b32 v114, 0
    v_mov_b32 v115, 0
    s_lshl_b32 s76, s3, 2
    s_add_u32 s76, s76, s6
    s_sub_u32 s76, s76, 264
    s_lshl_b32 s82, s76, 10
    s_cmp_lt_u32 s76, 512
    s_cselect_b32 s80, s76, 0x20000
    s_and_b32 s72, s76, 7
    s_lshr_b32 s73, s76, 3
    s_mul_i32 s77, s72, 74
    s_add_u32 s77, s77, s73
    s_mul_i32 s77, s77, 5120
    s_mul_i32 s72, s72, 160
    s_mul_i32 s78, s73, 40960
    s_add_u32 s78, s78, s72
    s_mov_b32 s79, 0
    s_cmp_lt_u32 s73, 54
    s_cbranch_scc1 L_rps_done_3071
    s_sub_u32 s73, s73, 54
    s_mul_i32 s74, s73, 52
    s_lshr_b32 s74, s74, 8
    s_mul_i32 s78, s74, 5
    s_sub_u32 s73, s73, s78
    s_mul_i32 s78, s74, 204800
    s_add_u32 s78, s78, s72
    s_mul_i32 s74, s73, 51200
    s_cmp_eq_u32 s73, 4
    s_cselect_b32 s74, 0, s74
    s_cselect_b32 s79, 2, 1
    s_add_u32 s78, s78, s74
L_rps_done_3071:
    s_cmp_lt_u32 s76, 592
    s_cselect_b32 s78, s78, 0x40000000
    s_cselect_b32 s77, s77, 0x40000000
    s_waitcnt vmcnt(5)
    s_barrier
    s_add_u32 m0, s9, s7
    s_nop 0
    buffer_load_dwordx4 v16, s[44:47], s11 offen lds
    s_add_u32 m0, m0, 1024
    s_nop 0
    buffer_load_dwordx4 v17, s[44:47], s11 offen lds
    s_add_u32 m0, m0, 1024
    s_nop 0
    buffer_load_dwordx4 v18, s[44:47], s11 offen lds
    s_add_u32 m0, m0, 1024
    s_nop 0
    buffer_load_dwordx4 v19, s[44:47], s11 offen lds
    s_add_u32 m0, m0, 1024
    s_nop 0
    buffer_load_dwordx4 v20, s[44:47], s11 offen lds
    s_add_u32 s11, s11, 122880
    s_cmp_eq_u32 s11, 2457600
    s_cselect_b32 s11, 0, s11
    s_add_u32 s9, s9, 10240
    s_cmp_eq_u32 s9, 51200
    s_cselect_b32 s9, 0, s9
    s_add_u32 m0, s9, s7
    s_nop 0
    buffer_load_dwordx4 v16, s[44:47], s11 offen lds
    s_add_u32 m0, m0, 1024
    s_nop 0
    buffer_load_dwordx4 v17, s[44:47], s11 offen lds
    s_add_u32 m0, m0, 1024
    s_nop 0
    buffer_load_dwordx4 v18, s[44:47], s11 offen lds
    s_add_u32 m0, m0, 1024
    s_nop 0
    buffer_load_dwordx4 v19, s[44:47], s11 offen lds
    s_add_u32 m0, m0, 1024
    s_nop 0
    buffer_load_dwordx4 v20, s[44:47], s11 offen lds
    s_add_u32 s11, s11, 122880
    s_cmp_eq_u32 s11, 2457600
    s_cselect_b32 s11, 0, s11
    s_add_u32 s9, s9, 10240
    s_cmp_eq_u32 s9, 51200
    s_cselect_b32 s9, 0, s9
L_k1_ldw_loop_q:
    s_waitcnt vmcnt(10)
    s_barrier
    s_add_u32 m0, s9, s7
    s_nop 0
    buffer_load_dwordx4 v16, s[44:47], s11 offen lds
    s_add_u32 m0, m0, 1024
    s_nop 0
    buffer_load_dwordx4 v17, s[44:47], s11 offen lds
    s_add_u32 m0, m0, 1024
    s_nop 0
    buffer_load_dwordx4 v18, s[44:47], s11 offen lds
    s_add_u32 m0, m0, 1024
    s_nop 0
    buffer_load_dwordx4 v19, s[44:47], s11 offen lds
    s_add_u32 m0, m0, 1024
    s_nop 0
    buffer_load_dwordx4 v20, s[44:47], s11 offen lds
    s_add_u32 s11, s11, 122880
    s_cmp_eq_u32 s11, 2457600
    s_cselect_b32 s11, 0, s11
    s_add_u32 s9, s9, 10240
    s_cmp_eq_u32 s9, 51200
    s_cselect_b32 s9, 0, s9
    s_add_u32 s12, s12, 1
    s_cmp_lt_u32 s12, 16
    s_cbranch_scc1 L_k1_ldw_loop_q
    s_waitcnt vmcnt(10)
    s_barrier
    s_branch L_k1_rp
L_k1_kv:
    s_cmp_ge_u32 s6, 8
    s_cbranch_scc1 L_k1_ld_kv
    v_lshrrev_b32 v14, 1, v11
    v_lshlrev_b32 v14, 4, v14
    v_and_b32 v96, 1, v11
    v_lshl_add_u32 v14, v96, 2, v14
    v_add_u32 v14, v14, v12
    v_mul_u32_u24 v14, 160, v14
    v_mul_u32_u24 v15, 40, v13
    s_mul_i32 s72, s7, 5120
    s_add_u32 s72, s72, 98304
    v_add3_u32 v5, v14, v15, s72
    v_lshrrev_b32 v14, 1, v10
    v_xor_b32 v15, v14, v11
    v_lshlrev_b32 v14, 7, v10
    v_lshl_add_u32 v14, v15, 4, v14
    s_mul_i32 s72, s15, 8192
    v_add_u32 v1, s72, v14
    v_xor_b32 v2, 64, v1
    v_mov_b32 v3, v1
    v_mov_b32 v8, v5
    s_mov_b32 s8, 10240
    s_mov_b32 s13, 0
    s_mov_b32 s12, 0
    v_mov_b32 v16, 0
    v_mov_b32 v17, 0
    v_mov_b32 v18, 0
    v_mov_b32 v19, 0
    v_mov_b32 v20, 0
    v_mov_b32 v21, 0
    v_mov_b32 v22, 0
    v_mov_b32 v23, 0
    v_mov_b32 v24, 0
    v_mov_b32 v25, 0
    v_mov_b32 v26, 0
    v_mov_b32 v27, 0
    v_mov_b32 v28, 0
    v_mov_b32 v29, 0
    v_mov_b32 v30, 0
    v_mov_b32 v31, 0
    v_mov_b32 v32, 0
    v_mov_b32 v33, 0
    v_mov_b32 v34, 0
    v_mov_b32 v35, 0
    v_mov_b32 v36, 0
    v_mov_b32 v37, 0
    v_mov_b32 v38, 0
    v_mov_b32 v39, 0
    v_mov_b32 v40, 0
    v_mov_b32 v41, 0
    v_mov_b32 v42, 0
    v_mov_b32 v43, 0
    v_mov_b32 v44, 0
    v_mov_b32 v45, 0
    v_mov_b32 v46, 0
    v_mov_b32 v47, 0
    v_mov_b32 v48, 0
    v_mov_b32 v49, 0
    v_mov_b32 v50, 0
    v_mov_b32 v51, 0
    v_mov_b32 v52, 0
    v_mov_b32 v53, 0
    v_mov_b32 v54, 0
    v_mov_b32 v55, 0
    v_mov_b32 v56, 0
    v_mov_b32 v57, 0
    v_mov_b32 v58, 0
    v_mov_b32 v59, 0
    v_mov_b32 v60, 0
    v_mov_b32 v61, 0
    v_mov_b32 v62, 0
    v_mov_b32 v63, 0
    v_mov_b32 v64, 0
    v_mov_b32 v65, 0
    v_mov_b32 v66, 0
    v_mov_b32 v67, 0
    v_mov_b32 v68, 0
    v_mov_b32 v69, 0
    v_mov_b32 v70, 0
    v_mov_b32 v71, 0
    v_mov_b32 v72, 0
    v_mov_b32 v73, 0
    v_mov_b32 v74, 0
    v_mov_b32 v75, 0
    v_mov_b32 v76, 0
    v_mov_b32 v77, 0
    v_mov_b32 v78, 0
    v_mov_b32 v79, 0
    v_mov_b32 v80, 0
    v_mov_b32 v81, 0
    v_mov_b32 v82, 0
    v_mov_b32 v83, 0
    v_mov_b32 v84, 0
    v_mov_b32 v85, 0
    v_mov_b32 v86, 0
    v_mov_b32 v87, 0
    v_mov_b32 v88, 0
    v_mov_b32 v89, 0
    v_mov_b32 v90, 0
    v_mov_b32 v91, 0
    v_mov_b32 v92, 0
    v_mov_b32 v93, 0
    v_mov_b32 v94, 0
    v_mov_b32 v95, 0
    s_add_u32 s48, s38, 0xc00000
    s_addc_u32 s49, s39, 0
    s_and_b32 s49, s49, 0xffff
    s_mov_b32 s50, 0x140000
    s_mov_b32 s51, 0x20000
    s_barrier
    ds_read_b128 v[96:99], v3 offset:0
    ds_read_b128 v[100:103], v3 offset:2048
    ds_read_b128 v[104:107], v3 offset:4096
    ds_read_b128 v[108:111], v3 offset:6144
    ds_read_b64_tr_b16 v[128:129], v8 offset:0
    ds_read_b64_tr_b16 v[130:131], v8 offset:1280
    ds_read_b64_tr_b16 v[132:133], v8 offset:8
    ds_read_b64_tr_b16 v[134:135], v8 offset:1288
    ds_read_b64_tr_b16 v[136:137], v8 offset:16
    ds_read_b64_tr_b16 v[138:139], v8 offset:1296
    ds_read_b64_tr_b16 v[140:141], v8 offset:24
    ds_read_b64_tr_b16 v[142:143], v8 offset:1304
    s_waitcnt lgkmcnt(0)
    s_nop 7
    s_nop 3
L_k1_loop_kv:
    s_waitcnt lgkmcnt(6)
    v_mfma_f32_16x16x32_bf16 v[16:19], v[128:131], v[96:99], v[16:19]
    ds_read_b64_tr_b16 v[144:145], v8 offset:32
    v_mfma_f32_16x16x32_bf16 v[36:39], v[128:131], v[100:103], v[36:39]
    ds_read_b64_tr_b16 v[146:147], v8 offset:1312
    v_mfma_f32_16x16x32_bf16 v[56:59], v[128:131], v[104:107], v[56:59]
    s_barrier
    v_add_u32 v4, s13, v2
    v_add_u32 v9, s8, v5
    v_mfma_f32_16x16x32_bf16 v[76:79], v[128:131], v[108:111], v[76:79]
    s_add_u32 s8, s8, 10240
    s_cmp_eq_u32 s8, 51200
    s_cselect_b32 s8, 0, s8
    s_waitcnt lgkmcnt(6)
    v_mfma_f32_16x16x32_bf16 v[20:23], v[132:135], v[96:99], v[20:23]
    ds_read_b128 v[112:115], v4 offset:0
    v_mfma_f32_16x16x32_bf16 v[40:43], v[132:135], v[100:103], v[40:43]
    ds_read_b128 v[116:119], v4 offset:2048
    v_mfma_f32_16x16x32_bf16 v[60:63], v[132:135], v[104:107], v[60:63]
    ds_read_b64_tr_b16 v[128:129], v9 offset:0
    v_mfma_f32_16x16x32_bf16 v[80:83], v[132:135], v[108:111], v[80:83]
    ds_read_b64_tr_b16 v[130:131], v9 offset:1280
    s_waitcnt lgkmcnt(8)
    v_mfma_f32_16x16x32_bf16 v[24:27], v[136:139], v[96:99], v[24:27]
    ds_read_b128 v[120:123], v4 offset:4096
    v_mfma_f32_16x16x32_bf16 v[44:47], v[136:139], v[100:103], v[44:47]
    ds_read_b128 v[124:127], v4 offset:6144
    v_mfma_f32_16x16x32_bf16 v[64:67], v[136:139], v[104:107], v[64:67]
    ds_read_b64_tr_b16 v[132:133], v9 offset:8
    v_mfma_f32_16x16x32_bf16 v[84:87], v[136:139], v[108:111], v[84:87]
    ds_read_b64_tr_b16 v[134:135], v9 offset:1288
    s_waitcnt lgkmcnt(10)
    v_mfma_f32_16x16x32_bf16 v[28:31], v[140:143], v[96:99], v[28:31]
    ds_read_b64_tr_b16 v[136:137], v9 offset:16
    v_mfma_f32_16x16x32_bf16 v[48:51], v[140:143], v[100:103], v[48:51]
    ds_read_b64_tr_b16 v[138:139], v9 offset:1296
    v_mfma_f32_16x16x32_bf16 v[68:71], v[140:143], v[104:107], v[68:71]
    v_mfma_f32_16x16x32_bf16 v[88:91], v[140:143], v[108:111], v[88:91]
    s_waitcnt lgkmcnt(10)
    v_mfma_f32_16x16x32_bf16 v[32:35], v[144:147], v[96:99], v[32:35]
    ds_read_b64_tr_b16 v[140:141], v9 offset:24
    v_mfma_f32_16x16x32_bf16 v[52:55], v[144:147], v[100:103], v[52:55]
    ds_read_b64_tr_b16 v[142:143], v9 offset:1304
    v_mfma_f32_16x16x32_bf16 v[72:75], v[144:147], v[104:107], v[72:75]
    v_mfma_f32_16x16x32_bf16 v[92:95], v[144:147], v[108:111], v[92:95]
    s_waitcnt lgkmcnt(6)
    v_mfma_f32_16x16x32_bf16 v[16:19], v[128:131], v[112:115], v[16:19]
    ds_read_b64_tr_b16 v[144:145], v9 offset:32
    v_mfma_f32_16x16x32_bf16 v[36:39], v[128:131], v[116:119], v[36:39]
    ds_read_b64_tr_b16 v[146:147], v9 offset:1312
    v_mfma_f32_16x16x32_bf16 v[56:59], v[128:131], v[120:123], v[56:59]
    s_add_u32 s13, s13, 32768
    s_cmp_eq_u32 s13, 98304
    s_cselect_b32 s13, 0, s13
    s_barrier
    v_add_u32 v3, s13, v1
    v_add_u32 v8, s8, v5
    v_mfma_f32_16x16x32_bf16 v[76:79], v[128:131], v[124:127], v[76:79]
    s_add_u32 s8, s8, 10240
    s_cmp_eq_u32 s8, 51200
    s_cselect_b32 s8, 0, s8
    s_waitcnt lgkmcnt(6)
    v_mfma_f32_16x16x32_bf16 v[20:23], v[132:135], v[112:115], v[20:23]
    ds_read_b128 v[96:99], v3 offset:0
    v_mfma_f32_16x16x32_bf16 v[40:43], v[132:135], v[116:119], v[40:43]
    ds_read_b128 v[100:103], v3 offset:2048
    v_mfma_f32_16x16x32_bf16 v[60:63], v[132:135], v[120:123], v[60:63]
    ds_read_b64_tr_b16 v[128:129], v8 offset:0
    v_mfma_f32_16x16x32_bf16 v[80:83], v[132:135], v[124:127], v[80:83]
    ds_read_b64_tr_b16 v[130:131], v8 offset:1280
    s_waitcnt lgkmcnt(8)
    v_mfma_f32_16x16x32_bf16 v[24:27], v[136:139], v[112:115], v[24:27]
    ds_read_b128 v[104:107], v3 offset:4096
    v_mfma_f32_16x16x32_bf16 v[44:47], v[136:139], v[116:119], v[44:47]
    ds_read_b128 v[108:111], v3 offset:6144
    v_mfma_f32_16x16x32_bf16 v[64:67], v[136:139], v[120:123], v[64:67]
    ds_read_b64_tr_b16 v[132:133], v8 offset:8
    v_mfma_f32_16x16x32_bf16 v[84:87], v[136:139], v[124:127], v[84:87]
    ds_read_b64_tr_b16 v[134:135], v8 offset:1288
    s_waitcnt lgkmcnt(10)
    v_mfma_f32_16x16x32_bf16 v[28:31], v[140:143], v[112:115], v[28:31]
    ds_read_b64_tr_b16 v[136:137], v8 offset:16
    v_mfma_f32_16x16x32_bf16 v[48:51], v[140:143], v[116:119], v[48:51]
    ds_read_b64_tr_b16 v[138:139], v8 offset:1296
    v_mfma_f32_16x16x32_bf16 v[68:71], v[140:143], v[120:123], v[68:71]
    v_mfma_f32_16x16x32_bf16 v[88:91], v[140:143], v[124:127], v[88:91]
    s_waitcnt lgkmcnt(10)
    v_mfma_f32_16x16x32_bf16 v[32:35], v[144:147], v[112:115], v[32:35]
    ds_read_b64_tr_b16 v[140:141], v8 offset:24
    v_mfma_f32_16x16x32_bf16 v[52:55], v[144:147], v[116:119], v[52:55]
    ds_read_b64_tr_b16 v[142:143], v8 offset:1304
    v_mfma_f32_16x16x32_bf16 v[72:75], v[144:147], v[120:123], v[72:75]
    v_mfma_f32_16x16x32_bf16 v[92:95], v[144:147], v[124:127], v[92:95]
    s_add_u32 s12, s12, 1
    s_cmp_lt_u32 s12, 10
    s_cbranch_scc1 L_k1_loop_kv
    s_nop 7
    s_nop 3
    s_waitcnt vmcnt(0) lgkmcnt(0)
    s_mul_i32 s72, s5, 16
    s_mul_i32 s73, s15, 4
    s_add_u32 s72, s72, s73
    s_mov_b32 s98, 0x3fb8aa3b
    v_mul_u32_u24 v14, 800, v11
    v_mul_u32_u24 v15, 40, v12
    s_mov_b32 s73, 151552
    v_add3_u32 v14, v14, v15, s73
    v_mov_b32 v15, 157952
    v_cmp_eq_u32 vcc, v13, v11
    s_nop 1
    v_cndmask_b32 v14, v15, v14, vcc
    ds_read_b64_tr_b16 v[96:97], v14 offset:0
    ds_read_b64_tr_b16 v[98:99], v14 offset:160
    ds_read_b64_tr_b16 v[100:101], v14 offset:8
    ds_read_b64_tr_b16 v[102:103], v14 offset:168
    ds_read_b64_tr_b16 v[104:105], v14 offset:16
    ds_read_b64_tr_b16 v[106:107], v14 offset:176
    ds_read_b64_tr_b16 v[108:109], v14 offset:24
    ds_read_b64_tr_b16 v[110:111], v14 offset:184
    ds_read_b64_tr_b16 v[112:113], v14 offset:32
    ds_read_b64_tr_b16 v[114:115], v14 offset:192
    v_lshrrev_b32 v136, 1, v11
    v_lshlrev_b32 v136, 3, v136
    v_and_b32 v4, 1, v11
    v_lshl_add_u32 v136, v4, 2, v136
    v_add_u32 v136, v136, v12
    v_lshlrev_b32 v136, 1, v136
    s_and_b32 s8, s6, 3
    s_lshr_b32 s13, s6, 2
    s_xor_b32 s13, s13, 1
    s_mul_i32 s74, s8, 80
    v_mul_u32_u24 v3, 336, v136
    v_lshl_add_u32 v3, v13, 3, v3
    v_add_u32 v3, s74, v3
    v_add_u32 v4, 43008, v3
    s_mul_i32 s74, s8, 40
    s_lshl_b32 s10, s13, 5
    s_add_u32 s74, s74, s10
    s_add_u32 s74, s74, 86016
    v_mul_u32_u24 v5, 176, v136
    v_lshl_add_u32 v5, v13, 3, v5
    v_add_u32 v5, s74, v5
    s_lshl_b32 s74, s5, 5
    s_lshl_b32 s10, s99, 2
    s_add_u32 s74, s74, s10
    s_add_u32 s74, s74, s8
    s_mul_i32 s9, s74, 5120
    v_mov_b32 v137, 0x40000000
    s_lshl_b32 s10, s13, 1
    v_lshlrev_b32 v138, s10, v10
    v_and_b32 v139, 1, v11
    v_lshlrev_b32 v139, 2, v139
    v_lshrrev_b32 v136, 1, v11
    v_lshl_add_u32 v136, v136, 7, v139
    s_lshl_b32 s10, s13, 9
    v_lshl_add_u32 v6, v138, 3, v136
    v_add_u32 v6, s10, v6
    v_lshlrev_b32 v6, 2, v6
    s_lshl_b32 s10, s13, 7
    s_add_u32 s10, s10, 1024
    v_lshl_add_u32 v7, v138, 3, v139
    v_add_u32 v7, s10, v7
    v_lshlrev_b32 v7, 2, v7
    v_cmp_gt_u32 vcc, 16, v138
    s_nop 1
    v_cndmask_b32 v6, v137, v6, vcc
    v_cndmask_b32 v7, v137, v7, vcc
    v_cmp_gt_u32 vcc, 2, v11
    s_nop 1
    v_cndmask_b32 v7, v137, v7, vcc
    v_lshl_add_u32 v8, v10, 3, v136
    v_add_u32 v8, 512, v8
    v_lshlrev_b32 v8, 2, v8
    v_lshl_add_u32 v9, v10, 3, v139
    v_add_u32 v9, 1152, v9
    v_lshlrev_b32 v9, 2, v9
    v_cndmask_b32 v9, v137, v9, vcc
    v_cmp_eq_u32 vcc, 1, v13
    s_nop 1
    v_cndmask_b32 v8, v137, v8, vcc
    v_cndmask_b32 v9, v137, v9, vcc
    s_barrier
    s_lshl_b32 s72, s15, 6
    v_add_u32 v15, s72, v10
    s_mul_i32 s72, s15, 5120
    s_add_u32 s72, s72, 131072
    v_lshlrev_b32 v166, 4, v0
    v_add_u32 v166, s72, v166
    s_nop 7
    s_nop 3
    s_cmp_eq_u32 s7, 0
    s_cbranch_scc1 L_k1_kv_k
    v_mul_u32_u24 v165, 176, v15
    v_mul_u32_u24 v1, 40, v11
    v_add3_u32 v165, v165, v1, 0
    v_add_u32 v165, 86016, v165
    v_cvt_pk_bf16_f32 v16, v16, v17
    v_cvt_pk_bf16_f32 v17, v18, v19
    v_cvt_pk_bf16_f32 v18, v20, v21
    v_cvt_pk_bf16_f32 v19, v22, v23
    v_cvt_pk_bf16_f32 v20, v24, v25
    v_cvt_pk_bf16_f32 v21, v26, v27
    v_cvt_pk_bf16_f32 v22, v28, v29
    v_cvt_pk_bf16_f32 v23, v30, v31
    v_cvt_pk_bf16_f32 v24, v32, v33
    v_cvt_pk_bf16_f32 v25, v34, v35
    ds_write_b64 v165, v[16:17] offset:0
    ds_write_b64 v165, v[18:19] offset:8
    ds_write_b64 v165, v[20:21] offset:16
    ds_write_b64 v165, v[22:23] offset:24
    ds_write_b64 v165, v[24:25] offset:32
    v_cvt_pk_bf16_f32 v36, v36, v37
    v_cvt_pk_bf16_f32 v37, v38, v39
    v_cvt_pk_bf16_f32 v38, v40, v41
    v_cvt_pk_bf16_f32 v39, v42, v43
    v_cvt_pk_bf16_f32 v40, v44, v45
    v_cvt_pk_bf16_f32 v41, v46, v47
    v_cvt_pk_bf16_f32 v42, v48, v49
    v_cvt_pk_bf16_f32 v43, v50, v51
    v_cvt_pk_bf16_f32 v44, v52, v53
    v_cvt_pk_bf16_f32 v45, v54, v55
    ds_write_b64 v165, v[36:37] offset:2816
    ds_write_b64 v165, v[38:39] offset:2824
    ds_write_b64 v165, v[40:41] offset:2832
    ds_write_b64 v165, v[42:43] offset:2840
    ds_write_b64 v165, v[44:45] offset:2848
    v_cvt_pk_bf16_f32 v56, v56, v57
    v_cvt_pk_bf16_f32 v57, v58, v59
    v_cvt_pk_bf16_f32 v58, v60, v61
    v_cvt_pk_bf16_f32 v59, v62, v63
    v_cvt_pk_bf16_f32 v60, v64, v65
    v_cvt_pk_bf16_f32 v61, v66, v67
    v_cvt_pk_bf16_f32 v62, v68, v69
    v_cvt_pk_bf16_f32 v63, v70, v71
    v_cvt_pk_bf16_f32 v64, v72, v73
    v_cvt_pk_bf16_f32 v65, v74, v75
    ds_write_b64 v165, v[56:57] offset:5632
    ds_write_b64 v165, v[58:59] offset:5640
    ds_write_b64 v165, v[60:61] offset:5648
    ds_write_b64 v165, v[62:63] offset:5656
    ds_write_b64 v165, v[64:65] offset:5664
    v_cvt_pk_bf16_f32 v76, v76, v77
    v_cvt_pk_bf16_f32 v77, v78, v79
    v_cvt_pk_bf16_f32 v78, v80, v81
    v_cvt_pk_bf16_f32 v79, v82, v83
    v_cvt_pk_bf16_f32 v80, v84, v85
    v_cvt_pk_bf16_f32 v81, v86, v87
    v_cvt_pk_bf16_f32 v82, v88, v89
    v_cvt_pk_bf16_f32 v83, v90, v91
    v_cvt_pk_bf16_f32 v84, v92, v93
    v_cvt_pk_bf16_f32 v85, v94, v95
    ds_write_b64 v165, v[76:77] offset:8448
    ds_write_b64 v165, v[78:79] offset:8456
    ds_write_b64 v165, v[80:81] offset:8464
    ds_write_b64 v165, v[82:83] offset:8472
    ds_write_b64 v165, v[84:85] offset:8480
    v_add_u32 v15, 32, v15
    s_barrier
    ds_read_b128 v[40:43], v166 offset:0
    ds_read_b128 v[44:47], v166 offset:1024
    ds_read_b128 v[48:51], v166 offset:2048
    ds_read_b128 v[52:55], v166 offset:3072
    ds_read_b128 v[56:59], v166 offset:4096
    s_waitcnt lgkmcnt(0)
    v_mov_b32 v16, v40
    v_mov_b32 v28, v50
    v_mov_b32 v17, v41
    v_mov_b32 v29, v51
    v_mov_b32 v18, v42
    v_mov_b32 v30, v52
    v_mov_b32 v19, v43
    v_mov_b32 v31, v53
    v_mov_b32 v20, v44
    v_mov_b32 v32, v54
    v_mov_b32 v21, v45
    v_mov_b32 v33, v55
    v_mov_b32 v22, v46
    v_mov_b32 v34, v56
    v_mov_b32 v23, v47
    v_mov_b32 v35, v57
    v_mov_b32 v24, v48
    v_mov_b32 v36, v58
    v_mov_b32 v25, v49
    v_mov_b32 v37, v59
    v_mov_b32 v26, 0
    v_mov_b32 v27, 0
    v_mov_b32 v38, 0
    v_mov_b32 v39, 0
    s_branch L_k1_kv_sm
L_k1_kv_k:
    v_cvt_pk_bf16_f32 v16, v16, v17
    v_cvt_pk_bf16_f32 v17, v18, v19
    v_cvt_pk_bf16_f32 v18, v20, v21
    v_cvt_pk_bf16_f32 v19, v22, v23
    v_cvt_pk_bf16_f32 v20, v24, v25
    v_cvt_pk_bf16_f32 v21, v26, v27
    v_cvt_pk_bf16_f32 v22, v28, v29
    v_cvt_pk_bf16_f32 v23, v30, v31
    v_cvt_pk_bf16_f32 v24, v32, v33
    v_cvt_pk_bf16_f32 v25, v34, v35
    v_cvt_pk_bf16_f32 v28, v36, v37
    v_cvt_pk_bf16_f32 v29, v38, v39
    v_cvt_pk_bf16_f32 v30, v40, v41
    v_cvt_pk_bf16_f32 v31, v42, v43
    v_cvt_pk_bf16_f32 v32, v44, v45
    v_cvt_pk_bf16_f32 v33, v46, v47
    v_cvt_pk_bf16_f32 v34, v48, v49
    v_cvt_pk_bf16_f32 v35, v50, v51
    v_cvt_pk_bf16_f32 v36, v52, v53
    v_cvt_pk_bf16_f32 v37, v54, v55
    v_cvt_pk_bf16_f32 v56, v56, v57
    v_cvt_pk_bf16_f32 v57, v58, v59
    v_cvt_pk_bf16_f32 v58, v60, v61
    v_cvt_pk_bf16_f32 v59, v62, v63
    v_cvt_pk_bf16_f32 v60, v64, v65
    v_cvt_pk_bf16_f32 v61, v66, v67
    v_cvt_pk_bf16_f32 v62, v68, v69
    v_cvt_pk_bf16_f32 v63, v70, v71
    v_cvt_pk_bf16_f32 v64, v72, v73
    v_cvt_pk_bf16_f32 v65, v74, v75
    v_cvt_pk_bf16_f32 v66, v76, v77
    v_cvt_pk_bf16_f32 v67, v78, v79
    v_cvt_pk_bf16_f32 v68, v80, v81
    v_cvt_pk_bf16_f32 v69, v82, v83
    v_cvt_pk_bf16_f32 v70, v84, v85
    v_cvt_pk_bf16_f32 v71, v86, v87
    v_cvt_pk_bf16_f32 v72, v88, v89
    v_cvt_pk_bf16_f32 v73, v90, v91
    v_cvt_pk_bf16_f32 v74, v92, v93
    v_cvt_pk_bf16_f32 v75, v94, v95
    ds_write_b128 v166, v[56:59] offset:0
    ds_write_b128 v166, v[60:63] offset:1024
    ds_write_b128 v166, v[64:67] offset:2048
    ds_write_b128 v166, v[68:71] offset:3072
    ds_write_b128 v166, v[72:75] offset:4096
    v_mov_b32 v26, 0
    v_mov_b32 v27, 0
    v_mov_b32 v38, 0
    v_mov_b32 v39, 0
    s_waitcnt lgkmcnt(0)
    s_barrier
L_k1_kv_sm:
    v_mul_u32_u24 v165, 336, v15
    v_mul_u32_u24 v1, 80, v11
    v_add_u32 v165, v165, v1
    v_mfma_f32_16x16x32_bf16 v[116:119], v[96:99], v[16:19], 0
    ds_read_b64_tr_b16 v[96:97], v14 offset:320
    ds_read_b64_tr_b16 v[98:99], v14 offset:480
    v_mfma_f32_16x16x32_bf16 v[120:123], v[100:103], v[16:19], 0
    ds_read_b64_tr_b16 v[100:101], v14 offset:328
    ds_read_b64_tr_b16 v[102:103], v14 offset:488
    v_mfma_f32_16x16x32_bf16 v[124:127], v[104:107], v[16:19], 0
    ds_read_b64_tr_b16 v[104:105], v14 offset:336
    ds_read_b64_tr_b16 v[106:107], v14 offset:496
    v_mfma_f32_16x16x32_bf16 v[128:131], v[108:111], v[16:19], 0
    ds_read_b64_tr_b16 v[108:109], v14 offset:344
    ds_read_b64_tr_b16 v[110:111], v14 offset:504
    v_mfma_f32_16x16x32_bf16 v[132:135], v[112:115], v[16:19], 0
    ds_read_b64_tr_b16 v[112:113], v14 offset:352
    ds_read_b64_tr_b16 v[114:115], v14 offset:512
    s_waitcnt lgkmcnt(8)
    v_mfma_f32_16x16x32_bf16 v[116:119], v[96:99], v[20:23], v[116:119]
    ds_read_b64_tr_b16 v[96:97], v14 offset:640
    s_waitcnt lgkmcnt(7)
    v_mfma_f32_16x16x32_bf16 v[120:123], v[100:103], v[20:23], v[120:123]
    ds_read_b64_tr_b16 v[100:101], v14 offset:648
    s_waitcnt lgkmcnt(6)
    v_mfma_f32_16x16x32_bf16 v[124:127], v[104:107], v[20:23], v[124:127]
    ds_read_b64_tr_b16 v[104:105], v14 offset:656
    s_waitcnt lgkmcnt(5)
    v_mfma_f32_16x16x32_bf16 v[128:131], v[108:111], v[20:23], v[128:131]
    ds_read_b64_tr_b16 v[108:109], v14 offset:664
    s_waitcnt lgkmcnt(4)
    v_mfma_f32_16x16x32_bf16 v[132:135], v[112:115], v[20:23], v[132:135]
    ds_read_b64_tr_b16 v[112:113], v14 offset:672
    s_waitcnt lgkmcnt(4)
    v_mfma_f32_16x16x32_bf16 v[116:119], v[96:99], v[24:27], v[116:119]
    ds_read_b64_tr_b16 v[96:97], v14 offset:0
    ds_read_b64_tr_b16 v[98:99], v14 offset:160
    s_waitcnt lgkmcnt(5)
    v_mfma_f32_16x16x32_bf16 v[120:123], v[100:103], v[24:27], v[120:123]
    ds_read_b64_tr_b16 v[100:101], v14 offset:8
    ds_read_b64_tr_b16 v[102:103], v14 offset:168
    s_waitcnt lgkmcnt(6)
    v_mfma_f32_16x16x32_bf16 v[124:127], v[104:107], v[24:27], v[124:127]
    ds_read_b64_tr_b16 v[104:105], v14 offset:16
    ds_read_b64_tr_b16 v[106:107], v14 offset:176
    s_waitcnt lgkmcnt(7)
    v_mfma_f32_16x16x32_bf16 v[128:131], v[108:111], v[24:27], v[128:131]
    ds_read_b64_tr_b16 v[108:109], v14 offset:24
    ds_read_b64_tr_b16 v[110:111], v14 offset:184
    s_waitcnt lgkmcnt(8)
    v_mfma_f32_16x16x32_bf16 v[132:135], v[112:115], v[24:27], v[132:135]
    ds_read_b64_tr_b16 v[112:113], v14 offset:32
    ds_read_b64_tr_b16 v[114:115], v14 offset:192
    v_max3_f32 v156, v116, v117, v118
    v_min3_f32 v158, v116, v117, v118
    v_max3_f32 v157, v119, v120, v121
    v_min3_f32 v159, v119, v120, v121
    v_max3_f32 v156, v156, v122, v123
    s_waitcnt lgkmcnt(8)
    v_mfma_f32_16x16x32_bf16 v[64:67], v[96:99], v[28:31], 0
    ds_read_b64_tr_b16 v[96:97], v14 offset:320
    ds_read_b64_tr_b16 v[98:99], v14 offset:480
    v_min3_f32 v158, v158, v122, v123
    v_max3_f32 v157, v157, v124, v125
    v_min3_f32 v159, v159, v124, v125
    v_max3_f32 v156, v156, v126, v127
    v_min3_f32 v158, v158, v126, v127
    v_max3_f32 v157, v157, v128, v129
    v_min3_f32 v159, v159, v128, v129
    s_waitcnt lgkmcnt(8)
    v_mfma_f32_16x16x32_bf16 v[68:71], v[100:103], v[28:31], 0
    ds_read_b64_tr_b16 v[100:101], v14 offset:328
    ds_read_b64_tr_b16 v[102:103], v14 offset:488
    v_max3_f32 v156, v156, v130, v131
    v_min3_f32 v158, v158, v130, v131
    v_max3_f32 v157, v157, v132, v133
    v_min3_f32 v159, v159, v132, v133
    v_max3_f32 v156, v156, v134, v135
    v_min3_f32 v158, v158, v134, v135
    v_max_f32 v156, v156, v157
    s_waitcnt lgkmcnt(8)
    v_mfma_f32_16x16x32_bf16 v[72:75], v[104:107], v[28:31], 0
    ds_read_b64_tr_b16 v[104:105], v14 offset:336
    ds_read_b64_tr_b16 v[106:107], v14 offset:496
    v_min_f32 v158, v158, v159
    v_mul_f32 v156, s98, v156
    v_mul_f32 v158, s98, v158
    v_pk_fma_f32 v[136:137], v[116:117], s[98:99], v[156:157] op_sel_hi:[1,0,0] neg_lo:[0,0,1] neg_hi:[0,0,1]
    v_pk_fma_f32 v[138:139], v[118:119], s[98:99], v[156:157] op_sel_hi:[1,0,0] neg_lo:[0,0,1] neg_hi:[0,0,1]
    v_pk_fma_f32 v[140:141], v[120:121], s[98:99], v[156:157] op_sel_hi:[1,0,0] neg_lo:[0,0,1] neg_hi:[0,0,1]
    v_pk_fma_f32 v[142:143], v[122:123], s[98:99], v[156:157] op_sel_hi:[1,0,0] neg_lo:[0,0,1] neg_hi:[0,0,1]
    s_waitcnt lgkmcnt(8)
    v_mfma_f32_16x16x32_bf16 v[76:79], v[108:111], v[28:31], 0
    ds_read_b64_tr_b16 v[108:109], v14 offset:344
    ds_read_b64_tr_b16 v[110:111], v14 offset:504
    v_pk_fma_f32 v[144:145], v[124:125], s[98:99], v[156:157] op_sel_hi:[1,0,0] neg_lo:[0,0,1] neg_hi:[0,0,1]
    v_pk_fma_f32 v[146:147], v[126:127], s[98:99], v[156:157] op_sel_hi:[1,0,0] neg_lo:[0,0,1] neg_hi:[0,0,1]
    v_pk_fma_f32 v[148:149], v[128:129], s[98:99], v[156:157] op_sel_hi:[1,0,0] neg_lo:[0,0,1] neg_hi:[0,0,1]
    v_pk_fma_f32 v[150:151], v[130:131], s[98:99], v[156:157] op_sel_hi:[1,0,0] neg_lo:[0,0,1] neg_hi:[0,0,1]
    v_pk_fma_f32 v[152:153], v[132:133], s[98:99], v[156:157] op_sel_hi:[1,0,0] neg_lo:[0,0,1] neg_hi:[0,0,1]
    v_pk_fma_f32 v[154:155], v[134:135], s[98:99], v[156:157] op_sel_hi:[1,0,0] neg_lo:[0,0,1] neg_hi:[0,0,1]
    v_exp_f32 v136, v136
    s_waitcnt lgkmcnt(8)
    v_mfma_f32_16x16x32_bf16 v[80:83], v[112:115], v[28:31], 0
    ds_read_b64_tr_b16 v[112:113], v14 offset:352
    ds_read_b64_tr_b16 v[114:115], v14 offset:512
    v_exp_f32 v137, v137
    v_exp_f32 v138, v138
    v_exp_f32 v139, v139
    v_exp_f32 v140, v140
    v_pk_add_f32 v[160:161], v[136:137], v[138:139]
    v_exp_f32 v141, v141
    v_exp_f32 v142, v142
    s_waitcnt lgkmcnt(8)
    v_mfma_f32_16x16x32_bf16 v[64:67], v[96:99], v[32:35], v[64:67]
    ds_read_b64_tr_b16 v[96:97], v14 offset:640
    v_pk_add_f32 v[160:161], v[160:161], v[140:141]
    v_exp_f32 v143, v143
    v_exp_f32 v144, v144
    v_pk_add_f32 v[160:161], v[160:161], v[142:143]
    v_exp_f32 v145, v145
    v_exp_f32 v146, v146
    v_pk_add_f32 v[160:161], v[160:161], v[144:145]
    s_waitcnt lgkmcnt(7)
    v_mfma_f32_16x16x32_bf16 v[68:71], v[100:103], v[32:35], v[68:71]
    ds_read_b64_tr_b16 v[100:101], v14 offset:648
    v_exp_f32 v147, v147
    v_exp_f32 v148, v148
    v_pk_add_f32 v[160:161], v[160:161], v[146:147]
    v_exp_f32 v149, v149
    v_exp_f32 v150, v150
    v_pk_add_f32 v[160:161], v[160:161], v[148:149]
    v_exp_f32 v151, v151
    s_waitcnt lgkmcnt(6)
    v_mfma_f32_16x16x32_bf16 v[72:75], v[104:107], v[32:35], v[72:75]
    ds_read_b64_tr_b16 v[104:105], v14 offset:656
    v_exp_f32 v152, v152
    v_pk_add_f32 v[160:161], v[160:161], v[150:151]
    v_exp_f32 v153, v153
    v_exp_f32 v154, v154
    v_pk_add_f32 v[160:161], v[160:161], v[152:153]
    v_exp_f32 v155, v155
    s_nop 0
    v_pk_add_f32 v[160:161], v[160:161], v[154:155]
    s_waitcnt lgkmcnt(5)
    v_mfma_f32_16x16x32_bf16 v[76:79], v[108:111], v[32:35], v[76:79]
    ds_read_b64_tr_b16 v[108:109], v14 offset:664
    v_add_f32 v160, v160, v161
    v_rcp_f32 v160, v160
    s_nop 0
    v_pk_mul_f32 v[136:137], v[136:137], v[160:161] op_sel_hi:[1,0]
    v_pk_mul_f32 v[138:139], v[138:139], v[160:161] op_sel_hi:[1,0]
    v_pk_mul_f32 v[140:141], v[140:141], v[160:161] op_sel_hi:[1,0]
    v_pk_mul_f32 v[142:143], v[142:143], v[160:161] op_sel_hi:[1,0]
    v_pk_mul_f32 v[144:145], v[144:145], v[160:161] op_sel_hi:[1,0]
    s_waitcnt lgkmcnt(4)
    v_mfma_f32_16x16x32_bf16 v[80:83], v[112:115], v[32:35], v[80:83]
    ds_read_b64_tr_b16 v[112:113], v14 offset:672
    v_pk_mul_f32 v[146:147], v[146:147], v[160:161] op_sel_hi:[1,0]
    v_pk_mul_f32 v[148:149], v[148:149], v[160:161] op_sel_hi:[1,0]
    v_pk_mul_f32 v[150:151], v[150:151], v[160:161] op_sel_hi:[1,0]
    v_pk_mul_f32 v[152:153], v[152:153], v[160:161] op_sel_hi:[1,0]
    v_pk_mul_f32 v[154:155], v[154:155], v[160:161] op_sel_hi:[1,0]
    v_cvt_pk_bf16_f32 v16, v136, v137
    v_cvt_pk_bf16_f32 v17, v138, v139
    s_waitcnt lgkmcnt(4)
    v_mfma_f32_16x16x32_bf16 v[64:67], v[96:99], v[36:39], v[64:67]
    v_cvt_pk_bf16_f32 v18, v140, v141
    v_cvt_pk_bf16_f32 v19, v142, v143
    v_cvt_pk_bf16_f32 v20, v144, v145
    v_cvt_pk_bf16_f32 v21, v146, v147
    v_cvt_pk_bf16_f32 v22, v148, v149
    v_cvt_pk_bf16_f32 v23, v150, v151
    v_cvt_pk_bf16_f32 v24, v152, v153
    s_waitcnt lgkmcnt(3)
    v_mfma_f32_16x16x32_bf16 v[68:71], v[100:103], v[36:39], v[68:71]
    v_cvt_pk_bf16_f32 v25, v154, v155
    v_pk_fma_f32 v[136:137], v[116:117], s[98:99], v[158:159] op_sel_hi:[1,0,0] neg_lo:[1,0,0] neg_hi:[1,0,0]
    v_pk_fma_f32 v[138:139], v[118:119], s[98:99], v[158:159] op_sel_hi:[1,0,0] neg_lo:[1,0,0] neg_hi:[1,0,0]
    v_pk_fma_f32 v[140:141], v[120:121], s[98:99], v[158:159] op_sel_hi:[1,0,0] neg_lo:[1,0,0] neg_hi:[1,0,0]
    v_pk_fma_f32 v[142:143], v[122:123], s[98:99], v[158:159] op_sel_hi:[1,0,0] neg_lo:[1,0,0] neg_hi:[1,0,0]
    v_pk_fma_f32 v[144:145], v[124:125], s[98:99], v[158:159] op_sel_hi:[1,0,0] neg_lo:[1,0,0] neg_hi:[1,0,0]
    v_pk_fma_f32 v[146:147], v[126:127], s[98:99], v[158:159] op_sel_hi:[1,0,0] neg_lo:[1,0,0] neg_hi:[1,0,0]
    s_waitcnt lgkmcnt(2)
    v_mfma_f32_16x16x32_bf16 v[72:75], v[104:107], v[36:39], v[72:75]
    v_pk_fma_f32 v[148:149], v[128:129], s[98:99], v[158:159] op_sel_hi:[1,0,0] neg_lo:[1,0,0] neg_hi:[1,0,0]
    v_pk_fma_f32 v[150:151], v[130:131], s[98:99], v[158:159] op_sel_hi:[1,0,0] neg_lo:[1,0,0] neg_hi:[1,0,0]
    v_pk_fma_f32 v[152:153], v[132:133], s[98:99], v[158:159] op_sel_hi:[1,0,0] neg_lo:[1,0,0] neg_hi:[1,0,0]
    v_pk_fma_f32 v[154:155], v[134:135], s[98:99], v[158:159] op_sel_hi:[1,0,0] neg_lo:[1,0,0] neg_hi:[1,0,0]
    v_exp_f32 v136, v136
    v_exp_f32 v137, v137
    v_exp_f32 v138, v138
    s_waitcnt lgkmcnt(1)
    v_mfma_f32_16x16x32_bf16 v[76:79], v[108:111], v[36:39], v[76:79]
    v_exp_f32 v139, v139
    v_exp_f32 v140, v140
    v_pk_add_f32 v[160:161], v[136:137], v[138:139]
    v_exp_f32 v141, v141
    v_exp_f32 v142, v142
    v_pk_add_f32 v[160:161], v[160:161], v[140:141]
    v_exp_f32 v143, v143
    s_waitcnt lgkmcnt(0)
    v_mfma_f32_16x16x32_bf16 v[80:83], v[112:115], v[36:39], v[80:83]
    v_exp_f32 v144, v144
    v_pk_add_f32 v[160:161], v[160:161], v[142:143]
    v_exp_f32 v145, v145
    v_exp_f32 v146, v146
    v_pk_add_f32 v[160:161], v[160:161], v[144:145]
    v_exp_f32 v147, v147
    v_exp_f32 v148, v148
    v_pk_add_f32 v[160:161], v[160:161], v[146:147]
    v_exp_f32 v149, v149
    v_exp_f32 v150, v150
    v_pk_add_f32 v[160:161], v[160:161], v[148:149]
    v_exp_f32 v151, v151
    v_exp_f32 v152, v152
    v_pk_add_f32 v[160:161], v[160:161], v[150:151]
    v_exp_f32 v153, v153
    v_exp_f32 v154, v154
    v_pk_add_f32 v[160:161], v[160:161], v[152:153]
    v_exp_f32 v155, v155
    s_nop 0
    v_pk_add_f32 v[160:161], v[160:161], v[154:155]
    v_add_f32 v160, v160, v161
    v_rcp_f32 v160, v160
    s_nop 0
    v_pk_mul_f32 v[136:137], v[136:137], v[160:161] op_sel_hi:[1,0]
    v_pk_mul_f32 v[138:139], v[138:139], v[160:161] op_sel_hi:[1,0]
    v_pk_mul_f32 v[140:141], v[140:141], v[160:161] op_sel_hi:[1,0]
    v_pk_mul_f32 v[142:143], v[142:143], v[160:161] op_sel_hi:[1,0]
    v_pk_mul_f32 v[144:145], v[144:145], v[160:161] op_sel_hi:[1,0]
    v_pk_mul_f32 v[146:147], v[146:147], v[160:161] op_sel_hi:[1,0]
    v_pk_mul_f32 v[148:149], v[148:149], v[160:161] op_sel_hi:[1,0]
    v_pk_mul_f32 v[150:151], v[150:151], v[160:161] op_sel_hi:[1,0]
    v_pk_mul_f32 v[152:153], v[152:153], v[160:161] op_sel_hi:[1,0]
    v_pk_mul_f32 v[154:155], v[154:155], v[160:161] op_sel_hi:[1,0]
    v_cvt_pk_bf16_f32 v26, v136, v137
    v_cvt_pk_bf16_f32 v27, v138, v139
    v_cvt_pk_bf16_f32 v84, v140, v141
    v_cvt_pk_bf16_f32 v85, v142, v143
    v_cvt_pk_bf16_f32 v86, v144, v145
    v_cvt_pk_bf16_f32 v87, v146, v147
    v_cvt_pk_bf16_f32 v88, v148, v149
    v_cvt_pk_bf16_f32 v89, v150, v151
    v_cvt_pk_bf16_f32 v90, v152, v153
    v_cvt_pk_bf16_f32 v91, v154, v155
    ds_write_b128 v165, v[16:19] offset:0
    ds_write_b128 v165, v[20:23] offset:16
    ds_write_b128 v165, v[24:27] offset:32
    ds_write_b128 v165, v[84:87] offset:48
    ds_write_b128 v165, v[88:91] offset:64
    v_max3_f32 v156, v64, v65, v66
    v_min3_f32 v158, v64, v65, v66
    v_max3_f32 v157, v67, v68, v69
    v_min3_f32 v159, v67, v68, v69
    v_max3_f32 v156, v156, v70, v71
    v_min3_f32 v158, v158, v70, v71
    v_max3_f32 v157, v157, v72, v73
    v_min3_f32 v159, v159, v72, v73
    v_max3_f32 v156, v156, v74, v75
    v_min3_f32 v158, v158, v74, v75
    v_max3_f32 v157, v157, v76, v77
    v_min3_f32 v159, v159, v76, v77
    v_max3_f32 v156, v156, v78, v79
    v_min3_f32 v158, v158, v78, v79
    v_max3_f32 v157, v157, v80, v81
    v_min3_f32 v159, v159, v80, v81
    v_max3_f32 v156, v156, v82, v83
    v_min3_f32 v158, v158, v82, v83
    v_max_f32 v156, v156, v157
    v_min_f32 v158, v158, v159
    v_mul_f32 v156, s98, v156
    v_mul_f32 v158, s98, v158
    v_pk_fma_f32 v[136:137], v[64:65], s[98:99], v[156:157] op_sel_hi:[1,0,0] neg_lo:[0,0,1] neg_hi:[0,0,1]
    v_pk_fma_f32 v[138:139], v[66:67], s[98:99], v[156:157] op_sel_hi:[1,0,0] neg_lo:[0,0,1] neg_hi:[0,0,1]
    v_pk_fma_f32 v[140:141], v[68:69], s[98:99], v[156:157] op_sel_hi:[1,0,0] neg_lo:[0,0,1] neg_hi:[0,0,1]
    v_pk_fma_f32 v[142:143], v[70:71], s[98:99], v[156:157] op_sel_hi:[1,0,0] neg_lo:[0,0,1] neg_hi:[0,0,1]
    v_pk_fma_f32 v[144:145], v[72:73], s[98:99], v[156:157] op_sel_hi:[1,0,0] neg_lo:[0,0,1] neg_hi:[0,0,1]
    v_pk_fma_f32 v[146:147], v[74:75], s[98:99], v[156:157] op_sel_hi:[1,0,0] neg_lo:[0,0,1] neg_hi:[0,0,1]
    v_pk_fma_f32 v[148:149], v[76:77], s[98:99], v[156:157] op_sel_hi:[1,0,0] neg_lo:[0,0,1] neg_hi:[0,0,1]
    v_pk_fma_f32 v[150:151], v[78:79], s[98:99], v[156:157] op_sel_hi:[1,0,0] neg_lo:[0,0,1] neg_hi:[0,0,1]
    v_pk_fma_f32 v[152:153], v[80:81], s[98:99], v[156:157] op_sel_hi:[1,0,0] neg_lo:[0,0,1] neg_hi:[0,0,1]
    v_pk_fma_f32 v[154:155], v[82:83], s[98:99], v[156:157] op_sel_hi:[1,0,0] neg_lo:[0,0,1] neg_hi:[0,0,1]
    v_exp_f32 v136, v136
    v_exp_f32 v137, v137
    v_exp_f32 v138, v138
    v_exp_f32 v139, v139
    v_exp_f32 v140, v140
    v_pk_add_f32 v[160:161], v[136:137], v[138:139]
    v_exp_f32 v141, v141
    v_exp_f32 v142, v142
    v_pk_add_f32 v[160:161], v[160:161], v[140:141]
    v_exp_f32 v143, v143
    v_exp_f32 v144, v144
    v_pk_add_f32 v[160:161], v[160:161], v[142:143]
    v_exp_f32 v145, v145
    v_exp_f32 v146, v146
    v_pk_add_f32 v[160:161], v[160:161], v[144:145]
    v_exp_f32 v147, v147
    v_exp_f32 v148, v148
    v_pk_add_f32 v[160:161], v[160:161], v[146:147]
    v_exp_f32 v149, v149
    v_exp_f32 v150, v150
    v_pk_add_f32 v[160:161], v[160:161], v[148:149]
    v_exp_f32 v151, v151
    v_exp_f32 v152, v152
    v_pk_add_f32 v[160:161], v[160:161], v[150:151]
    v_exp_f32 v153, v153
    v_exp_f32 v154, v154
    v_pk_add_f32 v[160:161], v[160:161], v[152:153]
    v_exp_f32 v155, v155
    s_nop 0
    v_pk_add_f32 v[160:161], v[160:161], v[154:155]
    v_add_f32 v160, v160, v161
    v_rcp_f32 v160, v160
    s_nop 0
    v_pk_mul_f32 v[136:137], v[136:137], v[160:161] op_sel_hi:[1,0]
    v_pk_mul_f32 v[138:139], v[138:139], v[160:161] op_sel_hi:[1,0]
    v_pk_mul_f32 v[140:141], v[140:141], v[160:161] op_sel_hi:[1,0]
    v_pk_mul_f32 v[142:143], v[142:143], v[160:161] op_sel_hi:[1,0]
    v_pk_mul_f32 v[144:145], v[144:145], v[160:161] op_sel_hi:[1,0]
    v_pk_mul_f32 v[146:147], v[146:147], v[160:161] op_sel_hi:[1,0]
    v_pk_mul_f32 v[148:149], v[148:149], v[160:161] op_sel_hi:[1,0]
    v_pk_mul_f32 v[150:151], v[150:151], v[160:161] op_sel_hi:[1,0]
    v_pk_mul_f32 v[152:153], v[152:153], v[160:161] op_sel_hi:[1,0]
    v_pk_mul_f32 v[154:155], v[154:155], v[160:161] op_sel_hi:[1,0]
    v_cvt_pk_bf16_f32 v28, v136, v137
    v_cvt_pk_bf16_f32 v29, v138, v139
    v_cvt_pk_bf16_f32 v30, v140, v141
    v_cvt_pk_bf16_f32 v31, v142, v143
    v_cvt_pk_bf16_f32 v32, v144, v145
    v_cvt_pk_bf16_f32 v33, v146, v147
    v_cvt_pk_bf16_f32 v34, v148, v149
    v_cvt_pk_bf16_f32 v35, v150, v151
    v_cvt_pk_bf16_f32 v36, v152, v153
    v_cvt_pk_bf16_f32 v37, v154, v155
    v_pk_fma_f32 v[136:137], v[64:65], s[98:99], v[158:159] op_sel_hi:[1,0,0] neg_lo:[1,0,0] neg_hi:[1,0,0]
    v_pk_fma_f32 v[138:139], v[66:67], s[98:99], v[158:159] op_sel_hi:[1,0,0] neg_lo:[1,0,0] neg_hi:[1,0,0]
    v_pk_fma_f32 v[140:141], v[68:69], s[98:99], v[158:159] op_sel_hi:[1,0,0] neg_lo:[1,0,0] neg_hi:[1,0,0]
    v_pk_fma_f32 v[142:143], v[70:71], s[98:99], v[158:159] op_sel_hi:[1,0,0] neg_lo:[1,0,0] neg_hi:[1,0,0]
    v_pk_fma_f32 v[144:145], v[72:73], s[98:99], v[158:159] op_sel_hi:[1,0,0] neg_lo:[1,0,0] neg_hi:[1,0,0]
    v_pk_fma_f32 v[146:147], v[74:75], s[98:99], v[158:159] op_sel_hi:[1,0,0] neg_lo:[1,0,0] neg_hi:[1,0,0]
    v_pk_fma_f32 v[148:149], v[76:77], s[98:99], v[158:159] op_sel_hi:[1,0,0] neg_lo:[1,0,0] neg_hi:[1,0,0]
    v_pk_fma_f32 v[150:151], v[78:79], s[98:99], v[158:159] op_sel_hi:[1,0,0] neg_lo:[1,0,0] neg_hi:[1,0,0]
    v_pk_fma_f32 v[152:153], v[80:81], s[98:99], v[158:159] op_sel_hi:[1,0,0] neg_lo:[1,0,0] neg_hi:[1,0,0]
    v_pk_fma_f32 v[154:155], v[82:83], s[98:99], v[158:159] op_sel_hi:[1,0,0] neg_lo:[1,0,0] neg_hi:[1,0,0]
    v_exp_f32 v136, v136
    v_exp_f32 v137, v137
    v_exp_f32 v138, v138
    v_exp_f32 v139, v139
    v_exp_f32 v140, v140
    v_pk_add_f32 v[160:161], v[136:137], v[138:139]
    v_exp_f32 v141, v141
    v_exp_f32 v142, v142
    v_pk_add_f32 v[160:161], v[160:161], v[140:141]
    v_exp_f32 v143, v143
    v_exp_f32 v144, v144
    v_pk_add_f32 v[160:161], v[160:161], v[142:143]
    v_exp_f32 v145, v145
    v_exp_f32 v146, v146
    v_pk_add_f32 v[160:161], v[160:161], v[144:145]
    v_exp_f32 v147, v147
    v_exp_f32 v148, v148
    v_pk_add_f32 v[160:161], v[160:161], v[146:147]
    v_exp_f32 v149, v149
    v_exp_f32 v150, v150
    v_pk_add_f32 v[160:161], v[160:161], v[148:149]
    v_exp_f32 v151, v151
    v_exp_f32 v152, v152
    v_pk_add_f32 v[160:161], v[160:161], v[150:151]
    v_exp_f32 v153, v153
    v_exp_f32 v154, v154
    v_pk_add_f32 v[160:161], v[160:161], v[152:153]
    v_exp_f32 v155, v155
    s_nop 0
    v_pk_add_f32 v[160:161], v[160:161], v[154:155]
    v_add_f32 v160, v160, v161
    v_rcp_f32 v160, v160
    s_nop 0
    v_pk_mul_f32 v[136:137], v[136:137], v[160:161] op_sel_hi:[1,0]
    v_pk_mul_f32 v[138:139], v[138:139], v[160:161] op_sel_hi:[1,0]
    v_pk_mul_f32 v[140:141], v[140:141], v[160:161] op_sel_hi:[1,0]
    v_pk_mul_f32 v[142:143], v[142:143], v[160:161] op_sel_hi:[1,0]
    v_pk_mul_f32 v[144:145], v[144:145], v[160:161] op_sel_hi:[1,0]
    v_pk_mul_f32 v[146:147], v[146:147], v[160:161] op_sel_hi:[1,0]
    v_pk_mul_f32 v[148:149], v[148:149], v[160:161] op_sel_hi:[1,0]
    v_pk_mul_f32 v[150:151], v[150:151], v[160:161] op_sel_hi:[1,0]
    v_pk_mul_f32 v[152:153], v[152:153], v[160:161] op_sel_hi:[1,0]
    v_pk_mul_f32 v[154:155], v[154:155], v[160:161] op_sel_hi:[1,0]
    v_cvt_pk_bf16_f32 v38, v136, v137
    v_cvt_pk_bf16_f32 v39, v138, v139
    v_cvt_pk_bf16_f32 v84, v140, v141
    v_cvt_pk_bf16_f32 v85, v142, v143
    v_cvt_pk_bf16_f32 v86, v144, v145
    v_cvt_pk_bf16_f32 v87, v146, v147
    v_cvt_pk_bf16_f32 v88, v148, v149
    v_cvt_pk_bf16_f32 v89, v150, v151
    v_cvt_pk_bf16_f32 v90, v152, v153
    v_cvt_pk_bf16_f32 v91, v154, v155
    ds_write_b128 v165, v[28:31] offset:5376
    ds_write_b128 v165, v[32:35] offset:5392
    ds_write_b128 v165, v[36:39] offset:5408
    ds_write_b128 v165, v[84:87] offset:5424
    ds_write_b128 v165, v[88:91] offset:5440
    s_waitcnt lgkmcnt(0)
    s_barrier
    v_mov_b32 v16, 0x3f803f80
    v_mov_b32 v17, 0x3f803f80
    v_mov_b32 v18, 0x3f803f80
    v_mov_b32 v19, 0x3f803f80
    ds_read_b64_tr_b16 v[44:45], v3 offset:0
    ds_read_b64_tr_b16 v[46:47], v3 offset:336
    ds_read_b64_tr_b16 v[48:49], v3 offset:32
    ds_read_b64_tr_b16 v[50:51], v3 offset:368
    ds_read_b64_tr_b16 v[52:53], v3 offset:64
    ds_read_b64_tr_b16 v[54:55], v3 offset:400
    ds_read_b64_tr_b16 v[56:57], v5 offset:0
    ds_read_b64_tr_b16 v[58:59], v5 offset:176
    ds_read_b64_tr_b16 v[60:61], v3 offset:10752
    ds_read_b64_tr_b16 v[62:63], v3 offset:11088
    ds_read_b64_tr_b16 v[64:65], v3 offset:10784
    ds_read_b64_tr_b16 v[66:67], v3 offset:11120
    ds_read_b64_tr_b16 v[68:69], v3 offset:10816
    ds_read_b64_tr_b16 v[70:71], v3 offset:11152
    ds_read_b64_tr_b16 v[72:73], v5 offset:5632
    ds_read_b64_tr_b16 v[74:75], v5 offset:5808
    ds_read_b64_tr_b16 v[76:77], v3 offset:21504
    ds_read_b64_tr_b16 v[78:79], v3 offset:21840
    ds_read_b64_tr_b16 v[80:81], v3 offset:21536
    ds_read_b64_tr_b16 v[82:83], v3 offset:21872
    ds_read_b64_tr_b16 v[84:85], v3 offset:21568
    ds_read_b64_tr_b16 v[86:87], v3 offset:21904
    ds_read_b64_tr_b16 v[88:89], v5 offset:11264
    ds_read_b64_tr_b16 v[90:91], v5 offset:11440
    ds_read_b64_tr_b16 v[92:93], v3 offset:32256
    ds_read_b64_tr_b16 v[94:95], v3 offset:32592
    ds_read_b64_tr_b16 v[96:97], v3 offset:32288
    ds_read_b64_tr_b16 v[98:99], v3 offset:32624
    ds_read_b64_tr_b16 v[100:101], v3 offset:32320
    ds_read_b64_tr_b16 v[102:103], v3 offset:32656
    ds_read_b64_tr_b16 v[104:105], v5 offset:16896
    ds_read_b64_tr_b16 v[106:107], v5 offset:17072
    s_cmp_eq_u32 s13, 1
    s_nop 7
    s_nop 3
    s_cbranch_scc1 L_k1_kv_z
    ds_read_b64_tr_b16 v[108:109], v4 offset:0
    ds_read_b64_tr_b16 v[110:111], v4 offset:336
    ds_read_b64_tr_b16 v[112:113], v4 offset:32
    ds_read_b64_tr_b16 v[114:115], v4 offset:368
    ds_read_b64_tr_b16 v[116:117], v4 offset:64
    ds_read_b64_tr_b16 v[118:119], v4 offset:400
    ds_read_b64_tr_b16 v[120:121], v5 offset:22528
    ds_read_b64_tr_b16 v[122:123], v5 offset:22704
    s_waitcnt lgkmcnt(15)
    v_mfma_f32_16x16x32_bf16 v[20:23], v[44:47], v[56:59], 0
    v_mfma_f32_16x16x32_bf16 v[24:27], v[48:51], v[56:59], 0
    v_mfma_f32_16x16x32_bf16 v[28:31], v[52:55], v[56:59], 0
    ds_read_b64_tr_b16 v[124:125], v4 offset:10752
    ds_read_b64_tr_b16 v[126:127], v4 offset:11088
    ds_read_b64_tr_b16 v[128:129], v4 offset:10784
    ds_read_b64_tr_b16 v[130:131], v4 offset:11120
    ds_read_b64_tr_b16 v[132:133], v4 offset:10816
    ds_read_b64_tr_b16 v[134:135], v4 offset:11152
    ds_read_b64_tr_b16 v[136:137], v5 offset:28160
    ds_read_b64_tr_b16 v[138:139], v5 offset:28336
    v_mfma_f32_16x16x32_bf16 v[20:23], v[60:63], v[72:75], v[20:23]
    v_mfma_f32_16x16x32_bf16 v[24:27], v[64:67], v[72:75], v[24:27]
    v_mfma_f32_16x16x32_bf16 v[28:31], v[68:71], v[72:75], v[28:31]
    ds_read_b64_tr_b16 v[44:45], v4 offset:21504
    ds_read_b64_tr_b16 v[46:47], v4 offset:21840
    ds_read_b64_tr_b16 v[48:49], v4 offset:21536
    ds_read_b64_tr_b16 v[50:51], v4 offset:21872
    ds_read_b64_tr_b16 v[52:53], v4 offset:21568
    ds_read_b64_tr_b16 v[54:55], v4 offset:21904
    ds_read_b64_tr_b16 v[56:57], v5 offset:33792
    ds_read_b64_tr_b16 v[58:59], v5 offset:33968
    v_mfma_f32_16x16x32_bf16 v[20:23], v[76:79], v[88:91], v[20:23]
    v_mfma_f32_16x16x32_bf16 v[24:27], v[80:83], v[88:91], v[24:27]
    v_mfma_f32_16x16x32_bf16 v[28:31], v[84:87], v[88:91], v[28:31]
    ds_read_b64_tr_b16 v[60:61], v4 offset:32256
    ds_read_b64_tr_b16 v[62:63], v4 offset:32592
    ds_read_b64_tr_b16 v[64:65], v4 offset:32288
    ds_read_b64_tr_b16 v[66:67], v4 offset:32624
    ds_read_b64_tr_b16 v[68:69], v4 offset:32320
    ds_read_b64_tr_b16 v[70:71], v4 offset:32656
    ds_read_b64_tr_b16 v[72:73], v5 offset:39424
    ds_read_b64_tr_b16 v[74:75], v5 offset:39600
    s_waitcnt lgkmcnt(15)
    v_mfma_f32_16x16x32_bf16 v[20:23], v[92:95], v[104:107], v[20:23]
    v_mfma_f32_16x16x32_bf16 v[24:27], v[96:99], v[104:107], v[24:27]
    v_mfma_f32_16x16x32_bf16 v[28:31], v[100:103], v[104:107], v[28:31]
    v_mfma_f32_16x16x32_bf16 v[20:23], v[108:111], v[120:123], v[20:23]
    v_mfma_f32_16x16x32_bf16 v[24:27], v[112:115], v[120:123], v[24:27]
    v_mfma_f32_16x16x32_bf16 v[28:31], v[116:119], v[120:123], v[28:31]
    v_mfma_f32_16x16x32_bf16 v[20:23], v[124:127], v[136:139], v[20:23]
    v_mfma_f32_16x16x32_bf16 v[24:27], v[128:131], v[136:139], v[24:27]
    v_mfma_f32_16x16x32_bf16 v[28:31], v[132:135], v[136:139], v[28:31]
    s_waitcnt lgkmcnt(8)
    v_mfma_f32_16x16x32_bf16 v[20:23], v[44:47], v[56:59], v[20:23]
    v_mfma_f32_16x16x32_bf16 v[24:27], v[48:51], v[56:59], v[24:27]
    v_mfma_f32_16x16x32_bf16 v[28:31], v[52:55], v[56:59], v[28:31]
    s_waitcnt lgkmcnt(0)
    v_mfma_f32_16x16x32_bf16 v[20:23], v[60:63], v[72:75], v[20:23]
    v_mfma_f32_16x16x32_bf16 v[24:27], v[64:67], v[72:75], v[24:27]
    v_mfma_f32_16x16x32_bf16 v[28:31], v[68:71], v[72:75], v[28:31]
    s_nop 5
    buffer_store_dwordx4 v[20:23], v6, s[48:51], s9 offen offset:0
    buffer_store_dwordx4 v[24:27], v6, s[48:51], s9 offen offset:1024
    buffer_store_dwordx4 v[28:31], v7, s[48:51], s9 offen offset:0
    s_endpgm
L_k1_kv_z:
    ds_read_b64_tr_b16 v[108:109], v4 offset:0
    ds_read_b64_tr_b16 v[110:111], v4 offset:336
    ds_read_b64_tr_b16 v[112:113], v4 offset:32
    ds_read_b64_tr_b16 v[114:115], v4 offset:368
    ds_read_b64_tr_b16 v[116:117], v4 offset:64
    ds_read_b64_tr_b16 v[118:119], v4 offset:400
    ds_read_b64_tr_b16 v[120:121], v5 offset:22528
    ds_read_b64_tr_b16 v[122:123], v5 offset:22704
    s_waitcnt lgkmcnt(15)
    v_mfma_f32_16x16x32_bf16 v[20:23], v[44:47], v[56:59], 0
    v_mfma_f32_16x16x32_bf16 v[32:35], v[44:47], v[16:19], 0
    v_mfma_f32_16x16x32_bf16 v[24:27], v[48:51], v[56:59], 0
    v_mfma_f32_16x16x32_bf16 v[36:39], v[48:51], v[16:19], 0
    v_mfma_f32_16x16x32_bf16 v[28:31], v[52:55], v[56:59], 0
    v_mfma_f32_16x16x32_bf16 v[40:43], v[52:55], v[16:19], 0
    ds_read_b64_tr_b16 v[124:125], v4 offset:10752
    ds_read_b64_tr_b16 v[126:127], v4 offset:11088
    ds_read_b64_tr_b16 v[128:129], v4 offset:10784
    ds_read_b64_tr_b16 v[130:131], v4 offset:11120
    ds_read_b64_tr_b16 v[132:133], v4 offset:10816
    ds_read_b64_tr_b16 v[134:135], v4 offset:11152
    ds_read_b64_tr_b16 v[136:137], v5 offset:28160
    ds_read_b64_tr_b16 v[138:139], v5 offset:28336
    v_mfma_f32_16x16x32_bf16 v[20:23], v[60:63], v[72:75], v[20:23]
    v_mfma_f32_16x16x32_bf16 v[32:35], v[60:63], v[16:19], v[32:35]
    v_mfma_f32_16x16x32_bf16 v[24:27], v[64:67], v[72:75], v[24:27]
    v_mfma_f32_16x16x32_bf16 v[36:39], v[64:67], v[16:19], v[36:39]
    v_mfma_f32_16x16x32_bf16 v[28:31], v[68:71], v[72:75], v[28:31]
    v_mfma_f32_16x16x32_bf16 v[40:43], v[68:71], v[16:19], v[40:43]
    ds_read_b64_tr_b16 v[44:45], v4 offset:21504
    ds_read_b64_tr_b16 v[46:47], v4 offset:21840
    ds_read_b64_tr_b16 v[48:49], v4 offset:21536
    ds_read_b64_tr_b16 v[50:51], v4 offset:21872
    ds_read_b64_tr_b16 v[52:53], v4 offset:21568
    ds_read_b64_tr_b16 v[54:55], v4 offset:21904
    ds_read_b64_tr_b16 v[56:57], v5 offset:33792
    ds_read_b64_tr_b16 v[58:59], v5 offset:33968
    v_mfma_f32_16x16x32_bf16 v[20:23], v[76:79], v[88:91], v[20:23]
    v_mfma_f32_16x16x32_bf16 v[32:35], v[76:79], v[16:19], v[32:35]
    v_mfma_f32_16x16x32_bf16 v[24:27], v[80:83], v[88:91], v[24:27]
    v_mfma_f32_16x16x32_bf16 v[36:39], v[80:83], v[16:19], v[36:39]
    v_mfma_f32_16x16x32_bf16 v[28:31], v[84:87], v[88:91], v[28:31]
    v_mfma_f32_16x16x32_bf16 v[40:43], v[84:87], v[16:19], v[40:43]
    ds_read_b64_tr_b16 v[60:61], v4 offset:32256
    ds_read_b64_tr_b16 v[62:63], v4 offset:32592
    ds_read_b64_tr_b16 v[64:65], v4 offset:32288
    ds_read_b64_tr_b16 v[66:67], v4 offset:32624
    ds_read_b64_tr_b16 v[68:69], v4 offset:32320
    ds_read_b64_tr_b16 v[70:71], v4 offset:32656
    ds_read_b64_tr_b16 v[72:73], v5 offset:39424
    ds_read_b64_tr_b16 v[74:75], v5 offset:39600
    s_waitcnt lgkmcnt(15)
    v_mfma_f32_16x16x32_bf16 v[20:23], v[92:95], v[104:107], v[20:23]
    v_mfma_f32_16x16x32_bf16 v[32:35], v[92:95], v[16:19], v[32:35]
    v_mfma_f32_16x16x32_bf16 v[24:27], v[96:99], v[104:107], v[24:27]
    v_mfma_f32_16x16x32_bf16 v[36:39], v[96:99], v[16:19], v[36:39]
    v_mfma_f32_16x16x32_bf16 v[28:31], v[100:103], v[104:107], v[28:31]
    v_mfma_f32_16x16x32_bf16 v[40:43], v[100:103], v[16:19], v[40:43]
    v_mfma_f32_16x16x32_bf16 v[20:23], v[108:111], v[120:123], v[20:23]
    v_mfma_f32_16x16x32_bf16 v[32:35], v[108:111], v[16:19], v[32:35]
    v_mfma_f32_16x16x32_bf16 v[24:27], v[112:115], v[120:123], v[24:27]
    v_mfma_f32_16x16x32_bf16 v[36:39], v[112:115], v[16:19], v[36:39]
    v_mfma_f32_16x16x32_bf16 v[28:31], v[116:119], v[120:123], v[28:31]
    v_mfma_f32_16x16x32_bf16 v[40:43], v[116:119], v[16:19], v[40:43]
    v_mfma_f32_16x16x32_bf16 v[20:23], v[124:127], v[136:139], v[20:23]
    v_mfma_f32_16x16x32_bf16 v[32:35], v[124:127], v[16:19], v[32:35]
    v_mfma_f32_16x16x32_bf16 v[24:27], v[128:131], v[136:139], v[24:27]
    v_mfma_f32_16x16x32_bf16 v[36:39], v[128:131], v[16:19], v[36:39]
    v_mfma_f32_16x16x32_bf16 v[28:31], v[132:135], v[136:139], v[28:31]
    v_mfma_f32_16x16x32_bf16 v[40:43], v[132:135], v[16:19], v[40:43]
    s_waitcnt lgkmcnt(8)
    v_mfma_f32_16x16x32_bf16 v[20:23], v[44:47], v[56:59], v[20:23]
    v_mfma_f32_16x16x32_bf16 v[32:35], v[44:47], v[16:19], v[32:35]
    v_mfma_f32_16x16x32_bf16 v[24:27], v[48:51], v[56:59], v[24:27]
    v_mfma_f32_16x16x32_bf16 v[36:39], v[48:51], v[16:19], v[36:39]
    v_mfma_f32_16x16x32_bf16 v[28:31], v[52:55], v[56:59], v[28:31]
    v_mfma_f32_16x16x32_bf16 v[40:43], v[52:55], v[16:19], v[40:43]
    s_waitcnt lgkmcnt(0)
    v_mfma_f32_16x16x32_bf16 v[20:23], v[60:63], v[72:75], v[20:23]
    v_mfma_f32_16x16x32_bf16 v[32:35], v[60:63], v[16:19], v[32:35]
    v_mfma_f32_16x16x32_bf16 v[24:27], v[64:67], v[72:75], v[24:27]
    v_mfma_f32_16x16x32_bf16 v[36:39], v[64:67], v[16:19], v[36:39]
    v_mfma_f32_16x16x32_bf16 v[28:31], v[68:71], v[72:75], v[28:31]
    v_mfma_f32_16x16x32_bf16 v[40:43], v[68:71], v[16:19], v[40:43]
    s_nop 2
    buffer_store_dwordx4 v[20:23], v6, s[48:51], s9 offen offset:0
    buffer_store_dwordx4 v[32:35], v8, s[48:51], s9 offen offset:0
    buffer_store_dwordx4 v[24:27], v6, s[48:51], s9 offen offset:1024
    buffer_store_dwordx4 v[36:39], v8, s[48:51], s9 offen offset:1024
    buffer_store_dwordx4 v[28:31], v7, s[48:51], s9 offen offset:0
    buffer_store_dwordx4 v[40:43], v9, s[48:51], s9 offen offset:0
    s_endpgm
L_k1_ld_kv:
    s_setprio 3
    s_mov_b32 s9, 0
    s_mov_b32 s12, 0
    s_and_b32 s15, s6, 1
    s_cmp_ge_u32 s6, 10
    s_cbranch_scc1 L_k1_ldw_kv
    v_and_b32 v14, 7, v0
    v_xor_b32 v14, v14, v11
    v_lshrrev_b32 v15, 3, v0
    v_mul_u32_u24 v15, 1280, v15
    v_lshl_add_u32 v16, v14, 4, v15
    v_xor_b32 v14, 4, v14
    v_lshl_add_u32 v17, v14, 4, v15
    v_add_u32 v17, 10240, v17
    v_add_u32 v18, 20480, v16
    v_add_u32 v19, 20480, v17
    v_add_u32 v20, 40960, v16
    v_add_u32 v21, 40960, v17
    v_add_u32 v22, 61440, v16
    v_add_u32 v23, 61440, v17
    s_mul_i32 s10, s5, 327680
    s_mul_i32 s72, s15, 163840
    s_add_u32 s11, s10, s72
    s_lshl_b32 s8, s14, 7
    s_add_u32 s10, s11, s8
    s_mul_i32 s7, s15, 16384
    s_add_u32 m0, s9, s7
    s_mov_b32 s72, s10
    buffer_load_dwordx4 v16, s[40:43], s72 offen lds
    s_add_u32 m0, m0, 1024
    s_nop 0
    buffer_load_dwordx4 v17, s[40:43], s72 offen lds
    s_add_u32 m0, m0, 1024
    s_nop 0
    buffer_load_dwordx4 v18, s[40:43], s72 offen lds
    s_add_u32 m0, m0, 1024
    s_nop 0
    buffer_load_dwordx4 v19, s[40:43], s72 offen lds
    s_add_u32 m0, m0, 1024
    s_nop 0
    buffer_load_dwordx4 v20, s[40:43], s72 offen lds
    s_add_u32 m0, m0, 1024
    s_nop 0
    buffer_load_dwordx4 v21, s[40:43], s72 offen lds
    s_add_u32 m0, m0, 1024
    s_nop 0
    buffer_load_dwordx4 v22, s[40:43], s72 offen lds
    s_add_u32 m0, m0, 1024
    s_nop 0
    buffer_load_dwordx4 v23, s[40:43], s72 offen lds
    s_add_u32 m0, s9, s7
    s_add_u32 m0, m0, 8192
    s_add_u32 s72, s10, 81920
    buffer_load_dwordx4 v16, s[40:43], s72 offen lds
    s_add_u32 m0, m0, 1024
    s_nop 0
    buffer_load_dwordx4 v17, s[40:43], s72 offen lds
    s_add_u32 m0, m0, 1024
    s_nop 0
    buffer_load_dwordx4 v18, s[40:43], s72 offen lds
    s_add_u32 m0, m0, 1024
    s_nop 0
    buffer_load_dwordx4 v19, s[40:43], s72 offen lds
    s_add_u32 m0, m0, 1024
    s_nop 0
    buffer_load_dwordx4 v20, s[40:43], s72 offen lds
    s_add_u32 m0, m0, 1024
    s_nop 0
    buffer_load_dwordx4 v21, s[40:43], s72 offen lds
    s_add_u32 m0, m0, 1024
    s_nop 0
    buffer_load_dwordx4 v22, s[40:43], s72 offen lds
    s_add_u32 m0, m0, 1024
    s_nop 0
    buffer_load_dwordx4 v23, s[40:43], s72 offen lds
    s_add_u32 s8, s8, 128
    s_cmp_eq_u32 s8, 1280
    s_cselect_b32 s8, 0, s8
    s_add_u32 s10, s11, s8
    s_add_u32 s9, s9, 32768
    s_cmp_eq_u32 s9, 98304
    s_cselect_b32 s9, 0, s9
    s_waitcnt vmcnt(0)
    s_barrier
    s_add_u32 m0, s9, s7
    s_mov_b32 s72, s10
    buffer_load_dwordx4 v16, s[40:43], s72 offen lds
    s_add_u32 m0, m0, 1024
    s_nop 0
    buffer_load_dwordx4 v17, s[40:43], s72 offen lds
    s_add_u32 m0, m0, 1024
    s_nop 0
    buffer_load_dwordx4 v18, s[40:43], s72 offen lds
    s_add_u32 m0, m0, 1024
    s_nop 0
    buffer_load_dwordx4 v19, s[40:43], s72 offen lds
    s_add_u32 m0, m0, 1024
    s_nop 0
    buffer_load_dwordx4 v20, s[40:43], s72 offen lds
    s_add_u32 m0, m0, 1024
    s_nop 0
    buffer_load_dwordx4 v21, s[40:43], s72 offen lds
    s_add_u32 m0, m0, 1024
    s_nop 0
    buffer_load_dwordx4 v22, s[40:43], s72 offen lds
    s_add_u32 m0, m0, 1024
    s_nop 0
    buffer_load_dwordx4 v23, s[40:43], s72 offen lds
    s_add_u32 m0, s9, s7
    s_add_u32 m0, m0, 8192
    s_add_u32 s72, s10, 81920
    buffer_load_dwordx4 v16, s[40:43], s72 offen lds
    s_add_u32 m0, m0, 1024
    s_nop 0
    buffer_load_dwordx4 v17, s[40:43], s72 offen lds
    s_add_u32 m0, m0, 1024
    s_nop 0
    buffer_load_dwordx4 v18, s[40:43], s72 offen lds
    s_add_u32 m0, m0, 1024
    s_nop 0
    buffer_load_dwordx4 v19, s[40:43], s72 offen lds
    s_add_u32 m0, m0, 1024
    s_nop 0
    buffer_load_dwordx4 v20, s[40:43], s72 offen lds
    s_add_u32 m0, m0, 1024
    s_nop 0
    buffer_load_dwordx4 v21, s[40:43], s72 offen lds
    s_add_u32 m0, m0, 1024
    s_nop 0
    buffer_load_dwordx4 v22, s[40:43], s72 offen lds
    s_add_u32 m0, m0, 1024
    s_nop 0
    buffer_load_dwordx4 v23, s[40:43], s72 offen lds
    s_add_u32 s8, s8, 128
    s_cmp_eq_u32 s8, 1280
    s_cselect_b32 s8, 0, s8
    s_add_u32 s10, s11, s8
    s_add_u32 s9, s9, 32768
    s_cmp_eq_u32 s9, 98304
    s_cselect_b32 s9, 0, s9
L_k1_ldx_loop_kv:
    s_barrier
    s_add_u32 m0, s9, s7
    s_mov_b32 s72, s10
    buffer_load_dwordx4 v16, s[40:43], s72 offen lds
    s_add_u32 m0, m0, 1024
    s_nop 0
    buffer_load_dwordx4 v17, s[40:43], s72 offen lds
    s_add_u32 m0, m0, 1024
    s_nop 0
    buffer_load_dwordx4 v18, s[40:43], s72 offen lds
    s_add_u32 m0, m0, 1024
    s_nop 0
    buffer_load_dwordx4 v19, s[40:43], s72 offen lds
    s_add_u32 m0, m0, 1024
    s_nop 0
    buffer_load_dwordx4 v20, s[40:43], s72 offen lds
    s_add_u32 m0, m0, 1024
    s_nop 0
    buffer_load_dwordx4 v21, s[40:43], s72 offen lds
    s_add_u32 m0, m0, 1024
    s_nop 0
    buffer_load_dwordx4 v22, s[40:43], s72 offen lds
    s_add_u32 m0, m0, 1024
    s_nop 0
    buffer_load_dwordx4 v23, s[40:43], s72 offen lds
    s_waitcnt vmcnt(8)
    s_barrier
    s_add_u32 m0, s9, s7
    s_add_u32 m0, m0, 8192
    s_add_u32 s72, s10, 81920
    buffer_load_dwordx4 v16, s[40:43], s72 offen lds
    s_add_u32 m0, m0, 1024
    s_nop 0
    buffer_load_dwordx4 v17, s[40:43], s72 offen lds
    s_add_u32 m0, m0, 1024
    s_nop 0
    buffer_load_dwordx4 v18, s[40:43], s72 offen lds
    s_add_u32 m0, m0, 1024
    s_nop 0
    buffer_load_dwordx4 v19, s[40:43], s72 offen lds
    s_add_u32 m0, m0, 1024
    s_nop 0
    buffer_load_dwordx4 v20, s[40:43], s72 offen lds
    s_add_u32 m0, m0, 1024
    s_nop 0
    buffer_load_dwordx4 v21, s[40:43], s72 offen lds
    s_add_u32 m0, m0, 1024
    s_nop 0
    buffer_load_dwordx4 v22, s[40:43], s72 offen lds
    s_add_u32 m0, m0, 1024
    s_nop 0
    buffer_load_dwordx4 v23, s[40:43], s72 offen lds
    s_add_u32 s8, s8, 128
    s_cmp_eq_u32 s8, 1280
    s_cselect_b32 s8, 0, s8
    s_add_u32 s10, s11, s8
    s_add_u32 s9, s9, 32768
    s_cmp_eq_u32 s9, 98304
    s_cselect_b32 s9, 0, s9
    s_add_u32 s12, s12, 1
    s_cmp_lt_u32 s12, 8
    s_cbranch_scc1 L_k1_ldx_loop_kv
    s_barrier
    s_waitcnt vmcnt(0)
    s_barrier
    s_barrier
    s_barrier
    s_endpgm
L_k1_ldw_kv:
    s_mov_b32 s44, s18
    s_and_b32 s45, s19, 0xffff
    s_mov_b32 s46, 0x258000
    s_mov_b32 s47, 0x20000
    s_mul_i32 s72, s99, 160
    s_add_u32 s72, s72, 1280
    s_mul_i32 s74, s15, 1280
    s_add_u32 s72, s72, s74
    s_mul_i32 s74, s99, 3200
    s_add_u32 s52, s20, s74
    s_addc_u32 s53, s21, 0
    s_and_b32 s53, s53, 0xffff
    s_mov_b32 s54, 3200
    s_mov_b32 s55, 0x20000
    v_add_u32 v14, 0, v0
    v_mul_u32_u24 v15, 205, v14
    v_lshrrev_b32 v15, 11, v15
    v_mul_u32_u24 v1, 10, v15
    v_sub_u32 v14, v14, v1
    v_and_b32 v2, 4, v15
    v_and_b32 v1, 0x13, v15
    v_lshl_or_b32 v1, v2, 1, v1
    v_and_b32 v2, 8, v15
    v_lshrrev_b32 v2, 1, v2
    v_or_b32 v1, v1, v2
    v_mul_u32_u24 v1, 3840, v1
    v_add_u32 v1, s72, v1
    v_lshl_add_u32 v16, v14, 4, v1
    v_add_u32 v14, 64, v0
    v_mul_u32_u24 v15, 205, v14
    v_lshrrev_b32 v15, 11, v15
    v_mul_u32_u24 v1, 10, v15
    v_sub_u32 v14, v14, v1
    v_and_b32 v2, 4, v15
    v_and_b32 v1, 0x13, v15
    v_lshl_or_b32 v1, v2, 1, v1
    v_and_b32 v2, 8, v15
    v_lshrrev_b32 v2, 1, v2
    v_or_b32 v1, v1, v2
    v_mul_u32_u24 v1, 3840, v1
    v_add_u32 v1, s72, v1
    v_lshl_add_u32 v17, v14, 4, v1
    v_add_u32 v14, 128, v0
    v_mul_u32_u24 v15, 205, v14
    v_lshrrev_b32 v15, 11, v15
    v_mul_u32_u24 v1, 10, v15
    v_sub_u32 v14, v14, v1
    v_and_b32 v2, 4, v15
    v_and_b32 v1, 0x13, v15
    v_lshl_or_b32 v1, v2, 1, v1
    v_and_b32 v2, 8, v15
    v_lshrrev_b32 v2, 1, v2
    v_or_b32 v1, v1, v2
    v_mul_u32_u24 v1, 3840, v1
    v_add_u32 v1, s72, v1
    v_lshl_add_u32 v18, v14, 4, v1
    v_add_u32 v14, 192, v0
    v_mul_u32_u24 v15, 205, v14
    v_lshrrev_b32 v15, 11, v15
    v_mul_u32_u24 v1, 10, v15
    v_sub_u32 v14, v14, v1
    v_and_b32 v2, 4, v15
    v_and_b32 v1, 0x13, v15
    v_lshl_or_b32 v1, v2, 1, v1
    v_and_b32 v2, 8, v15
    v_lshrrev_b32 v2, 1, v2
    v_or_b32 v1, v1, v2
    v_mul_u32_u24 v1, 3840, v1
    v_add_u32 v1, s72, v1
    v_lshl_add_u32 v19, v14, 4, v1
    v_add_u32 v14, 256, v0
    v_mul_u32_u24 v15, 205, v14
    v_lshrrev_b32 v15, 11, v15
    v_mul_u32_u24 v1, 10, v15
    v_sub_u32 v14, v14, v1
    v_and_b32 v2, 4, v15
    v_and_b32 v1, 0x13, v15
    v_lshl_or_b32 v1, v2, 1, v1
    v_and_b32 v2, 8, v15
    v_lshrrev_b32 v2, 1, v2
    v_or_b32 v1, v1, v2
    v_mul_u32_u24 v1, 3840, v1
    v_add_u32 v1, s72, v1
    v_lshl_add_u32 v20, v14, 4, v1
    s_mul_i32 s11, s14, 245760
    s_mul_i32 s7, s15, 5120
    s_add_u32 s7, s7, 98304
    s_add_u32 m0, s9, s7
    s_nop 0
    buffer_load_dwordx4 v16, s[44:47], s11 offen lds
    s_add_u32 m0, m0, 1024
    s_nop 0
    buffer_load_dwordx4 v17, s[44:47], s11 offen lds
    s_add_u32 m0, m0, 1024
    s_nop 0
    buffer_load_dwordx4 v18, s[44:47], s11 offen lds
    s_add_u32 m0, m0, 1024
    s_nop 0
    buffer_load_dwordx4 v19, s[44:47], s11 offen lds
    s_add_u32 m0, m0, 1024
    s_nop 0
    buffer_load_dwordx4 v20, s[44:47], s11 offen lds
    s_add_u32 s11, s11, 122880
    s_cmp_eq_u32 s11, 2457600
    s_cselect_b32 s11, 0, s11
    s_add_u32 s9, s9, 10240
    s_cmp_eq_u32 s9, 51200
    s_cselect_b32 s9, 0, s9
    v_lshlrev_b32 v14, 4, v0
    s_lshl_b32 s73, s15, 12
    s_add_u32 m0, s73, 151552
    s_nop 0
    buffer_load_dwordx4 v14, s[52:55], s73 offen lds
    s_add_u32 m0, m0, 1024
    s_add_u32 s73, s73, 1024
    buffer_load_dwordx4 v14, s[52:55], s73 offen lds
    s_add_u32 m0, m0, 1024
    s_add_u32 s73, s73, 1024
    buffer_load_dwordx4 v14, s[52:55], s73 offen lds
    s_add_u32 m0, m0, 1024
    s_add_u32 s73, s73, 1024
    buffer_load_dwordx4 v14, s[52:55], s73 offen lds
    s_add_u32 m0, m0, 1024
    s_add_u32 s73, s73, 1024
    s_add_u32 m0, s9, s7
    s_nop 0
    buffer_load_dwordx4 v16, s[44:47], s11 offen lds
    s_add_u32 m0, m0, 1024
    s_nop 0
    buffer_load_dwordx4 v17, s[44:47], s11 offen lds
    s_add_u32 m0, m0, 1024
    s_nop 0
    buffer_load_dwordx4 v18, s[44:47], s11 offen lds
    s_add_u32 m0, m0, 1024
    s_nop 0
    buffer_load_dwordx4 v19, s[44:47], s11 offen lds
    s_add_u32 m0, m0, 1024
    s_nop 0
    buffer_load_dwordx4 v20, s[44:47], s11 offen lds
    s_add_u32 s11, s11, 122880
    s_cmp_eq_u32 s11, 2457600
    s_cselect_b32 s11, 0, s11
    s_add_u32 s9, s9, 10240
    s_cmp_eq_u32 s9, 51200
    s_cselect_b32 s9, 0, s9
    s_waitcnt vmcnt(5)
    s_barrier
    s_add_u32 m0, s9, s7
    s_nop 0
    buffer_load_dwordx4 v16, s[44:47], s11 offen lds
    s_add_u32 m0, m0, 1024
    s_nop 0
    buffer_load_dwordx4 v17, s[44:47], s11 offen lds
    s_add_u32 m0, m0, 1024
    s_nop 0
    buffer_load_dwordx4 v18, s[44:47], s11 offen lds
    s_add_u32 m0, m0, 1024
    s_nop 0
    buffer_load_dwordx4 v19, s[44:47], s11 offen lds
    s_add_u32 m0, m0, 1024
    s_nop 0
    buffer_load_dwordx4 v20, s[44:47], s11 offen lds
    s_add_u32 s11, s11, 122880
    s_cmp_eq_u32 s11, 2457600
    s_cselect_b32 s11, 0, s11
    s_add_u32 s9, s9, 10240
    s_cmp_eq_u32 s9, 51200
    s_cselect_b32 s9, 0, s9
    s_add_u32 m0, s9, s7
    s_nop 0
    buffer_load_dwordx4 v16, s[44:47], s11 offen lds
    s_add_u32 m0, m0, 1024
    s_nop 0
    buffer_load_dwordx4 v17, s[44:47], s11 offen lds
    s_add_u32 m0, m0, 1024
    s_nop 0
    buffer_load_dwordx4 v18, s[44:47], s11 offen lds
    s_add_u32 m0, m0, 1024
    s_nop 0
    buffer_load_dwordx4 v19, s[44:47], s11 offen lds
    s_add_u32 m0, m0, 1024
    s_nop 0
    buffer_load_dwordx4 v20, s[44:47], s11 offen lds
    s_add_u32 s11, s11, 122880
    s_cmp_eq_u32 s11, 2457600
    s_cselect_b32 s11, 0, s11
    s_add_u32 s9, s9, 10240
    s_cmp_eq_u32 s9, 51200
    s_cselect_b32 s9, 0, s9
L_k1_ldw_loop_kv:
    s_waitcnt vmcnt(10)
    s_barrier
    s_add_u32 m0, s9, s7
    s_nop 0
    buffer_load_dwordx4 v16, s[44:47], s11 offen lds
    s_add_u32 m0, m0, 1024
    s_nop 0
    buffer_load_dwordx4 v17, s[44:47], s11 offen lds
    s_add_u32 m0, m0, 1024
    s_nop 0
    buffer_load_dwordx4 v18, s[44:47], s11 offen lds
    s_add_u32 m0, m0, 1024
    s_nop 0
    buffer_load_dwordx4 v19, s[44:47], s11 offen lds
    s_add_u32 m0, m0, 1024
    s_nop 0
    buffer_load_dwordx4 v20, s[44:47], s11 offen lds
    s_add_u32 s11, s11, 122880
    s_cmp_eq_u32 s11, 2457600
    s_cselect_b32 s11, 0, s11
    s_add_u32 s9, s9, 10240
    s_cmp_eq_u32 s9, 51200
    s_cselect_b32 s9, 0, s9
    s_add_u32 s12, s12, 1
    s_cmp_lt_u32 s12, 16
    s_cbranch_scc1 L_k1_ldw_loop_kv
    s_waitcnt vmcnt(10)
    s_barrier
    s_waitcnt vmcnt(5)
    s_barrier
    s_waitcnt vmcnt(0)
    s_barrier
    s_barrier
    s_endpgm
L_k1_rp:
    buffer_load_dwordx4 v[92:95], v51, s[56:59], 0 offen offset:0
    buffer_load_dwordx4 v[96:99], v51, s[56:59], 0 offen offset:256
    buffer_load_dwordx4 v[100:103], v51, s[56:59], 0 offen offset:512
    buffer_load_dwordx4 v[104:107], v51, s[56:59], 0 offen offset:768
    buffer_load_dwordx4 v[108:111], v51, s[56:59], 0 offen offset:1024
    s_mul_i32 s72, s80, 5120
    buffer_load_dwordx4 v[72:75], v49, s[40:43], s72 offen offset:0
    buffer_load_dwordx4 v[76:79], v49, s[40:43], s72 offen offset:256
    buffer_load_dwordx4 v[80:83], v49, s[40:43], s72 offen offset:512
    buffer_load_dwordx4 v[84:87], v49, s[40:43], s72 offen offset:768
    buffer_load_dwordx4 v[88:91], v49, s[40:43], s72 offen offset:1024
    buffer_store_dwordx4 v[112:115], v48, s[64:67], s82 offen
    s_mov_b32 m0, s81
    s_cmp_eq_u32 s79, 1
    s_cbranch_scc1 L_k1_rp_wo
    s_cmp_eq_u32 s79, 2
    s_cbranch_scc1 L_k1_rp_wo4
    buffer_load_dwordx4 v32, s[84:87], s78 offen lds
    s_add_u32 m0, m0, 1024
    s_nop 0
    buffer_load_dwordx4 v33, s[84:87], s78 offen lds
    s_add_u32 m0, m0, 1024
    s_nop 0
    buffer_load_dwordx4 v34, s[84:87], s78 offen lds
    s_add_u32 m0, m0, 1024
    s_nop 0
    buffer_load_dwordx4 v35, s[84:87], s78 offen lds
    s_add_u32 m0, m0, 1024
    s_nop 0
    buffer_load_dwordx4 v36, s[84:87], s78 offen lds
    s_branch L_k1_rp_go
L_k1_rp_wo:
    buffer_load_dwordx4 v37, s[88:91], s78 offen lds
    s_add_u32 m0, m0, 1024
    s_nop 0
    buffer_load_dwordx4 v38, s[88:91], s78 offen lds
    s_add_u32 m0, m0, 1024
    s_nop 0
    buffer_load_dwordx4 v39, s[88:91], s78 offen lds
    s_add_u32 m0, m0, 1024
    s_nop 0
    buffer_load_dwordx4 v40, s[88:91], s78 offen lds
    s_add_u32 m0, m0, 1024
    s_nop 0
    buffer_load_dwordx4 v41, s[88:91], s78 offen lds
    s_branch L_k1_rp_go
L_k1_rp_wo4:
    buffer_load_dwordx4 v42, s[88:91], s78 offen lds
    s_add_u32 m0, m0, 1024
    s_nop 0
    buffer_load_dwordx4 v43, s[88:91], s78 offen lds
    s_add_u32 m0, m0, 1024
    s_nop 0
    buffer_load_dwordx4 v44, s[88:91], s78 offen lds
    s_add_u32 m0, m0, 1024
    s_nop 0
    buffer_load_dwordx4 v45, s[88:91], s78 offen lds
    s_add_u32 m0, m0, 1024
    s_nop 0
    buffer_load_dwordx4 v46, s[88:91], s78 offen lds
L_k1_rp_go:
    s_waitcnt vmcnt(16)
    s_barrier
    s_barrier
    s_barrier
    s_setprio 0
    s_waitcnt vmcnt(0)
    ds_read_b64_tr_b16 v[52:53], v47 offset:0
    ds_read_b64_tr_b16 v[54:55], v47 offset:1280
    ds_read_b64_tr_b16 v[56:57], v47 offset:8
    ds_read_b64_tr_b16 v[58:59], v47 offset:1288
    ds_read_b64_tr_b16 v[60:61], v47 offset:64
    ds_read_b64_tr_b16 v[62:63], v47 offset:1344
    ds_read_b64_tr_b16 v[64:65], v47 offset:72
    ds_read_b64_tr_b16 v[66:67], v47 offset:1352
    ds_read_b64_tr_b16 v[68:69], v31 offset:128
    ds_read_b64_tr_b16 v[70:71], v31 offset:1408
    s_mov_b32 s98, 0x3fb8aa3b
    v_dot2_f32_bf16 v112, v72, v92, v112
    v_dot2_f32_bf16 v113, v73, v93, v113
    v_dot2_f32_bf16 v112, v74, v94, v112
    v_dot2_f32_bf16 v113, v75, v95, v113
    v_dot2_f32_bf16 v112, v76, v96, v112
    v_dot2_f32_bf16 v113, v77, v97, v113
    v_dot2_f32_bf16 v112, v78, v98, v112
    v_dot2_f32_bf16 v113, v79, v99, v113
    v_dot2_f32_bf16 v112, v80, v100, v112
    v_dot2_f32_bf16 v113, v81, v101, v113
    v_dot2_f32_bf16 v112, v82, v102, v112
    v_dot2_f32_bf16 v113, v83, v103, v113
    v_dot2_f32_bf16 v112, v84, v104, v112
    v_dot2_f32_bf16 v113, v85, v105, v113
    v_dot2_f32_bf16 v112, v86, v106, v112
    v_dot2_f32_bf16 v113, v87, v107, v113
    v_dot2_f32_bf16 v112, v88, v108, v112
    v_dot2_f32_bf16 v113, v89, v109, v113
    v_dot2_f32_bf16 v112, v90, v110, v112
    v_dot2_f32_bf16 v113, v91, v111, v113
    s_waitcnt lgkmcnt(0)
    buffer_store_dwordx4 v[52:55], v48, s[92:95], s77 offen offset:0 sc1
    buffer_store_dwordx4 v[56:59], v48, s[92:95], s77 offen offset:1024 sc1
    buffer_store_dwordx4 v[60:63], v48, s[92:95], s77 offen offset:2048 sc1
    buffer_store_dwordx4 v[64:67], v48, s[92:95], s77 offen offset:3072 sc1
    s_add_u32 s77, s77, 4096
    buffer_store_dwordx4 v[68:71], v48, s[92:95], s77 offen sc1
    v_add_f32 v112, v112, v113
    s_nop 1
    v_add_f32_dpp v112, v112, v112 quad_perm:[1,0,3,2] row_mask:0xf bank_mask:0xf
    s_nop 1
    v_add_f32_dpp v112, v112, v112 quad_perm:[2,3,0,1] row_mask:0xf bank_mask:0xf
    s_nop 1
    v_add_f32_dpp v112, v112, v112 row_half_mirror row_mask:0xf bank_mask:0xf
    s_nop 1
    v_add_f32_dpp v112, v112, v112 row_mirror row_mask:0xf bank_mask:0xf
    v_mul_f32 v112, s98, v112
    v_exp_f32 v112, -v112
    s_nop 0
    v_add_f32 v112, 1.0, v112
    v_rcp_f32 v112, v112
    s_lshl_b32 s72, s80, 4
    buffer_store_dword v112, v50, s[60:63], s72 offen
    s_endpgm
L_k1_exit:
    s_endpgm
.globl k2_kernel
.p2align 8
.type k2_kernel,@function
k2_kernel:
    s_cmp_ge_u32 s2, 256
    s_cbranch_scc1 L_k2_exit
    s_load_dwordx8 s[32:39], s[0:1], 64
    s_and_b32 s3, s2, 7
    s_lshr_b32 s7, s2, 3
    s_lshl_b32 s3, s3, 2
    s_lshr_b32 s4, s7, 3
    s_add_u32 s4, s4, s3
    s_and_b32 s5, s7, 7
    v_lshrrev_b32 v1, 6, v0
    s_nop 0
    v_readfirstlane_b32 s6, v1
    v_and_b32 v0, 63, v0
    v_and_b32 v1, 15, v0
    v_lshrrev_b32 v2, 4, v0
    v_lshlrev_b32 v18, 4, v0
    v_add_u32 v19, 4096, v18
    v_add_u32 v5, 0, v18
    v_add_u32 v6, 55296, v18
    v_add_u32 v7, 110592, v18
    v_add_u32 v8, 165888, v18
    s_mul_i32 s76, s6, 14
    s_cmp_eq_u32 s6, 3
    s_cselect_b32 s80, 1, 0
    s_sub_u32 s76, s76, s80
    s_mul_i32 s88, s4, 216
    s_add_u32 s88, s88, s76
    s_lshl_b32 s88, s88, 10
    s_mul_i32 s89, s5, 74
    s_add_u32 s80, s89, s76
    s_mul_i32 s78, s80, 5120
    s_mov_b32 s77, s88
    s_waitcnt lgkmcnt(0)
    s_add_u32 s64, s38, 0x1000000
    s_addc_u32 s65, s39, 0
    s_and_b32 s65, s65, 0xffff
    s_mov_b32 s66, 0x2e4000
    s_mov_b32 s67, 0x20000
    s_mov_b32 s40, s38
    s_and_b32 s41, s39, 0xffff
    s_mov_b32 s42, 0x6c0000
    s_mov_b32 s43, 0x20000
    buffer_load_dwordx4 a[0:3], v18, s[64:67], s78 offen offset:0
    buffer_load_dwordx4 a[4:7], v18, s[64:67], s78 offen offset:1024
    buffer_load_dwordx4 a[8:11], v18, s[64:67], s78 offen offset:2048
    buffer_load_dwordx4 a[12:15], v18, s[64:67], s78 offen offset:3072
    buffer_load_dwordx4 a[16:19], v19, s[64:67], s78 offen offset:0
    buffer_load_dwordx4 a[20:23], v5, s[40:43], s77 offen
    buffer_load_dwordx4 a[24:27], v6, s[40:43], s77 offen
    buffer_load_dwordx4 a[28:31], v7, s[40:43], s77 offen
    buffer_load_dwordx4 a[32:35], v8, s[40:43], s77 offen
    s_add_u32 s77, s77, 1024
    s_add_u32 s78, s78, 5120
    buffer_load_dwordx4 a[36:39], v18, s[64:67], s78 offen offset:0
    buffer_load_dwordx4 a[40:43], v18, s[64:67], s78 offen offset:1024
    buffer_load_dwordx4 a[44:47], v18, s[64:67], s78 offen offset:2048
    buffer_load_dwordx4 a[48:51], v18, s[64:67], s78 offen offset:3072
    buffer_load_dwordx4 a[52:55], v19, s[64:67], s78 offen offset:0
    buffer_load_dwordx4 a[56:59], v5, s[40:43], s77 offen
    buffer_load_dwordx4 a[60:63], v6, s[40:43], s77 offen
    buffer_load_dwordx4 a[64:67], v7, s[40:43], s77 offen
    buffer_load_dwordx4 a[68:71], v8, s[40:43], s77 offen
    s_add_u32 s77, s77, 1024
    s_add_u32 s78, s78, 5120
    v_bfe_u32 v3, v0, 2, 2
    v_and_b32 v4, 3, v0
    s_add_u32 s44, s38, 0x700000
    s_addc_u32 s45, s39, 0
    s_and_b32 s45, s45, 0xffff
    s_mov_b32 s46, 0x500000
    s_mov_b32 s47, 0x20000
    s_add_u32 s48, s38, 0xc00000
    s_addc_u32 s49, s39, 0
    s_and_b32 s49, s49, 0xffff
    s_mov_b32 s50, 0x140000
    s_mov_b32 s51, 0x20000
    s_add_u32 s52, s38, 0xe00000
    s_addc_u32 s53, s39, 0
    s_and_b32 s53, s53, 0xffff
    s_mov_b32 s54, 0x14000
    s_mov_b32 s55, 0x20000
    s_add_u32 s56, s38, 0xe20000
    s_addc_u32 s57, s39, 0
    s_and_b32 s57, s57, 0xffff
    s_mov_b32 s58, 0x400
    s_mov_b32 s59, 0x20000
    s_add_u32 s60, s38, 0xe30000
    s_addc_u32 s61, s39, 0
    s_and_b32 s61, s61, 0xffff
    s_mov_b32 s62, 0x2000
    s_mov_b32 s63, 0x20000
    s_mov_b32 s72, s34
    s_and_b32 s73, s35, 0xffff
    s_mov_b32 s74, 0x280000
    s_mov_b32 s75, 0x20000
    v_mov_b32 v34, 0x40000000
    v_cmp_gt_u32 vcc, 40, v0
    v_lshlrev_b32 v33, 3, v0
    s_nop 0
    v_cndmask_b32 v21, v34, v18, vcc
    v_cndmask_b32 v22, v34, v33, vcc
    s_cmp_eq_u32 s6, 0
    s_cselect_b32 s84, 0, 0x40000000
    s_mul_i32 s80, s2, 640
    s_add_u32 s80, s80, s84
    buffer_load_dwordx4 v[200:203], v21, s[48:51], s80 offen
    s_add_u32 s80, s80, 163840
    buffer_load_dwordx4 v[204:207], v21, s[48:51], s80 offen
    s_add_u32 s80, s80, 163840
    buffer_load_dwordx4 v[208:211], v21, s[48:51], s80 offen
    s_add_u32 s80, s80, 163840
    buffer_load_dwordx4 v[212:215], v21, s[48:51], s80 offen
    s_add_u32 s80, s80, 163840
    buffer_load_dwordx4 v[216:219], v21, s[48:51], s80 offen
    s_add_u32 s80, s80, 163840
    buffer_load_dwordx4 v[220:223], v21, s[48:51], s80 offen
    s_add_u32 s80, s80, 163840
    buffer_load_dwordx4 v[224:227], v21, s[48:51], s80 offen
    s_add_u32 s80, s80, 163840
    buffer_load_dwordx4 v[228:231], v21, s[48:51], s80 offen
    buffer_load_dwordx4 a[72:75], v18, s[64:67], s78 offen offset:0
    buffer_load_dwordx4 a[76:79], v18, s[64:67], s78 offen offset:1024
    buffer_load_dwordx4 a[80:83], v18, s[64:67], s78 offen offset:2048
    buffer_load_dwordx4 a[84:87], v18, s[64:67], s78 offen offset:3072
    buffer_load_dwordx4 a[88:91], v19, s[64:67], s78 offen offset:0
    buffer_load_dwordx4 a[92:95], v5, s[40:43], s77 offen
    buffer_load_dwordx4 a[96:99], v6, s[40:43], s77 offen
    buffer_load_dwordx4 a[100:103], v7, s[40:43], s77 offen
    buffer_load_dwordx4 a[104:107], v8, s[40:43], s77 offen
    s_add_u32 s77, s77, 1024
    s_add_u32 s78, s78, 5120
    v_lshlrev_b32 v20, 4, v1
    v_mul_u32_u24 v32, 40960, v2
    v_add3_u32 v14, v32, v20, 0
    v_add_u32 v14, 1024, v14
    v_add_u32 v10, 0, v18
    v_add_u32 v11, 40960, v18
    v_add_u32 v12, 81920, v18
    v_add_u32 v13, 122880, v18
    s_mov_b32 s8, 0xffff
    s_mov_b32 s9, 0x0
    s_mov_b32 s10, 0xffff0000
    s_mov_b32 s11, 0x0
    s_mov_b32 s12, 0x0
    s_mov_b32 s13, 0xffff
    s_mov_b32 s14, 0x0
    s_mov_b32 s15, 0xffff0000
    s_lshl_b32 s87, s4, 7
    s_lshl_b32 s80, s6, 3
    s_add_u32 s87, s87, s80
    s_mul_i32 s87, s87, 1280
    s_mul_i32 s86, s6, 20480
    s_lshl_b32 s80, s4, 8
    v_lshlrev_b32 v35, 2, v1
    buffer_load_dword v28, v35, s[60:63], s80 offen offset:0
    buffer_load_dword v29, v35, s[60:63], s80 offen offset:64
    buffer_load_dword v30, v35, s[60:63], s80 offen offset:128
    buffer_load_dword v31, v35, s[60:63], s80 offen offset:192
    buffer_load_dwordx4 a[108:111], v18, s[64:67], s78 offen offset:0
    buffer_load_dwordx4 a[112:115], v18, s[64:67], s78 offen offset:1024
    buffer_load_dwordx4 a[116:119], v18, s[64:67], s78 offen offset:2048
    buffer_load_dwordx4 a[120:123], v18, s[64:67], s78 offen offset:3072
    buffer_load_dwordx4 a[124:127], v19, s[64:67], s78 offen offset:0
    buffer_load_dwordx4 a[128:131], v5, s[40:43], s77 offen
    buffer_load_dwordx4 a[132:135], v6, s[40:43], s77 offen
    buffer_load_dwordx4 a[136:139], v7, s[40:43], s77 offen
    buffer_load_dwordx4 a[140:143], v8, s[40:43], s77 offen
    s_add_u32 s77, s77, 1024
    s_add_u32 s78, s78, 5120
    s_waitcnt vmcnt(39)
    v_mfma_f32_16x16x32_bf16 v[40:43], a[0:3], a[20:23], 0
    v_mfma_f32_16x16x32_bf16 v[60:63], a[0:3], a[24:27], 0
    v_mfma_f32_16x16x32_bf16 v[80:83], a[0:3], a[28:31], 0
    v_mfma_f32_16x16x32_bf16 v[100:103], a[0:3], a[32:35], 0
    v_mfma_f32_16x16x32_bf16 v[44:47], a[4:7], a[20:23], 0
    v_mfma_f32_16x16x32_bf16 v[64:67], a[4:7], a[24:27], 0
    v_mfma_f32_16x16x32_bf16 v[84:87], a[4:7], a[28:31], 0
    v_mfma_f32_16x16x32_bf16 v[104:107], a[4:7], a[32:35], 0
    v_mfma_f32_16x16x32_bf16 v[48:51], a[8:11], a[20:23], 0
    v_mfma_f32_16x16x32_bf16 v[68:71], a[8:11], a[24:27], 0
    v_mfma_f32_16x16x32_bf16 v[88:91], a[8:11], a[28:31], 0
    v_mfma_f32_16x16x32_bf16 v[108:111], a[8:11], a[32:35], 0
    v_mfma_f32_16x16x32_bf16 v[52:55], a[12:15], a[20:23], 0
    v_mfma_f32_16x16x32_bf16 v[72:75], a[12:15], a[24:27], 0
    v_mfma_f32_16x16x32_bf16 v[92:95], a[12:15], a[28:31], 0
    v_mfma_f32_16x16x32_bf16 v[112:115], a[12:15], a[32:35], 0
    v_mfma_f32_16x16x32_bf16 v[56:59], a[16:19], a[20:23], 0
    v_mfma_f32_16x16x32_bf16 v[76:79], a[16:19], a[24:27], 0
    v_mfma_f32_16x16x32_bf16 v[96:99], a[16:19], a[28:31], 0
    v_mfma_f32_16x16x32_bf16 v[116:119], a[16:19], a[32:35], 0
    buffer_load_dwordx4 a[0:3], v18, s[64:67], s78 offen offset:0
    buffer_load_dwordx4 a[4:7], v18, s[64:67], s78 offen offset:1024
    buffer_load_dwordx4 a[8:11], v18, s[64:67], s78 offen offset:2048
    buffer_load_dwordx4 a[12:15], v18, s[64:67], s78 offen offset:3072
    buffer_load_dwordx4 a[16:19], v19, s[64:67], s78 offen offset:0
    buffer_load_dwordx4 a[20:23], v5, s[40:43], s77 offen
    buffer_load_dwordx4 a[24:27], v6, s[40:43], s77 offen
    buffer_load_dwordx4 a[28:31], v7, s[40:43], s77 offen
    buffer_load_dwordx4 a[32:35], v8, s[40:43], s77 offen
    s_add_u32 s77, s77, 1024
    s_add_u32 s78, s78, 5120
    s_waitcnt vmcnt(31)
    v_add_f32 v200, v200, v216
    v_add_f32 v201, v201, v217
    v_add_f32 v202, v202, v218
    v_add_f32 v203, v203, v219
    v_add_f32 v204, v204, v220
    v_add_f32 v205, v205, v221
    v_add_f32 v206, v206, v222
    v_add_f32 v207, v207, v223
    v_add_f32 v208, v208, v224
    v_add_f32 v209, v209, v225
    v_add_f32 v210, v210, v226
    v_add_f32 v211, v211, v227
    v_add_f32 v212, v212, v228
    v_add_f32 v213, v213, v229
    v_add_f32 v214, v214, v230
    v_add_f32 v215, v215, v231
    v_add_f32 v200, v200, v208
    v_add_f32 v201, v201, v209
    v_add_f32 v202, v202, v210
    v_add_f32 v203, v203, v211
    v_add_f32 v204, v204, v212
    v_add_f32 v205, v205, v213
    v_add_f32 v206, v206, v214
    v_add_f32 v207, v207, v215
    v_add_f32 v200, v200, v204
    v_add_f32 v201, v201, v205
    v_add_f32 v202, v202, v206
    v_add_f32 v203, v203, v207
    v_cvt_pk_bf16_f32 v200, v200, v201
    v_cvt_pk_bf16_f32 v201, v202, v203
    s_mul_i32 s80, s2, 320
    s_add_u32 s80, s80, s84
    buffer_store_dwordx2 v[200:201], v22, s[52:55], s80 offen sc1
    v_mfma_f32_16x16x32_bf16 v[40:43], a[36:39], a[56:59], v[40:43]
    v_mfma_f32_16x16x32_bf16 v[60:63], a[36:39], a[60:63], v[60:63]
    v_mfma_f32_16x16x32_bf16 v[80:83], a[36:39], a[64:67], v[80:83]
    v_mfma_f32_16x16x32_bf16 v[100:103], a[36:39], a[68:71], v[100:103]
    v_mfma_f32_16x16x32_bf16 v[44:47], a[40:43], a[56:59], v[44:47]
    v_mfma_f32_16x16x32_bf16 v[64:67], a[40:43], a[60:63], v[64:67]
    v_mfma_f32_16x16x32_bf16 v[84:87], a[40:43], a[64:67], v[84:87]
    v_mfma_f32_16x16x32_bf16 v[104:107], a[40:43], a[68:71], v[104:107]
    v_mfma_f32_16x16x32_bf16 v[48:51], a[44:47], a[56:59], v[48:51]
    v_mfma_f32_16x16x32_bf16 v[68:71], a[44:47], a[60:63], v[68:71]
    v_mfma_f32_16x16x32_bf16 v[88:91], a[44:47], a[64:67], v[88:91]
    v_mfma_f32_16x16x32_bf16 v[108:111], a[44:47], a[68:71], v[108:111]
    v_mfma_f32_16x16x32_bf16 v[52:55], a[48:51], a[56:59], v[52:55]
    v_mfma_f32_16x16x32_bf16 v[72:75], a[48:51], a[60:63], v[72:75]
    v_mfma_f32_16x16x32_bf16 v[92:95], a[48:51], a[64:67], v[92:95]
    v_mfma_f32_16x16x32_bf16 v[112:115], a[48:51], a[68:71], v[112:115]
    v_mfma_f32_16x16x32_bf16 v[56:59], a[52:55], a[56:59], v[56:59]
    v_mfma_f32_16x16x32_bf16 v[76:79], a[52:55], a[60:63], v[76:79]
    v_mfma_f32_16x16x32_bf16 v[96:99], a[52:55], a[64:67], v[96:99]
    v_mfma_f32_16x16x32_bf16 v[116:119], a[52:55], a[68:71], v[116:119]
    buffer_load_dwordx4 a[36:39], v18, s[64:67], s78 offen offset:0
    buffer_load_dwordx4 a[40:43], v18, s[64:67], s78 offen offset:1024
    buffer_load_dwordx4 a[44:47], v18, s[64:67], s78 offen offset:2048
    buffer_load_dwordx4 a[48:51], v18, s[64:67], s78 offen offset:3072
    buffer_load_dwordx4 a[52:55], v19, s[64:67], s78 offen offset:0
    buffer_load_dwordx4 a[56:59], v5, s[40:43], s77 offen
    buffer_load_dwordx4 a[60:63], v6, s[40:43], s77 offen
    buffer_load_dwordx4 a[64:67], v7, s[40:43], s77 offen
    buffer_load_dwordx4 a[68:71], v8, s[40:43], s77 offen
    s_add_u32 s77, s77, 1024
    s_add_u32 s78, s78, 5120
    s_waitcnt vmcnt(32)
    v_mfma_f32_16x16x32_bf16 v[40:43], a[72:75], a[92:95], v[40:43]
    v_mfma_f32_16x16x32_bf16 v[60:63], a[72:75], a[96:99], v[60:63]
    v_mfma_f32_16x16x32_bf16 v[80:83], a[72:75], a[100:103], v[80:83]
    v_mfma_f32_16x16x32_bf16 v[100:103], a[72:75], a[104:107], v[100:103]
    v_mfma_f32_16x16x32_bf16 v[44:47], a[76:79], a[92:95], v[44:47]
    v_mfma_f32_16x16x32_bf16 v[64:67], a[76:79], a[96:99], v[64:67]
    v_mfma_f32_16x16x32_bf16 v[84:87], a[76:79], a[100:103], v[84:87]
    v_mfma_f32_16x16x32_bf16 v[104:107], a[76:79], a[104:107], v[104:107]
    v_mfma_f32_16x16x32_bf16 v[48:51], a[80:83], a[92:95], v[48:51]
    v_mfma_f32_16x16x32_bf16 v[68:71], a[80:83], a[96:99], v[68:71]
    v_mfma_f32_16x16x32_bf16 v[88:91], a[80:83], a[100:103], v[88:91]
    v_mfma_f32_16x16x32_bf16 v[108:111], a[80:83], a[104:107], v[108:111]
    v_mfma_f32_16x16x32_bf16 v[52:55], a[84:87], a[92:95], v[52:55]
    v_mfma_f32_16x16x32_bf16 v[72:75], a[84:87], a[96:99], v[72:75]
    v_mfma_f32_16x16x32_bf16 v[92:95], a[84:87], a[100:103], v[92:95]
    v_mfma_f32_16x16x32_bf16 v[112:115], a[84:87], a[104:107], v[112:115]
    v_mfma_f32_16x16x32_bf16 v[56:59], a[88:91], a[92:95], v[56:59]
    v_mfma_f32_16x16x32_bf16 v[76:79], a[88:91], a[96:99], v[76:79]
    v_mfma_f32_16x16x32_bf16 v[96:99], a[88:91], a[100:103], v[96:99]
    v_mfma_f32_16x16x32_bf16 v[116:119], a[88:91], a[104:107], v[116:119]
    buffer_load_dwordx4 a[72:75], v18, s[64:67], s78 offen offset:0
    buffer_load_dwordx4 a[76:79], v18, s[64:67], s78 offen offset:1024
    buffer_load_dwordx4 a[80:83], v18, s[64:67], s78 offen offset:2048
    buffer_load_dwordx4 a[84:87], v18, s[64:67], s78 offen offset:3072
    buffer_load_dwordx4 a[88:91], v19, s[64:67], s78 offen offset:0
    buffer_load_dwordx4 a[92:95], v5, s[40:43], s77 offen
    buffer_load_dwordx4 a[96:99], v6, s[40:43], s77 offen
    buffer_load_dwordx4 a[100:103], v7, s[40:43], s77 offen
    buffer_load_dwordx4 a[104:107], v8, s[40:43], s77 offen
    s_add_u32 s77, s77, 1024
    s_add_u32 s78, s78, 5120
    s_waitcnt vmcnt(9)
    v_mov_b32 v32, 0x40000000
    v_cmp_eq_u32 vcc, 0, v0
    s_nop 1
    v_cndmask_b32 v32, v32, v0, vcc
    v_mov_b32 v33, 1
    s_lshl_b32 s80, s2, 2
    s_add_u32 s80, s80, s84
    buffer_store_dword v33, v32, s[56:59], s80 offen sc1
    v_mfma_f32_16x16x32_bf16 v[40:43], a[108:111], a[128:131], v[40:43]
    v_mfma_f32_16x16x32_bf16 v[60:63], a[108:111], a[132:135], v[60:63]
    v_mfma_f32_16x16x32_bf16 v[80:83], a[108:111], a[136:139], v[80:83]
    v_mfma_f32_16x16x32_bf16 v[100:103], a[108:111], a[140:143], v[100:103]
    v_mfma_f32_16x16x32_bf16 v[44:47], a[112:115], a[128:131], v[44:47]
    v_mfma_f32_16x16x32_bf16 v[64:67], a[112:115], a[132:135], v[64:67]
    v_mfma_f32_16x16x32_bf16 v[84:87], a[112:115], a[136:139], v[84:87]
    v_mfma_f32_16x16x32_bf16 v[104:107], a[112:115], a[140:143], v[104:107]
    v_mfma_f32_16x16x32_bf16 v[48:51], a[116:119], a[128:131], v[48:51]
    v_mfma_f32_16x16x32_bf16 v[68:71], a[116:119], a[132:135], v[68:71]
    v_mfma_f32_16x16x32_bf16 v[88:91], a[116:119], a[136:139], v[88:91]
    v_mfma_f32_16x16x32_bf16 v[108:111], a[116:119], a[140:143], v[108:111]
    v_mfma_f32_16x16x32_bf16 v[52:55], a[120:123], a[128:131], v[52:55]
    v_mfma_f32_16x16x32_bf16 v[72:75], a[120:123], a[132:135], v[72:75]
    v_mfma_f32_16x16x32_bf16 v[92:95], a[120:123], a[136:139], v[92:95]
    v_mfma_f32_16x16x32_bf16 v[112:115], a[120:123], a[140:143], v[112:115]
    v_mfma_f32_16x16x32_bf16 v[56:59], a[124:127], a[128:131], v[56:59]
    v_mfma_f32_16x16x32_bf16 v[76:79], a[124:127], a[132:135], v[76:79]
    v_mfma_f32_16x16x32_bf16 v[96:99], a[124:127], a[136:139], v[96:99]
    v_mfma_f32_16x16x32_bf16 v[116:119], a[124:127], a[140:143], v[116:119]
    buffer_load_dwordx4 a[108:111], v18, s[64:67], s78 offen offset:0
    buffer_load_dwordx4 a[112:115], v18, s[64:67], s78 offen offset:1024
    buffer_load_dwordx4 a[116:119], v18, s[64:67], s78 offen offset:2048
    buffer_load_dwordx4 a[120:123], v18, s[64:67], s78 offen offset:3072
    buffer_load_dwordx4 a[124:127], v19, s[64:67], s78 offen offset:0
    buffer_load_dwordx4 a[128:131], v5, s[40:43], s77 offen
    buffer_load_dwordx4 a[132:135], v6, s[40:43], s77 offen
    buffer_load_dwordx4 a[136:139], v7, s[40:43], s77 offen
    buffer_load_dwordx4 a[140:143], v8, s[40:43], s77 offen
    s_add_u32 s77, s77, 1024
    s_add_u32 s78, s78, 5120
    v_mfma_f32_16x16x32_bf16 v[40:43], a[0:3], a[20:23], v[40:43]
    v_mfma_f32_16x16x32_bf16 v[60:63], a[0:3], a[24:27], v[60:63]
    v_mfma_f32_16x16x32_bf16 v[80:83], a[0:3], a[28:31], v[80:83]
    v_mfma_f32_16x16x32_bf16 v[100:103], a[0:3], a[32:35], v[100:103]
    v_mfma_f32_16x16x32_bf16 v[44:47], a[4:7], a[20:23], v[44:47]
    v_mfma_f32_16x16x32_bf16 v[64:67], a[4:7], a[24:27], v[64:67]
    v_mfma_f32_16x16x32_bf16 v[84:87], a[4:7], a[28:31], v[84:87]
    v_mfma_f32_16x16x32_bf16 v[104:107], a[4:7], a[32:35], v[104:107]
    v_mfma_f32_16x16x32_bf16 v[48:51], a[8:11], a[20:23], v[48:51]
    v_mfma_f32_16x16x32_bf16 v[68:71], a[8:11], a[24:27], v[68:71]
    v_mfma_f32_16x16x32_bf16 v[88:91], a[8:11], a[28:31], v[88:91]
    v_mfma_f32_16x16x32_bf16 v[108:111], a[8:11], a[32:35], v[108:111]
    v_mfma_f32_16x16x32_bf16 v[52:55], a[12:15], a[20:23], v[52:55]
    v_mfma_f32_16x16x32_bf16 v[72:75], a[12:15], a[24:27], v[72:75]
    v_mfma_f32_16x16x32_bf16 v[92:95], a[12:15], a[28:31], v[92:95]
    v_mfma_f32_16x16x32_bf16 v[112:115], a[12:15], a[32:35], v[112:115]
    v_mfma_f32_16x16x32_bf16 v[56:59], a[16:19], a[20:23], v[56:59]
    v_mfma_f32_16x16x32_bf16 v[76:79], a[16:19], a[24:27], v[76:79]
    v_mfma_f32_16x16x32_bf16 v[96:99], a[16:19], a[28:31], v[96:99]
    v_mfma_f32_16x16x32_bf16 v[116:119], a[16:19], a[32:35], v[116:119]
    buffer_load_dwordx4 a[0:3], v18, s[64:67], s78 offen offset:0
    buffer_load_dwordx4 a[4:7], v18, s[64:67], s78 offen offset:1024
    buffer_load_dwordx4 a[8:11], v18, s[64:67], s78 offen offset:2048
    buffer_load_dwordx4 a[12:15], v18, s[64:67], s78 offen offset:3072
    buffer_load_dwordx4 a[16:19], v19, s[64:67], s78 offen offset:0
    buffer_load_dwordx4 a[20:23], v5, s[40:43], s77 offen
    buffer_load_dwordx4 a[24:27], v6, s[40:43], s77 offen
    buffer_load_dwordx4 a[28:31], v7, s[40:43], s77 offen
    buffer_load_dwordx4 a[32:35], v8, s[40:43], s77 offen
    s_add_u32 s77, s77, 1024
    s_add_u32 s78, s78, 5120
    v_mfma_f32_16x16x32_bf16 v[40:43], a[36:39], a[56:59], v[40:43]
    v_mfma_f32_16x16x32_bf16 v[60:63], a[36:39], a[60:63], v[60:63]
    v_mfma_f32_16x16x32_bf16 v[80:83], a[36:39], a[64:67], v[80:83]
    v_mfma_f32_16x16x32_bf16 v[100:103], a[36:39], a[68:71], v[100:103]
    v_mfma_f32_16x16x32_bf16 v[44:47], a[40:43], a[56:59], v[44:47]
    v_mfma_f32_16x16x32_bf16 v[64:67], a[40:43], a[60:63], v[64:67]
    v_mfma_f32_16x16x32_bf16 v[84:87], a[40:43], a[64:67], v[84:87]
    v_mfma_f32_16x16x32_bf16 v[104:107], a[40:43], a[68:71], v[104:107]
    v_mfma_f32_16x16x32_bf16 v[48:51], a[44:47], a[56:59], v[48:51]
    v_mfma_f32_16x16x32_bf16 v[68:71], a[44:47], a[60:63], v[68:71]
    v_mfma_f32_16x16x32_bf16 v[88:91], a[44:47], a[64:67], v[88:91]
    v_mfma_f32_16x16x32_bf16 v[108:111], a[44:47], a[68:71], v[108:111]
    v_mfma_f32_16x16x32_bf16 v[52:55], a[48:51], a[56:59], v[52:55]
    v_mfma_f32_16x16x32_bf16 v[72:75], a[48:51], a[60:63], v[72:75]
    v_mfma_f32_16x16x32_bf16 v[92:95], a[48:51], a[64:67], v[92:95]
    v_mfma_f32_16x16x32_bf16 v[112:115], a[48:51], a[68:71], v[112:115]
    v_mfma_f32_16x16x32_bf16 v[56:59], a[52:55], a[56:59], v[56:59]
    v_mfma_f32_16x16x32_bf16 v[76:79], a[52:55], a[60:63], v[76:79]
    v_mfma_f32_16x16x32_bf16 v[96:99], a[52:55], a[64:67], v[96:99]
    v_mfma_f32_16x16x32_bf16 v[116:119], a[52:55], a[68:71], v[116:119]
    buffer_load_dwordx4 a[36:39], v18, s[64:67], s78 offen offset:0
    buffer_load_dwordx4 a[40:43], v18, s[64:67], s78 offen offset:1024
    buffer_load_dwordx4 a[44:47], v18, s[64:67], s78 offen offset:2048
    buffer_load_dwordx4 a[48:51], v18, s[64:67], s78 offen offset:3072
    buffer_load_dwordx4 a[52:55], v19, s[64:67], s78 offen offset:0
    buffer_load_dwordx4 a[56:59], v5, s[40:43], s77 offen
    buffer_load_dwordx4 a[60:63], v6, s[40:43], s77 offen
    buffer_load_dwordx4 a[64:67], v7, s[40:43], s77 offen
    buffer_load_dwordx4 a[68:71], v8, s[40:43], s77 offen
    s_add_u32 s77, s77, 1024
    s_add_u32 s78, s78, 5120
    s_waitcnt vmcnt(28)
    v_mfma_f32_16x16x32_bf16 v[40:43], a[72:75], a[92:95], v[40:43]
    v_mfma_f32_16x16x32_bf16 v[60:63], a[72:75], a[96:99], v[60:63]
    v_mfma_f32_16x16x32_bf16 v[80:83], a[72:75], a[100:103], v[80:83]
    v_mfma_f32_16x16x32_bf16 v[100:103], a[72:75], a[104:107], v[100:103]
    v_mfma_f32_16x16x32_bf16 v[44:47], a[76:79], a[92:95], v[44:47]
    v_mfma_f32_16x16x32_bf16 v[64:67], a[76:79], a[96:99], v[64:67]
    v_mfma_f32_16x16x32_bf16 v[84:87], a[76:79], a[100:103], v[84:87]
    v_mfma_f32_16x16x32_bf16 v[104:107], a[76:79], a[104:107], v[104:107]
    v_mfma_f32_16x16x32_bf16 v[48:51], a[80:83], a[92:95], v[48:51]
    v_mfma_f32_16x16x32_bf16 v[68:71], a[80:83], a[96:99], v[68:71]
    v_mfma_f32_16x16x32_bf16 v[88:91], a[80:83], a[100:103], v[88:91]
    v_mfma_f32_16x16x32_bf16 v[108:111], a[80:83], a[104:107], v[108:111]
    v_mfma_f32_16x16x32_bf16 v[52:55], a[84:87], a[92:95], v[52:55]
    v_mfma_f32_16x16x32_bf16 v[72:75], a[84:87], a[96:99], v[72:75]
    v_mfma_f32_16x16x32_bf16 v[92:95], a[84:87], a[100:103], v[92:95]
    v_mfma_f32_16x16x32_bf16 v[112:115], a[84:87], a[104:107], v[112:115]
    v_mfma_f32_16x16x32_bf16 v[56:59], a[88:91], a[92:95], v[56:59]
    v_mfma_f32_16x16x32_bf16 v[76:79], a[88:91], a[96:99], v[76:79]
    v_mfma_f32_16x16x32_bf16 v[96:99], a[88:91], a[100:103], v[96:99]
    v_mfma_f32_16x16x32_bf16 v[116:119], a[88:91], a[104:107], v[116:119]
    buffer_load_dwordx4 a[72:75], v18, s[64:67], s78 offen offset:0
    buffer_load_dwordx4 a[76:79], v18, s[64:67], s78 offen offset:1024
    buffer_load_dwordx4 a[80:83], v18, s[64:67], s78 offen offset:2048
    buffer_load_dwordx4 a[84:87], v18, s[64:67], s78 offen offset:3072
    buffer_load_dwordx4 a[88:91], v19, s[64:67], s78 offen offset:0
    buffer_load_dwordx4 a[92:95], v5, s[40:43], s77 offen
    buffer_load_dwordx4 a[96:99], v6, s[40:43], s77 offen
    buffer_load_dwordx4 a[100:103], v7, s[40:43], s77 offen
    buffer_load_dwordx4 a[104:107], v8, s[40:43], s77 offen
    s_add_u32 s77, s77, 1024
    s_add_u32 s78, s78, 5120
    s_waitcnt vmcnt(27)
    v_mfma_f32_16x16x32_bf16 v[40:43], a[108:111], a[128:131], v[40:43]
    v_mfma_f32_16x16x32_bf16 v[60:63], a[108:111], a[132:135], v[60:63]
    v_mfma_f32_16x16x32_bf16 v[80:83], a[108:111], a[136:139], v[80:83]
    v_mfma_f32_16x16x32_bf16 v[100:103], a[108:111], a[140:143], v[100:103]
    v_mfma_f32_16x16x32_bf16 v[44:47], a[112:115], a[128:131], v[44:47]
    v_mfma_f32_16x16x32_bf16 v[64:67], a[112:115], a[132:135], v[64:67]
    v_mfma_f32_16x16x32_bf16 v[84:87], a[112:115], a[136:139], v[84:87]
    v_mfma_f32_16x16x32_bf16 v[104:107], a[112:115], a[140:143], v[104:107]
    v_mfma_f32_16x16x32_bf16 v[48:51], a[116:119], a[128:131], v[48:51]
    v_mfma_f32_16x16x32_bf16 v[68:71], a[116:119], a[132:135], v[68:71]
    v_mfma_f32_16x16x32_bf16 v[88:91], a[116:119], a[136:139], v[88:91]
    v_mfma_f32_16x16x32_bf16 v[108:111], a[116:119], a[140:143], v[108:111]
    v_mfma_f32_16x16x32_bf16 v[52:55], a[120:123], a[128:131], v[52:55]
    v_mfma_f32_16x16x32_bf16 v[72:75], a[120:123], a[132:135], v[72:75]
    v_mfma_f32_16x16x32_bf16 v[92:95], a[120:123], a[136:139], v[92:95]
    v_mfma_f32_16x16x32_bf16 v[112:115], a[120:123], a[140:143], v[112:115]
    v_mfma_f32_16x16x32_bf16 v[56:59], a[124:127], a[128:131], v[56:59]
    v_mfma_f32_16x16x32_bf16 v[76:79], a[124:127], a[132:135], v[76:79]
    v_mfma_f32_16x16x32_bf16 v[96:99], a[124:127], a[136:139], v[96:99]
    v_mfma_f32_16x16x32_bf16 v[116:119], a[124:127], a[140:143], v[116:119]
    buffer_load_dwordx4 a[108:111], v18, s[64:67], s78 offen offset:0
    buffer_load_dwordx4 a[112:115], v18, s[64:67], s78 offen offset:1024
    buffer_load_dwordx4 a[116:119], v18, s[64:67], s78 offen offset:2048
    buffer_load_dwordx4 a[120:123], v18, s[64:67], s78 offen offset:3072
    buffer_load_dwordx4 a[124:127], v19, s[64:67], s78 offen offset:0
    buffer_load_dwordx4 a[128:131], v5, s[40:43], s77 offen
    buffer_load_dwordx4 a[132:135], v6, s[40:43], s77 offen
    buffer_load_dwordx4 a[136:139], v7, s[40:43], s77 offen
    buffer_load_dwordx4 a[140:143], v8, s[40:43], s77 offen
    s_add_u32 s77, s77, 1024
    s_add_u32 s78, s78, 5120
    s_waitcnt vmcnt(27)
    v_mfma_f32_16x16x32_bf16 v[40:43], a[0:3], a[20:23], v[40:43]
    v_mfma_f32_16x16x32_bf16 v[60:63], a[0:3], a[24:27], v[60:63]
    v_mfma_f32_16x16x32_bf16 v[80:83], a[0:3], a[28:31], v[80:83]
    v_mfma_f32_16x16x32_bf16 v[100:103], a[0:3], a[32:35], v[100:103]
    v_mfma_f32_16x16x32_bf16 v[44:47], a[4:7], a[20:23], v[44:47]
    v_mfma_f32_16x16x32_bf16 v[64:67], a[4:7], a[24:27], v[64:67]
    v_mfma_f32_16x16x32_bf16 v[84:87], a[4:7], a[28:31], v[84:87]
    v_mfma_f32_16x16x32_bf16 v[104:107], a[4:7], a[32:35], v[104:107]
    v_mfma_f32_16x16x32_bf16 v[48:51], a[8:11], a[20:23], v[48:51]
    v_mfma_f32_16x16x32_bf16 v[68:71], a[8:11], a[24:27], v[68:71]
    v_mfma_f32_16x16x32_bf16 v[88:91], a[8:11], a[28:31], v[88:91]
    v_mfma_f32_16x16x32_bf16 v[108:111], a[8:11], a[32:35], v[108:111]
    v_mfma_f32_16x16x32_bf16 v[52:55], a[12:15], a[20:23], v[52:55]
    v_mfma_f32_16x16x32_bf16 v[72:75], a[12:15], a[24:27], v[72:75]
    v_mfma_f32_16x16x32_bf16 v[92:95], a[12:15], a[28:31], v[92:95]
    v_mfma_f32_16x16x32_bf16 v[112:115], a[12:15], a[32:35], v[112:115]
    v_mfma_f32_16x16x32_bf16 v[56:59], a[16:19], a[20:23], v[56:59]
    v_mfma_f32_16x16x32_bf16 v[76:79], a[16:19], a[24:27], v[76:79]
    v_mfma_f32_16x16x32_bf16 v[96:99], a[16:19], a[28:31], v[96:99]
    v_mfma_f32_16x16x32_bf16 v[116:119], a[16:19], a[32:35], v[116:119]
    buffer_load_dwordx4 a[0:3], v18, s[64:67], s78 offen offset:0
    buffer_load_dwordx4 a[4:7], v18, s[64:67], s78 offen offset:1024
    buffer_load_dwordx4 a[8:11], v18, s[64:67], s78 offen offset:2048
    buffer_load_dwordx4 a[12:15], v18, s[64:67], s78 offen offset:3072
    buffer_load_dwordx4 a[16:19], v19, s[64:67], s78 offen offset:0
    buffer_load_dwordx4 a[20:23], v5, s[40:43], s77 offen
    buffer_load_dwordx4 a[24:27], v6, s[40:43], s77 offen
    buffer_load_dwordx4 a[28:31], v7, s[40:43], s77 offen
    buffer_load_dwordx4 a[32:35], v8, s[40:43], s77 offen
    s_add_u32 s77, s77, 1024
    s_add_u32 s78, s78, 5120
    v_lshlrev_b32 v34, 2, v0
    s_lshl_b32 s83, s6, 8
    buffer_load_dword v252, v34, s[56:59], s83 offen sc1
    s_waitcnt vmcnt(28)
    v_mfma_f32_16x16x32_bf16 v[40:43], a[36:39], a[56:59], v[40:43]
    v_mfma_f32_16x16x32_bf16 v[60:63], a[36:39], a[60:63], v[60:63]
    v_mfma_f32_16x16x32_bf16 v[80:83], a[36:39], a[64:67], v[80:83]
    v_mfma_f32_16x16x32_bf16 v[100:103], a[36:39], a[68:71], v[100:103]
    v_mfma_f32_16x16x32_bf16 v[44:47], a[40:43], a[56:59], v[44:47]
    v_mfma_f32_16x16x32_bf16 v[64:67], a[40:43], a[60:63], v[64:67]
    v_mfma_f32_16x16x32_bf16 v[84:87], a[40:43], a[64:67], v[84:87]
    v_mfma_f32_16x16x32_bf16 v[104:107], a[40:43], a[68:71], v[104:107]
    v_mfma_f32_16x16x32_bf16 v[48:51], a[44:47], a[56:59], v[48:51]
    v_mfma_f32_16x16x32_bf16 v[68:71], a[44:47], a[60:63], v[68:71]
    v_mfma_f32_16x16x32_bf16 v[88:91], a[44:47], a[64:67], v[88:91]
    v_mfma_f32_16x16x32_bf16 v[108:111], a[44:47], a[68:71], v[108:111]
    v_mfma_f32_16x16x32_bf16 v[52:55], a[48:51], a[56:59], v[52:55]
    v_mfma_f32_16x16x32_bf16 v[72:75], a[48:51], a[60:63], v[72:75]
    v_mfma_f32_16x16x32_bf16 v[92:95], a[48:51], a[64:67], v[92:95]
    v_mfma_f32_16x16x32_bf16 v[112:115], a[48:51], a[68:71], v[112:115]
    v_mfma_f32_16x16x32_bf16 v[56:59], a[52:55], a[56:59], v[56:59]
    v_mfma_f32_16x16x32_bf16 v[76:79], a[52:55], a[60:63], v[76:79]
    v_mfma_f32_16x16x32_bf16 v[96:99], a[52:55], a[64:67], v[96:99]
    v_mfma_f32_16x16x32_bf16 v[116:119], a[52:55], a[68:71], v[116:119]
    s_cmp_ge_u32 s6, 2
    s_cselect_b32 s77, 0x40000000, s77
    s_cselect_b32 s78, 0x40000000, s78
    buffer_load_dwordx4 a[36:39], v18, s[64:67], s78 offen offset:0
    buffer_load_dwordx4 a[40:43], v18, s[64:67], s78 offen offset:1024
    buffer_load_dwordx4 a[44:47], v18, s[64:67], s78 offen offset:2048
    buffer_load_dwordx4 a[48:51], v18, s[64:67], s78 offen offset:3072
    buffer_load_dwordx4 a[52:55], v19, s[64:67], s78 offen offset:0
    buffer_load_dwordx4 a[56:59], v5, s[40:43], s77 offen
    buffer_load_dwordx4 a[60:63], v6, s[40:43], s77 offen
    buffer_load_dwordx4 a[64:67], v7, s[40:43], s77 offen
    buffer_load_dwordx4 a[68:71], v8, s[40:43], s77 offen
    s_waitcnt vmcnt(28)
    v_mfma_f32_16x16x32_bf16 v[40:43], a[72:75], a[92:95], v[40:43]
    v_mfma_f32_16x16x32_bf16 v[60:63], a[72:75], a[96:99], v[60:63]
    v_mfma_f32_16x16x32_bf16 v[80:83], a[72:75], a[100:103], v[80:83]
    v_mfma_f32_16x16x32_bf16 v[100:103], a[72:75], a[104:107], v[100:103]
    v_mfma_f32_16x16x32_bf16 v[44:47], a[76:79], a[92:95], v[44:47]
    v_mfma_f32_16x16x32_bf16 v[64:67], a[76:79], a[96:99], v[64:67]
    v_mfma_f32_16x16x32_bf16 v[84:87], a[76:79], a[100:103], v[84:87]
    v_mfma_f32_16x16x32_bf16 v[104:107], a[76:79], a[104:107], v[104:107]
    v_mfma_f32_16x16x32_bf16 v[48:51], a[80:83], a[92:95], v[48:51]
    v_mfma_f32_16x16x32_bf16 v[68:71], a[80:83], a[96:99], v[68:71]
    v_mfma_f32_16x16x32_bf16 v[88:91], a[80:83], a[100:103], v[88:91]
    v_mfma_f32_16x16x32_bf16 v[108:111], a[80:83], a[104:107], v[108:111]
    v_mfma_f32_16x16x32_bf16 v[52:55], a[84:87], a[92:95], v[52:55]
    v_mfma_f32_16x16x32_bf16 v[72:75], a[84:87], a[96:99], v[72:75]
    v_mfma_f32_16x16x32_bf16 v[92:95], a[84:87], a[100:103], v[92:95]
    v_mfma_f32_16x16x32_bf16 v[112:115], a[84:87], a[104:107], v[112:115]
    v_mfma_f32_16x16x32_bf16 v[56:59], a[88:91], a[92:95], v[56:59]
    v_mfma_f32_16x16x32_bf16 v[76:79], a[88:91], a[96:99], v[76:79]
    v_mfma_f32_16x16x32_bf16 v[96:99], a[88:91], a[100:103], v[96:99]
    v_mfma_f32_16x16x32_bf16 v[116:119], a[88:91], a[104:107], v[116:119]
    s_add_u32 s81, s87, 0
    buffer_load_dwordx4 a[144:147], v10, s[44:47], s81 offen
    buffer_load_dwordx4 a[148:151], v11, s[44:47], s81 offen
    buffer_load_dwordx4 a[152:155], v12, s[44:47], s81 offen
    buffer_load_dwordx4 a[156:159], v13, s[44:47], s81 offen
    buffer_load_dwordx4 v[184:187], v14, s[44:47], s81 offen
    s_waitcnt vmcnt(14)
    v_cmp_ne_u32 vcc, 0, v252
    s_nop 7
    s_nop 3
    s_cmp_eq_u64 vcc, exec
    s_cbranch_scc1 L_k2_ready
    s_mov_b32 s85, 0
L_k2_poll:
    s_sleep 8
    buffer_load_dword v252, v34, s[56:59], s83 offen sc1
    s_waitcnt vmcnt(0)
    v_cmp_ne_u32 vcc, 0, v252
    s_nop 7
    s_nop 3
    s_cmp_eq_u64 vcc, exec
    s_cbranch_scc1 L_k2_ready
    s_add_u32 s85, s85, 1
    s_cmp_lt_u32 s85, 2000
    s_cbranch_scc1 L_k2_poll
    s_lshl_b32 s85, s6, 6
    s_add_u32 s82, s85, 64
    s_mov_b32 s81, 0
L_k2_self:
    s_mul_i32 s80, s85, 640
    s_add_u32 s80, s80, s81
    buffer_load_dwordx4 v[200:203], v21, s[48:51], s80 offen
    s_add_u32 s80, s80, 163840
    buffer_load_dwordx4 v[204:207], v21, s[48:51], s80 offen
    s_add_u32 s80, s80, 163840
    buffer_load_dwordx4 v[208:211], v21, s[48:51], s80 offen
    s_add_u32 s80, s80, 163840
    buffer_load_dwordx4 v[212:215], v21, s[48:51], s80 offen
    s_add_u32 s80, s80, 163840
    buffer_load_dwordx4 v[216:219], v21, s[48:51], s80 offen
    s_add_u32 s80, s80, 163840
    buffer_load_dwordx4 v[220:223], v21, s[48:51], s80 offen
    s_add_u32 s80, s80, 163840
    buffer_load_dwordx4 v[224:227], v21, s[48:51], s80 offen
    s_add_u32 s80, s80, 163840
    buffer_load_dwordx4 v[228:231], v21, s[48:51], s80 offen
    s_waitcnt vmcnt(0)
    v_add_f32 v200, v200, v216
    v_add_f32 v201, v201, v217
    v_add_f32 v202, v202, v218
    v_add_f32 v203, v203, v219
    v_add_f32 v204, v204, v220
    v_add_f32 v205, v205, v221
    v_add_f32 v206, v206, v222
    v_add_f32 v207, v207, v223
    v_add_f32 v208, v208, v224
    v_add_f32 v209, v209, v225
    v_add_f32 v210, v210, v226
    v_add_f32 v211, v211, v227
    v_add_f32 v212, v212, v228
    v_add_f32 v213, v213, v229
    v_add_f32 v214, v214, v230
    v_add_f32 v215, v215, v231
    v_add_f32 v200, v200, v208
    v_add_f32 v201, v201, v209
    v_add_f32 v202, v202, v210
    v_add_f32 v203, v203, v211
    v_add_f32 v204, v204, v212
    v_add_f32 v205, v205, v213
    v_add_f32 v206, v206, v214
    v_add_f32 v207, v207, v215
    v_add_f32 v200, v200, v204
    v_add_f32 v201, v201, v205
    v_add_f32 v202, v202, v206
    v_add_f32 v203, v203, v207
    v_cvt_pk_bf16_f32 v200, v200, v201
    v_cvt_pk_bf16_f32 v201, v202, v203
    s_mul_i32 s80, s85, 320
    s_add_u32 s80, s80, s81
    buffer_store_dwordx2 v[200:201], v22, s[52:55], s80 offen sc1
    s_waitcnt vmcnt(0)
    s_nop 7
    s_nop 3
    s_add_u32 s85, s85, 1
    s_cmp_lt_u32 s85, s82
    s_cbranch_scc1 L_k2_self
L_k2_ready:
    s_add_u32 s80, s86, 0
    buffer_load_dwordx4 a[160:163], v18, s[52:55], s80 offen offset:0 sc1
    buffer_load_dwordx4 a[164:167], v18, s[52:55], s80 offen offset:1024 sc1
    buffer_load_dwordx4 a[168:171], v20, s[52:55], s80 offen offset:2048 sc1
    buffer_load_dwordx4 a[172:175], v20, s[52:55], s80 offen offset:2304 sc1
    v_mfma_f32_16x16x32_bf16 v[40:43], a[108:111], a[128:131], v[40:43]
    v_mfma_f32_16x16x32_bf16 v[60:63], a[108:111], a[132:135], v[60:63]
    v_mfma_f32_16x16x32_bf16 v[80:83], a[108:111], a[136:139], v[80:83]
    v_mfma_f32_16x16x32_bf16 v[100:103], a[108:111], a[140:143], v[100:103]
    v_mfma_f32_16x16x32_bf16 v[44:47], a[112:115], a[128:131], v[44:47]
    v_mfma_f32_16x16x32_bf16 v[64:67], a[112:115], a[132:135], v[64:67]
    v_mfma_f32_16x16x32_bf16 v[84:87], a[112:115], a[136:139], v[84:87]
    v_mfma_f32_16x16x32_bf16 v[104:107], a[112:115], a[140:143], v[104:107]
    v_mfma_f32_16x16x32_bf16 v[48:51], a[116:119], a[128:131], v[48:51]
    v_mfma_f32_16x16x32_bf16 v[68:71], a[116:119], a[132:135], v[68:71]
    v_mfma_f32_16x16x32_bf16 v[88:91], a[116:119], a[136:139], v[88:91]
    v_mfma_f32_16x16x32_bf16 v[108:111], a[116:119], a[140:143], v[108:111]
    v_mfma_f32_16x16x32_bf16 v[52:55], a[120:123], a[128:131], v[52:55]
    v_mfma_f32_16x16x32_bf16 v[72:75], a[120:123], a[132:135], v[72:75]
    v_mfma_f32_16x16x32_bf16 v[92:95], a[120:123], a[136:139], v[92:95]
    v_mfma_f32_16x16x32_bf16 v[112:115], a[120:123], a[140:143], v[112:115]
    v_mfma_f32_16x16x32_bf16 v[56:59], a[124:127], a[128:131], v[56:59]
    v_mfma_f32_16x16x32_bf16 v[76:79], a[124:127], a[132:135], v[76:79]
    v_mfma_f32_16x16x32_bf16 v[96:99], a[124:127], a[136:139], v[96:99]
    v_mfma_f32_16x16x32_bf16 v[116:119], a[124:127], a[140:143], v[116:119]
    s_add_u32 s81, s87, 1280
    buffer_load_dwordx4 a[176:179], v10, s[44:47], s81 offen
    buffer_load_dwordx4 a[180:183], v11, s[44:47], s81 offen
    buffer_load_dwordx4 a[184:187], v12, s[44:47], s81 offen
    buffer_load_dwordx4 a[188:191], v13, s[44:47], s81 offen
    buffer_load_dwordx4 v[188:191], v14, s[44:47], s81 offen
    s_add_u32 s80, s86, 2560
    buffer_load_dwordx4 a[192:195], v18, s[52:55], s80 offen offset:0 sc1
    buffer_load_dwordx4 a[196:199], v18, s[52:55], s80 offen offset:1024 sc1
    buffer_load_dwordx4 a[200:203], v20, s[52:55], s80 offen offset:2048 sc1
    buffer_load_dwordx4 a[204:207], v20, s[52:55], s80 offen offset:2304 sc1
    v_mfma_f32_16x16x32_bf16 v[40:43], a[0:3], a[20:23], v[40:43]
    v_mfma_f32_16x16x32_bf16 v[60:63], a[0:3], a[24:27], v[60:63]
    v_mfma_f32_16x16x32_bf16 v[80:83], a[0:3], a[28:31], v[80:83]
    v_mfma_f32_16x16x32_bf16 v[100:103], a[0:3], a[32:35], v[100:103]
    v_mfma_f32_16x16x32_bf16 v[44:47], a[4:7], a[20:23], v[44:47]
    v_mfma_f32_16x16x32_bf16 v[64:67], a[4:7], a[24:27], v[64:67]
    v_mfma_f32_16x16x32_bf16 v[84:87], a[4:7], a[28:31], v[84:87]
    v_mfma_f32_16x16x32_bf16 v[104:107], a[4:7], a[32:35], v[104:107]
    v_mfma_f32_16x16x32_bf16 v[48:51], a[8:11], a[20:23], v[48:51]
    v_mfma_f32_16x16x32_bf16 v[68:71], a[8:11], a[24:27], v[68:71]
    v_mfma_f32_16x16x32_bf16 v[88:91], a[8:11], a[28:31], v[88:91]
    v_mfma_f32_16x16x32_bf16 v[108:111], a[8:11], a[32:35], v[108:111]
    v_mfma_f32_16x16x32_bf16 v[52:55], a[12:15], a[20:23], v[52:55]
    v_mfma_f32_16x16x32_bf16 v[72:75], a[12:15], a[24:27], v[72:75]
    v_mfma_f32_16x16x32_bf16 v[92:95], a[12:15], a[28:31], v[92:95]
    v_mfma_f32_16x16x32_bf16 v[112:115], a[12:15], a[32:35], v[112:115]
    v_mfma_f32_16x16x32_bf16 v[56:59], a[16:19], a[20:23], v[56:59]
    v_mfma_f32_16x16x32_bf16 v[76:79], a[16:19], a[24:27], v[76:79]
    v_mfma_f32_16x16x32_bf16 v[96:99], a[16:19], a[28:31], v[96:99]
    v_mfma_f32_16x16x32_bf16 v[116:119], a[16:19], a[32:35], v[116:119]
    s_add_u32 s81, s87, 2560
    buffer_load_dwordx4 a[208:211], v10, s[44:47], s81 offen
    buffer_load_dwordx4 a[212:215], v11, s[44:47], s81 offen
    buffer_load_dwordx4 a[216:219], v12, s[44:47], s81 offen
    buffer_load_dwordx4 a[220:223], v13, s[44:47], s81 offen
    buffer_load_dwordx4 v[192:195], v14, s[44:47], s81 offen
    s_add_u32 s80, s86, 5120
    buffer_load_dwordx4 a[224:227], v18, s[52:55], s80 offen offset:0 sc1
    buffer_load_dwordx4 a[228:231], v18, s[52:55], s80 offen offset:1024 sc1
    buffer_load_dwordx4 a[232:235], v20, s[52:55], s80 offen offset:2048 sc1
    buffer_load_dwordx4 a[236:239], v20, s[52:55], s80 offen offset:2304 sc1
    s_waitcnt vmcnt(27)
    v_mfma_f32_16x16x32_bf16 v[40:43], a[36:39], a[56:59], v[40:43]
    v_mfma_f32_16x16x32_bf16 v[60:63], a[36:39], a[60:63], v[60:63]
    v_mfma_f32_16x16x32_bf16 v[80:83], a[36:39], a[64:67], v[80:83]
    v_mfma_f32_16x16x32_bf16 v[100:103], a[36:39], a[68:71], v[100:103]
    v_mfma_f32_16x16x32_bf16 v[44:47], a[40:43], a[56:59], v[44:47]
    v_mfma_f32_16x16x32_bf16 v[64:67], a[40:43], a[60:63], v[64:67]
    v_mfma_f32_16x16x32_bf16 v[84:87], a[40:43], a[64:67], v[84:87]
    v_mfma_f32_16x16x32_bf16 v[104:107], a[40:43], a[68:71], v[104:107]
    v_mfma_f32_16x16x32_bf16 v[48:51], a[44:47], a[56:59], v[48:51]
    v_mfma_f32_16x16x32_bf16 v[68:71], a[44:47], a[60:63], v[68:71]
    v_mfma_f32_16x16x32_bf16 v[88:91], a[44:47], a[64:67], v[88:91]
    v_mfma_f32_16x16x32_bf16 v[108:111], a[44:47], a[68:71], v[108:111]
    v_mfma_f32_16x16x32_bf16 v[52:55], a[48:51], a[56:59], v[52:55]
    v_mfma_f32_16x16x32_bf16 v[72:75], a[48:51], a[60:63], v[72:75]
    v_mfma_f32_16x16x32_bf16 v[92:95], a[48:51], a[64:67], v[92:95]
    v_mfma_f32_16x16x32_bf16 v[112:115], a[48:51], a[68:71], v[112:115]
    v_mfma_f32_16x16x32_bf16 v[56:59], a[52:55], a[56:59], v[56:59]
    v_mfma_f32_16x16x32_bf16 v[76:79], a[52:55], a[60:63], v[76:79]
    v_mfma_f32_16x16x32_bf16 v[96:99], a[52:55], a[64:67], v[96:99]
    v_mfma_f32_16x16x32_bf16 v[116:119], a[52:55], a[68:71], v[116:119]
    s_add_u32 s81, s87, 3840
    buffer_load_dwordx4 a[0:3], v10, s[44:47], s81 offen
    buffer_load_dwordx4 a[4:7], v11, s[44:47], s81 offen
    buffer_load_dwordx4 a[8:11], v12, s[44:47], s81 offen
    buffer_load_dwordx4 a[12:15], v13, s[44:47], s81 offen
    buffer_load_dwordx4 v[196:199], v14, s[44:47], s81 offen
    s_add_u32 s80, s86, 7680
    buffer_load_dwordx4 a[16:19], v18, s[52:55], s80 offen offset:0 sc1
    buffer_load_dwordx4 a[20:23], v18, s[52:55], s80 offen offset:1024 sc1
    buffer_load_dwordx4 a[24:27], v20, s[52:55], s80 offen offset:2048 sc1
    buffer_load_dwordx4 a[28:31], v20, s[52:55], s80 offen offset:2304 sc1
    s_mul_i32 s80, s6, 5
    s_add_u32 s80, s80, s89
    s_add_u32 s80, s80, 54
    s_mul_i32 s80, s80, 5120
    buffer_load_dwordx4 a[32:35], v18, s[64:67], s80 offen offset:0
    buffer_load_dwordx4 a[36:39], v18, s[64:67], s80 offen offset:1024
    buffer_load_dwordx4 a[40:43], v18, s[64:67], s80 offen offset:2048
    buffer_load_dwordx4 a[44:47], v18, s[64:67], s80 offen offset:3072
    buffer_load_dwordx4 a[48:51], v19, s[64:67], s80 offen offset:0
    s_waitcnt vmcnt(32)
    v_mfma_f32_16x16x32_bf16 v[200:203], a[160:163], a[144:147], 0
    v_mfma_f32_16x16x32_bf16 v[204:207], a[164:167], a[144:147], 0
    v_cndmask_b32 v168, 0, v184, s[8:9]
    v_cndmask_b32 v169, 0, v185, s[8:9]
    v_cndmask_b32 v170, 0, v186, s[8:9]
    v_cndmask_b32 v171, 0, v187, s[8:9]
    v_mfma_f32_16x16x32_bf16 v[208:211], a[160:163], a[148:151], 0
    v_mfma_f32_16x16x32_bf16 v[212:215], a[164:167], a[148:151], 0
    v_cndmask_b32 v172, 0, v184, s[10:11]
    v_cndmask_b32 v173, 0, v185, s[10:11]
    v_cndmask_b32 v174, 0, v186, s[10:11]
    v_cndmask_b32 v175, 0, v187, s[10:11]
    v_mfma_f32_16x16x32_bf16 v[216:219], a[160:163], a[152:155], 0
    v_mfma_f32_16x16x32_bf16 v[220:223], a[164:167], a[152:155], 0
    v_cndmask_b32 v176, 0, v184, s[12:13]
    v_cndmask_b32 v177, 0, v185, s[12:13]
    v_cndmask_b32 v178, 0, v186, s[12:13]
    v_cndmask_b32 v179, 0, v187, s[12:13]
    v_mfma_f32_16x16x32_bf16 v[224:227], a[160:163], a[156:159], 0
    v_mfma_f32_16x16x32_bf16 v[228:231], a[164:167], a[156:159], 0
    v_cndmask_b32 v180, 0, v184, s[14:15]
    v_cndmask_b32 v181, 0, v185, s[14:15]
    v_cndmask_b32 v182, 0, v186, s[14:15]
    v_cndmask_b32 v183, 0, v187, s[14:15]
    v_mfma_f32_16x16x32_bf16 v[200:203], a[168:171], v[168:171], v[200:203]
    v_mfma_f32_16x16x32_bf16 v[204:207], a[172:175], v[168:171], v[204:207]
    v_mfma_f32_16x16x32_bf16 v[208:211], a[168:171], v[172:175], v[208:211]
    v_mfma_f32_16x16x32_bf16 v[212:215], a[172:175], v[172:175], v[212:215]
    v_mfma_f32_16x16x32_bf16 v[216:219], a[168:171], v[176:179], v[216:219]
    v_mfma_f32_16x16x32_bf16 v[220:223], a[172:175], v[176:179], v[220:223]
    v_mfma_f32_16x16x32_bf16 v[224:227], a[168:171], v[180:183], v[224:227]
    v_mfma_f32_16x16x32_bf16 v[228:231], a[172:175], v[180:183], v[228:231]
    s_add_u32 s81, s87, 5120
    buffer_load_dwordx4 a[144:147], v10, s[44:47], s81 offen
    buffer_load_dwordx4 a[148:151], v11, s[44:47], s81 offen
    buffer_load_dwordx4 a[152:155], v12, s[44:47], s81 offen
    buffer_load_dwordx4 a[156:159], v13, s[44:47], s81 offen
    buffer_load_dwordx4 v[184:187], v14, s[44:47], s81 offen
    s_add_u32 s80, s86, 10240
    buffer_load_dwordx4 a[160:163], v18, s[52:55], s80 offen offset:0 sc1
    buffer_load_dwordx4 a[164:167], v18, s[52:55], s80 offen offset:1024 sc1
    buffer_load_dwordx4 a[168:171], v20, s[52:55], s80 offen offset:2048 sc1
    buffer_load_dwordx4 a[172:175], v20, s[52:55], s80 offen offset:2304 sc1
    s_mul_i32 s80, s6, 5
    s_add_u32 s80, s80, s89
    s_add_u32 s80, s80, 55
    s_mul_i32 s80, s80, 5120
    buffer_load_dwordx4 a[52:55], v18, s[64:67], s80 offen offset:0
    buffer_load_dwordx4 a[56:59], v18, s[64:67], s80 offen offset:1024
    buffer_load_dwordx4 a[60:63], v18, s[64:67], s80 offen offset:2048
    buffer_load_dwordx4 a[64:67], v18, s[64:67], s80 offen offset:3072
    buffer_load_dwordx4 a[68:71], v19, s[64:67], s80 offen offset:0
    v_sub_f32 v32, 1.0, v28
    v_sub_f32 v34, 1.0, v29
    v_sub_f32 v36, 1.0, v30
    v_sub_f32 v38, 1.0, v31
    v_pk_mul_f32 v[40:41], v[40:41], v[32:33] op_sel_hi:[1,0]
    v_pk_mul_f32 v[42:43], v[42:43], v[32:33] op_sel_hi:[1,0]
    v_pk_mul_f32 v[44:45], v[44:45], v[32:33] op_sel_hi:[1,0]
    v_pk_mul_f32 v[46:47], v[46:47], v[32:33] op_sel_hi:[1,0]
    v_pk_mul_f32 v[48:49], v[48:49], v[32:33] op_sel_hi:[1,0]
    v_pk_mul_f32 v[50:51], v[50:51], v[32:33] op_sel_hi:[1,0]
    v_pk_mul_f32 v[52:53], v[52:53], v[32:33] op_sel_hi:[1,0]
    v_pk_mul_f32 v[54:55], v[54:55], v[32:33] op_sel_hi:[1,0]
    v_pk_mul_f32 v[56:57], v[56:57], v[32:33] op_sel_hi:[1,0]
    v_pk_mul_f32 v[58:59], v[58:59], v[32:33] op_sel_hi:[1,0]
    v_pk_mul_f32 v[60:61], v[60:61], v[34:35] op_sel_hi:[1,0]
    v_pk_mul_f32 v[62:63], v[62:63], v[34:35] op_sel_hi:[1,0]
    v_pk_mul_f32 v[64:65], v[64:65], v[34:35] op_sel_hi:[1,0]
    v_pk_mul_f32 v[66:67], v[66:67], v[34:35] op_sel_hi:[1,0]
    v_pk_mul_f32 v[68:69], v[68:69], v[34:35] op_sel_hi:[1,0]
    v_pk_mul_f32 v[70:71], v[70:71], v[34:35] op_sel_hi:[1,0]
    v_pk_mul_f32 v[72:73], v[72:73], v[34:35] op_sel_hi:[1,0]
    v_pk_mul_f32 v[74:75], v[74:75], v[34:35] op_sel_hi:[1,0]
    v_pk_mul_f32 v[76:77], v[76:77], v[34:35] op_sel_hi:[1,0]
    v_pk_mul_f32 v[78:79], v[78:79], v[34:35] op_sel_hi:[1,0]
    v_pk_mul_f32 v[80:81], v[80:81], v[36:37] op_sel_hi:[1,0]
    v_pk_mul_f32 v[82:83], v[82:83], v[36:37] op_sel_hi:[1,0]
    v_pk_mul_f32 v[84:85], v[84:85], v[36:37] op_sel_hi:[1,0]
    v_pk_mul_f32 v[86:87], v[86:87], v[36:37] op_sel_hi:[1,0]
    v_pk_mul_f32 v[88:89], v[88:89], v[36:37] op_sel_hi:[1,0]
    v_pk_mul_f32 v[90:91], v[90:91], v[36:37] op_sel_hi:[1,0]
    v_pk_mul_f32 v[92:93], v[92:93], v[36:37] op_sel_hi:[1,0]
    v_pk_mul_f32 v[94:95], v[94:95], v[36:37] op_sel_hi:[1,0]
    v_pk_mul_f32 v[96:97], v[96:97], v[36:37] op_sel_hi:[1,0]
    v_pk_mul_f32 v[98:99], v[98:99], v[36:37] op_sel_hi:[1,0]
    v_pk_mul_f32 v[100:101], v[100:101], v[38:39] op_sel_hi:[1,0]
    v_pk_mul_f32 v[102:103], v[102:103], v[38:39] op_sel_hi:[1,0]
    v_pk_mul_f32 v[104:105], v[104:105], v[38:39] op_sel_hi:[1,0]
    v_pk_mul_f32 v[106:107], v[106:107], v[38:39] op_sel_hi:[1,0]
    v_pk_mul_f32 v[108:109], v[108:109], v[38:39] op_sel_hi:[1,0]
    v_pk_mul_f32 v[110:111], v[110:111], v[38:39] op_sel_hi:[1,0]
    v_pk_mul_f32 v[112:113], v[112:113], v[38:39] op_sel_hi:[1,0]
    v_pk_mul_f32 v[114:115], v[114:115], v[38:39] op_sel_hi:[1,0]
    v_pk_mul_f32 v[116:117], v[116:117], v[38:39] op_sel_hi:[1,0]
    v_pk_mul_f32 v[118:119], v[118:119], v[38:39] op_sel_hi:[1,0]
    v_add_f32 v206, 0x358637bd, v205
    v_add_f32 v214, 0x358637bd, v213
    v_add_f32 v222, 0x358637bd, v221
    v_add_f32 v230, 0x358637bd, v229
    v_rcp_f32 v206, v206
    v_rcp_f32 v214, v214
    v_rcp_f32 v222, v222
    v_rcp_f32 v230, v230
    v_mul_f32 v206, v206, v28
    v_mul_f32 v214, v214, v29
    v_mul_f32 v222, v222, v30
    v_mul_f32 v230, v230, v31
    v_pk_mul_f32 v[200:201], v[200:201], v[206:207] op_sel_hi:[1,0]
    v_pk_mul_f32 v[202:203], v[202:203], v[206:207] op_sel_hi:[1,0]
    v_mul_f32 v232, v204, v206
    v_pk_mul_f32 v[208:209], v[208:209], v[214:215] op_sel_hi:[1,0]
    v_pk_mul_f32 v[210:211], v[210:211], v[214:215] op_sel_hi:[1,0]
    v_mul_f32 v233, v212, v214
    v_pk_mul_f32 v[216:217], v[216:217], v[222:223] op_sel_hi:[1,0]
    v_pk_mul_f32 v[218:219], v[218:219], v[222:223] op_sel_hi:[1,0]
    v_mul_f32 v234, v220, v222
    v_pk_mul_f32 v[224:225], v[224:225], v[230:231] op_sel_hi:[1,0]
    v_pk_mul_f32 v[226:227], v[226:227], v[230:231] op_sel_hi:[1,0]
    v_mul_f32 v235, v228, v230
    v_cvt_pk_bf16_f32 v120, v200, v201
    v_cvt_pk_bf16_f32 v121, v202, v203
    v_cvt_pk_bf16_f32 v124, v208, v209
    v_cvt_pk_bf16_f32 v125, v210, v211
    v_cvt_pk_bf16_f32 v128, v216, v217
    v_cvt_pk_bf16_f32 v129, v218, v219
    v_cvt_pk_bf16_f32 v132, v224, v225
    v_cvt_pk_bf16_f32 v133, v226, v227
    s_waitcnt vmcnt(37)
    v_mfma_f32_16x16x32_bf16 v[200:203], a[192:195], a[176:179], 0
    v_mfma_f32_16x16x32_bf16 v[204:207], a[196:199], a[176:179], 0
    v_cndmask_b32 v168, 0, v188, s[8:9]
    v_cndmask_b32 v169, 0, v189, s[8:9]
    v_cndmask_b32 v170, 0, v190, s[8:9]
    v_cndmask_b32 v171, 0, v191, s[8:9]
    v_mfma_f32_16x16x32_bf16 v[208:211], a[192:195], a[180:183], 0
    v_mfma_f32_16x16x32_bf16 v[212:215], a[196:199], a[180:183], 0
    v_cndmask_b32 v172, 0, v188, s[10:11]
    v_cndmask_b32 v173, 0, v189, s[10:11]
    v_cndmask_b32 v174, 0, v190, s[10:11]
    v_cndmask_b32 v175, 0, v191, s[10:11]
    v_mfma_f32_16x16x32_bf16 v[216:219], a[192:195], a[184:187], 0
    v_mfma_f32_16x16x32_bf16 v[220:223], a[196:199], a[184:187], 0
    v_cndmask_b32 v176, 0, v188, s[12:13]
    v_cndmask_b32 v177, 0, v189, s[12:13]
    v_cndmask_b32 v178, 0, v190, s[12:13]
    v_cndmask_b32 v179, 0, v191, s[12:13]
    v_mfma_f32_16x16x32_bf16 v[224:227], a[192:195], a[188:191], 0
    v_mfma_f32_16x16x32_bf16 v[228:231], a[196:199], a[188:191], 0
    v_cndmask_b32 v180, 0, v188, s[14:15]
    v_cndmask_b32 v181, 0, v189, s[14:15]
    v_cndmask_b32 v182, 0, v190, s[14:15]
    v_cndmask_b32 v183, 0, v191, s[14:15]
    v_mfma_f32_16x16x32_bf16 v[200:203], a[200:203], v[168:171], v[200:203]
    v_mfma_f32_16x16x32_bf16 v[204:207], a[204:207], v[168:171], v[204:207]
    v_mfma_f32_16x16x32_bf16 v[208:211], a[200:203], v[172:175], v[208:211]
    v_mfma_f32_16x16x32_bf16 v[212:215], a[204:207], v[172:175], v[212:215]
    v_mfma_f32_16x16x32_bf16 v[216:219], a[200:203], v[176:179], v[216:219]
    v_mfma_f32_16x16x32_bf16 v[220:223], a[204:207], v[176:179], v[220:223]
    v_mfma_f32_16x16x32_bf16 v[224:227], a[200:203], v[180:183], v[224:227]
    v_mfma_f32_16x16x32_bf16 v[228:231], a[204:207], v[180:183], v[228:231]
    s_add_u32 s81, s87, 6400
    buffer_load_dwordx4 a[176:179], v10, s[44:47], s81 offen
    buffer_load_dwordx4 a[180:183], v11, s[44:47], s81 offen
    buffer_load_dwordx4 a[184:187], v12, s[44:47], s81 offen
    buffer_load_dwordx4 a[188:191], v13, s[44:47], s81 offen
    buffer_load_dwordx4 v[188:191], v14, s[44:47], s81 offen
    s_add_u32 s80, s86, 12800
    buffer_load_dwordx4 a[192:195], v18, s[52:55], s80 offen offset:0 sc1
    buffer_load_dwordx4 a[196:199], v18, s[52:55], s80 offen offset:1024 sc1
    buffer_load_dwordx4 a[200:203], v20, s[52:55], s80 offen offset:2048 sc1
    buffer_load_dwordx4 a[204:207], v20, s[52:55], s80 offen offset:2304 sc1
    s_mul_i32 s80, s6, 5
    s_add_u32 s80, s80, s89
    s_add_u32 s80, s80, 56
    s_mul_i32 s80, s80, 5120
    buffer_load_dwordx4 a[72:75], v18, s[64:67], s80 offen offset:0
    buffer_load_dwordx4 a[76:79], v18, s[64:67], s80 offen offset:1024
    buffer_load_dwordx4 a[80:83], v18, s[64:67], s80 offen offset:2048
    buffer_load_dwordx4 a[84:87], v18, s[64:67], s80 offen offset:3072
    buffer_load_dwordx4 a[88:91], v19, s[64:67], s80 offen offset:0
    v_add_f32 v206, 0x358637bd, v205
    v_add_f32 v214, 0x358637bd, v213
    v_add_f32 v222, 0x358637bd, v221
    v_add_f32 v230, 0x358637bd, v229
    v_rcp_f32 v206, v206
    v_rcp_f32 v214, v214
    v_rcp_f32 v222, v222
    v_rcp_f32 v230, v230
    v_mul_f32 v206, v206, v28
    v_mul_f32 v214, v214, v29
    v_mul_f32 v222, v222, v30
    v_mul_f32 v230, v230, v31
    v_pk_mul_f32 v[200:201], v[200:201], v[206:207] op_sel_hi:[1,0]
    v_pk_mul_f32 v[202:203], v[202:203], v[206:207] op_sel_hi:[1,0]
    v_mul_f32 v204, v204, v206
    v_pk_mul_f32 v[208:209], v[208:209], v[214:215] op_sel_hi:[1,0]
    v_pk_mul_f32 v[210:211], v[210:211], v[214:215] op_sel_hi:[1,0]
    v_mul_f32 v212, v212, v214
    v_pk_mul_f32 v[216:217], v[216:217], v[222:223] op_sel_hi:[1,0]
    v_pk_mul_f32 v[218:219], v[218:219], v[222:223] op_sel_hi:[1,0]
    v_mul_f32 v220, v220, v222
    v_pk_mul_f32 v[224:225], v[224:225], v[230:231] op_sel_hi:[1,0]
    v_pk_mul_f32 v[226:227], v[226:227], v[230:231] op_sel_hi:[1,0]
    v_mul_f32 v228, v228, v230
    v_cvt_pk_bf16_f32 v122, v200, v201
    v_cvt_pk_bf16_f32 v123, v202, v203
    v_cvt_pk_bf16_f32 v152, v232, v204
    v_cvt_pk_bf16_f32 v126, v208, v209
    v_cvt_pk_bf16_f32 v127, v210, v211
    v_cvt_pk_bf16_f32 v156, v233, v212
    v_cvt_pk_bf16_f32 v130, v216, v217
    v_cvt_pk_bf16_f32 v131, v218, v219
    v_cvt_pk_bf16_f32 v160, v234, v220
    v_cvt_pk_bf16_f32 v134, v224, v225
    v_cvt_pk_bf16_f32 v135, v226, v227
    v_cvt_pk_bf16_f32 v164, v235, v228
    s_waitcnt vmcnt(42)
    v_mfma_f32_16x16x32_bf16 v[200:203], a[224:227], a[208:211], 0
    v_mfma_f32_16x16x32_bf16 v[204:207], a[228:231], a[208:211], 0
    v_cndmask_b32 v168, 0, v192, s[8:9]
    v_cndmask_b32 v169, 0, v193, s[8:9]
    v_cndmask_b32 v170, 0, v194, s[8:9]
    v_cndmask_b32 v171, 0, v195, s[8:9]
    v_mfma_f32_16x16x32_bf16 v[208:211], a[224:227], a[212:215], 0
    v_mfma_f32_16x16x32_bf16 v[212:215], a[228:231], a[212:215], 0
    v_cndmask_b32 v172, 0, v192, s[10:11]
    v_cndmask_b32 v173, 0, v193, s[10:11]
    v_cndmask_b32 v174, 0, v194, s[10:11]
    v_cndmask_b32 v175, 0, v195, s[10:11]
    v_mfma_f32_16x16x32_bf16 v[216:219], a[224:227], a[216:219], 0
    v_mfma_f32_16x16x32_bf16 v[220:223], a[228:231], a[216:219], 0
    v_cndmask_b32 v176, 0, v192, s[12:13]
    v_cndmask_b32 v177, 0, v193, s[12:13]
    v_cndmask_b32 v178, 0, v194, s[12:13]
    v_cndmask_b32 v179, 0, v195, s[12:13]
    v_mfma_f32_16x16x32_bf16 v[224:227], a[224:227], a[220:223], 0
    v_mfma_f32_16x16x32_bf16 v[228:231], a[228:231], a[220:223], 0
    v_cndmask_b32 v180, 0, v192, s[14:15]
    v_cndmask_b32 v181, 0, v193, s[14:15]
    v_cndmask_b32 v182, 0, v194, s[14:15]
    v_cndmask_b32 v183, 0, v195, s[14:15]
    v_mfma_f32_16x16x32_bf16 v[200:203], a[232:235], v[168:171], v[200:203]
    v_mfma_f32_16x16x32_bf16 v[204:207], a[236:239], v[168:171], v[204:207]
    v_mfma_f32_16x16x32_bf16 v[208:211], a[232:235], v[172:175], v[208:211]
    v_mfma_f32_16x16x32_bf16 v[212:215], a[236:239], v[172:175], v[212:215]
    v_mfma_f32_16x16x32_bf16 v[216:219], a[232:235], v[176:179], v[216:219]
    v_mfma_f32_16x16x32_bf16 v[220:223], a[236:239], v[176:179], v[220:223]
    v_mfma_f32_16x16x32_bf16 v[224:227], a[232:235], v[180:183], v[224:227]
    v_mfma_f32_16x16x32_bf16 v[228:231], a[236:239], v[180:183], v[228:231]
    s_add_u32 s81, s87, 7680
    buffer_load_dwordx4 a[208:211], v10, s[44:47], s81 offen
    buffer_load_dwordx4 a[212:215], v11, s[44:47], s81 offen
    buffer_load_dwordx4 a[216:219], v12, s[44:47], s81 offen
    buffer_load_dwordx4 a[220:223], v13, s[44:47], s81 offen
    buffer_load_dwordx4 v[192:195], v14, s[44:47], s81 offen
    s_add_u32 s80, s86, 15360
    buffer_load_dwordx4 a[224:227], v18, s[52:55], s80 offen offset:0 sc1
    buffer_load_dwordx4 a[228:231], v18, s[52:55], s80 offen offset:1024 sc1
    buffer_load_dwordx4 a[232:235], v20, s[52:55], s80 offen offset:2048 sc1
    buffer_load_dwordx4 a[236:239], v20, s[52:55], s80 offen offset:2304 sc1
    s_mul_i32 s80, s6, 5
    s_add_u32 s80, s80, s89
    s_add_u32 s80, s80, 57
    s_mul_i32 s80, s80, 5120
    buffer_load_dwordx4 a[92:95], v18, s[64:67], s80 offen offset:0
    buffer_load_dwordx4 a[96:99], v18, s[64:67], s80 offen offset:1024
    buffer_load_dwordx4 a[100:103], v18, s[64:67], s80 offen offset:2048
    buffer_load_dwordx4 a[104:107], v18, s[64:67], s80 offen offset:3072
    buffer_load_dwordx4 a[108:111], v19, s[64:67], s80 offen offset:0
    s_waitcnt vmcnt(42)
    v_mfma_f32_16x16x32_bf16 v[40:43], a[32:35], v[120:123], v[40:43]
    v_mfma_f32_16x16x32_bf16 v[60:63], a[32:35], v[124:127], v[60:63]
    v_mfma_f32_16x16x32_bf16 v[80:83], a[32:35], v[128:131], v[80:83]
    v_add_f32 v206, 0x358637bd, v205
    v_add_f32 v214, 0x358637bd, v213
    v_add_f32 v222, 0x358637bd, v221
    v_add_f32 v230, 0x358637bd, v229
    v_mfma_f32_16x16x32_bf16 v[100:103], a[32:35], v[132:135], v[100:103]
    v_rcp_f32 v206, v206
    v_rcp_f32 v214, v214
    v_rcp_f32 v222, v222
    v_rcp_f32 v230, v230
    v_mfma_f32_16x16x32_bf16 v[44:47], a[36:39], v[120:123], v[44:47]
    v_mul_f32 v206, v206, v28
    v_mul_f32 v214, v214, v29
    v_mul_f32 v222, v222, v30
    v_mul_f32 v230, v230, v31
    v_mfma_f32_16x16x32_bf16 v[64:67], a[36:39], v[124:127], v[64:67]
    v_pk_mul_f32 v[200:201], v[200:201], v[206:207] op_sel_hi:[1,0]
    v_pk_mul_f32 v[202:203], v[202:203], v[206:207] op_sel_hi:[1,0]
    v_mul_f32 v232, v204, v206
    v_pk_mul_f32 v[208:209], v[208:209], v[214:215] op_sel_hi:[1,0]
    v_mfma_f32_16x16x32_bf16 v[84:87], a[36:39], v[128:131], v[84:87]
    v_pk_mul_f32 v[210:211], v[210:211], v[214:215] op_sel_hi:[1,0]
    v_mul_f32 v233, v212, v214
    v_pk_mul_f32 v[216:217], v[216:217], v[222:223] op_sel_hi:[1,0]
    v_pk_mul_f32 v[218:219], v[218:219], v[222:223] op_sel_hi:[1,0]
    v_mfma_f32_16x16x32_bf16 v[104:107], a[36:39], v[132:135], v[104:107]
    v_mul_f32 v234, v220, v222
    v_pk_mul_f32 v[224:225], v[224:225], v[230:231] op_sel_hi:[1,0]
    v_pk_mul_f32 v[226:227], v[226:227], v[230:231] op_sel_hi:[1,0]
    v_mul_f32 v235, v228, v230
    v_mfma_f32_16x16x32_bf16 v[48:51], a[40:43], v[120:123], v[48:51]
    v_cvt_pk_bf16_f32 v136, v200, v201
    v_cvt_pk_bf16_f32 v137, v202, v203
    v_cvt_pk_bf16_f32 v140, v208, v209
    v_cvt_pk_bf16_f32 v141, v210, v211
    v_mfma_f32_16x16x32_bf16 v[68:71], a[40:43], v[124:127], v[68:71]
    v_cvt_pk_bf16_f32 v144, v216, v217
    v_cvt_pk_bf16_f32 v145, v218, v219
    v_cvt_pk_bf16_f32 v148, v224, v225
    v_cvt_pk_bf16_f32 v149, v226, v227
    v_mfma_f32_16x16x32_bf16 v[200:203], a[16:19], a[0:3], 0
    v_mfma_f32_16x16x32_bf16 v[204:207], a[20:23], a[0:3], 0
    v_cndmask_b32 v168, 0, v196, s[8:9]
    v_cndmask_b32 v169, 0, v197, s[8:9]
    v_cndmask_b32 v170, 0, v198, s[8:9]
    v_cndmask_b32 v171, 0, v199, s[8:9]
    v_mfma_f32_16x16x32_bf16 v[208:211], a[16:19], a[4:7], 0
    v_mfma_f32_16x16x32_bf16 v[212:215], a[20:23], a[4:7], 0
    v_cndmask_b32 v172, 0, v196, s[10:11]
    v_cndmask_b32 v173, 0, v197, s[10:11]
    v_cndmask_b32 v174, 0, v198, s[10:11]
    v_cndmask_b32 v175, 0, v199, s[10:11]
    v_mfma_f32_16x16x32_bf16 v[216:219], a[16:19], a[8:11], 0
    v_mfma_f32_16x16x32_bf16 v[220:223], a[20:23], a[8:11], 0
    v_cndmask_b32 v176, 0, v196, s[12:13]
    v_cndmask_b32 v177, 0, v197, s[12:13]
    v_cndmask_b32 v178, 0, v198, s[12:13]
    v_cndmask_b32 v179, 0, v199, s[12:13]
    v_mfma_f32_16x16x32_bf16 v[224:227], a[16:19], a[12:15], 0
    v_mfma_f32_16x16x32_bf16 v[228:231], a[20:23], a[12:15], 0
    v_cndmask_b32 v180, 0, v196, s[14:15]
    v_cndmask_b32 v181, 0, v197, s[14:15]
    v_cndmask_b32 v182, 0, v198, s[14:15]
    v_cndmask_b32 v183, 0, v199, s[14:15]
    v_mfma_f32_16x16x32_bf16 v[200:203], a[24:27], v[168:171], v[200:203]
    v_mfma_f32_16x16x32_bf16 v[204:207], a[28:31], v[168:171], v[204:207]
    v_mfma_f32_16x16x32_bf16 v[208:211], a[24:27], v[172:175], v[208:211]
    v_mfma_f32_16x16x32_bf16 v[212:215], a[28:31], v[172:175], v[212:215]
    v_mfma_f32_16x16x32_bf16 v[216:219], a[24:27], v[176:179], v[216:219]
    v_mfma_f32_16x16x32_bf16 v[220:223], a[28:31], v[176:179], v[220:223]
    v_mfma_f32_16x16x32_bf16 v[224:227], a[24:27], v[180:183], v[224:227]
    v_mfma_f32_16x16x32_bf16 v[228:231], a[28:31], v[180:183], v[228:231]
    s_add_u32 s81, s87, 8960
    buffer_load_dwordx4 a[0:3], v10, s[44:47], s81 offen
    buffer_load_dwordx4 a[4:7], v11, s[44:47], s81 offen
    buffer_load_dwordx4 a[8:11], v12, s[44:47], s81 offen
    buffer_load_dwordx4 a[12:15], v13, s[44:47], s81 offen
    buffer_load_dwordx4 v[196:199], v14, s[44:47], s81 offen
    s_add_u32 s80, s86, 17920
    buffer_load_dwordx4 a[16:19], v18, s[52:55], s80 offen offset:0 sc1
    buffer_load_dwordx4 a[20:23], v18, s[52:55], s80 offen offset:1024 sc1
    buffer_load_dwordx4 a[24:27], v20, s[52:55], s80 offen offset:2048 sc1
    buffer_load_dwordx4 a[28:31], v20, s[52:55], s80 offen offset:2304 sc1
    s_mul_i32 s80, s6, 5
    s_add_u32 s80, s80, s89
    s_add_u32 s80, s80, 58
    s_mul_i32 s80, s80, 5120
    buffer_load_dwordx4 a[112:115], v18, s[64:67], s80 offen offset:0
    buffer_load_dwordx4 a[116:119], v18, s[64:67], s80 offen offset:1024
    buffer_load_dwordx4 a[120:123], v18, s[64:67], s80 offen offset:2048
    buffer_load_dwordx4 a[124:127], v18, s[64:67], s80 offen offset:3072
    buffer_load_dwordx4 a[128:131], v19, s[64:67], s80 offen offset:0
    v_mfma_f32_16x16x32_bf16 v[88:91], a[40:43], v[128:131], v[88:91]
    v_mfma_f32_16x16x32_bf16 v[108:111], a[40:43], v[132:135], v[108:111]
    v_mfma_f32_16x16x32_bf16 v[52:55], a[44:47], v[120:123], v[52:55]
    v_add_f32 v206, 0x358637bd, v205
    v_add_f32 v214, 0x358637bd, v213
    v_add_f32 v222, 0x358637bd, v221
    v_add_f32 v230, 0x358637bd, v229
    v_mfma_f32_16x16x32_bf16 v[72:75], a[44:47], v[124:127], v[72:75]
    v_rcp_f32 v206, v206
    v_rcp_f32 v214, v214
    v_rcp_f32 v222, v222
    v_rcp_f32 v230, v230
    v_mfma_f32_16x16x32_bf16 v[92:95], a[44:47], v[128:131], v[92:95]
    v_mul_f32 v206, v206, v28
    v_mul_f32 v214, v214, v29
    v_mul_f32 v222, v222, v30
    v_mul_f32 v230, v230, v31
    v_mfma_f32_16x16x32_bf16 v[112:115], a[44:47], v[132:135], v[112:115]
    v_pk_mul_f32 v[200:201], v[200:201], v[206:207] op_sel_hi:[1,0]
    v_pk_mul_f32 v[202:203], v[202:203], v[206:207] op_sel_hi:[1,0]
    v_mul_f32 v204, v204, v206
    v_pk_mul_f32 v[208:209], v[208:209], v[214:215] op_sel_hi:[1,0]
    v_mfma_f32_16x16x32_bf16 v[56:59], a[48:51], v[120:123], v[56:59]
    v_pk_mul_f32 v[210:211], v[210:211], v[214:215] op_sel_hi:[1,0]
    v_mul_f32 v212, v212, v214
    v_pk_mul_f32 v[216:217], v[216:217], v[222:223] op_sel_hi:[1,0]
    v_pk_mul_f32 v[218:219], v[218:219], v[222:223] op_sel_hi:[1,0]
    v_mfma_f32_16x16x32_bf16 v[76:79], a[48:51], v[124:127], v[76:79]
    v_mul_f32 v220, v220, v222
    v_pk_mul_f32 v[224:225], v[224:225], v[230:231] op_sel_hi:[1,0]
    v_pk_mul_f32 v[226:227], v[226:227], v[230:231] op_sel_hi:[1,0]
    v_mul_f32 v228, v228, v230
    v_mfma_f32_16x16x32_bf16 v[96:99], a[48:51], v[128:131], v[96:99]
    v_cvt_pk_bf16_f32 v138, v200, v201
    v_cvt_pk_bf16_f32 v139, v202, v203
    v_cvt_pk_bf16_f32 v153, v232, v204
    v_cvt_pk_bf16_f32 v142, v208, v209
    v_mfma_f32_16x16x32_bf16 v[116:119], a[48:51], v[132:135], v[116:119]
    v_cvt_pk_bf16_f32 v143, v210, v211
    v_cvt_pk_bf16_f32 v157, v233, v212
    v_cvt_pk_bf16_f32 v146, v216, v217
    v_cvt_pk_bf16_f32 v147, v218, v219
    v_cvt_pk_bf16_f32 v161, v234, v220
    v_cvt_pk_bf16_f32 v150, v224, v225
    v_cvt_pk_bf16_f32 v151, v226, v227
    v_cvt_pk_bf16_f32 v165, v235, v228
    s_waitcnt vmcnt(47)
    v_mfma_f32_16x16x32_bf16 v[200:203], a[160:163], a[144:147], 0
    v_mfma_f32_16x16x32_bf16 v[204:207], a[164:167], a[144:147], 0
    v_cndmask_b32 v168, 0, v184, s[8:9]
    v_cndmask_b32 v169, 0, v185, s[8:9]
    v_cndmask_b32 v170, 0, v186, s[8:9]
    v_cndmask_b32 v171, 0, v187, s[8:9]
    v_mfma_f32_16x16x32_bf16 v[208:211], a[160:163], a[148:151], 0
    v_mfma_f32_16x16x32_bf16 v[212:215], a[164:167], a[148:151], 0
    v_cndmask_b32 v172, 0, v184, s[10:11]
    v_cndmask_b32 v173, 0, v185, s[10:11]
    v_cndmask_b32 v174, 0, v186, s[10:11]
    v_cndmask_b32 v175, 0, v187, s[10:11]
    v_mfma_f32_16x16x32_bf16 v[216:219], a[160:163], a[152:155], 0
    v_mfma_f32_16x16x32_bf16 v[220:223], a[164:167], a[152:155], 0
    v_cndmask_b32 v176, 0, v184, s[12:13]
    v_cndmask_b32 v177, 0, v185, s[12:13]
    v_cndmask_b32 v178, 0, v186, s[12:13]
    v_cndmask_b32 v179, 0, v187, s[12:13]
    v_mfma_f32_16x16x32_bf16 v[224:227], a[160:163], a[156:159], 0
    v_mfma_f32_16x16x32_bf16 v[228:231], a[164:167], a[156:159], 0
    v_cndmask_b32 v180, 0, v184, s[14:15]
    v_cndmask_b32 v181, 0, v185, s[14:15]
    v_cndmask_b32 v182, 0, v186, s[14:15]
    v_cndmask_b32 v183, 0, v187, s[14:15]
    v_mfma_f32_16x16x32_bf16 v[200:203], a[168:171], v[168:171], v[200:203]
    v_mfma_f32_16x16x32_bf16 v[204:207], a[172:175], v[168:171], v[204:207]
    v_mfma_f32_16x16x32_bf16 v[208:211], a[168:171], v[172:175], v[208:211]
    v_mfma_f32_16x16x32_bf16 v[212:215], a[172:175], v[172:175], v[212:215]
    v_mfma_f32_16x16x32_bf16 v[216:219], a[168:171], v[176:179], v[216:219]
    v_mfma_f32_16x16x32_bf16 v[220:223], a[172:175], v[176:179], v[220:223]
    v_mfma_f32_16x16x32_bf16 v[224:227], a[168:171], v[180:183], v[224:227]
    v_mfma_f32_16x16x32_bf16 v[228:231], a[172:175], v[180:183], v[228:231]
    s_waitcnt vmcnt(42)
    v_mfma_f32_16x16x32_bf16 v[40:43], a[52:55], v[136:139], v[40:43]
    v_mfma_f32_16x16x32_bf16 v[60:63], a[52:55], v[140:143], v[60:63]
    v_mfma_f32_16x16x32_bf16 v[80:83], a[52:55], v[144:147], v[80:83]
    v_add_f32 v206, 0x358637bd, v205
    v_add_f32 v214, 0x358637bd, v213
    v_add_f32 v222, 0x358637bd, v221
    s_nop 0
    v_add_f32 v230, 0x358637bd, v229
    v_mfma_f32_16x16x32_bf16 v[100:103], a[52:55], v[148:151], v[100:103]
    v_rcp_f32 v206, v206
    v_rcp_f32 v214, v214
    v_rcp_f32 v222, v222
    v_rcp_f32 v230, v230
    v_mfma_f32_16x16x32_bf16 v[44:47], a[56:59], v[136:139], v[44:47]
    v_mul_f32 v206, v206, v28
    v_mul_f32 v214, v214, v29
    v_mul_f32 v222, v222, v30
    v_mul_f32 v230, v230, v31
    v_mfma_f32_16x16x32_bf16 v[64:67], a[56:59], v[140:143], v[64:67]
    v_pk_mul_f32 v[200:201], v[200:201], v[206:207] op_sel_hi:[1,0]
    v_pk_mul_f32 v[202:203], v[202:203], v[206:207] op_sel_hi:[1,0]
    v_mul_f32 v232, v204, v206
    v_pk_mul_f32 v[208:209], v[208:209], v[214:215] op_sel_hi:[1,0]
    v_mfma_f32_16x16x32_bf16 v[84:87], a[56:59], v[144:147], v[84:87]
    v_pk_mul_f32 v[210:211], v[210:211], v[214:215] op_sel_hi:[1,0]
    v_mul_f32 v233, v212, v214
    v_pk_mul_f32 v[216:217], v[216:217], v[222:223] op_sel_hi:[1,0]
    v_pk_mul_f32 v[218:219], v[218:219], v[222:223] op_sel_hi:[1,0]
    v_mfma_f32_16x16x32_bf16 v[104:107], a[56:59], v[148:151], v[104:107]
    v_mul_f32 v234, v220, v222
    v_pk_mul_f32 v[224:225], v[224:225], v[230:231] op_sel_hi:[1,0]
    v_pk_mul_f32 v[226:227], v[226:227], v[230:231] op_sel_hi:[1,0]
    v_mul_f32 v235, v228, v230
    v_mfma_f32_16x16x32_bf16 v[48:51], a[60:63], v[136:139], v[48:51]
    v_cvt_pk_bf16_f32 v120, v200, v201
    v_cvt_pk_bf16_f32 v121, v202, v203
    v_cvt_pk_bf16_f32 v124, v208, v209
    v_cvt_pk_bf16_f32 v125, v210, v211
    v_mfma_f32_16x16x32_bf16 v[68:71], a[60:63], v[140:143], v[68:71]
    v_cvt_pk_bf16_f32 v128, v216, v217
    v_cvt_pk_bf16_f32 v129, v218, v219
    v_cvt_pk_bf16_f32 v132, v224, v225
    v_cvt_pk_bf16_f32 v133, v226, v227
    s_waitcnt vmcnt(33)
    v_mfma_f32_16x16x32_bf16 v[200:203], a[192:195], a[176:179], 0
    v_mfma_f32_16x16x32_bf16 v[204:207], a[196:199], a[176:179], 0
    v_cndmask_b32 v168, 0, v188, s[8:9]
    v_cndmask_b32 v169, 0, v189, s[8:9]
    v_cndmask_b32 v170, 0, v190, s[8:9]
    v_cndmask_b32 v171, 0, v191, s[8:9]
    v_mfma_f32_16x16x32_bf16 v[208:211], a[192:195], a[180:183], 0
    v_mfma_f32_16x16x32_bf16 v[212:215], a[196:199], a[180:183], 0
    v_cndmask_b32 v172, 0, v188, s[10:11]
    v_cndmask_b32 v173, 0, v189, s[10:11]
    v_cndmask_b32 v174, 0, v190, s[10:11]
    v_cndmask_b32 v175, 0, v191, s[10:11]
    v_mfma_f32_16x16x32_bf16 v[216:219], a[192:195], a[184:187], 0
    v_mfma_f32_16x16x32_bf16 v[220:223], a[196:199], a[184:187], 0
    v_cndmask_b32 v176, 0, v188, s[12:13]
    v_cndmask_b32 v177, 0, v189, s[12:13]
    v_cndmask_b32 v178, 0, v190, s[12:13]
    v_cndmask_b32 v179, 0, v191, s[12:13]
    v_mfma_f32_16x16x32_bf16 v[224:227], a[192:195], a[188:191], 0
    v_mfma_f32_16x16x32_bf16 v[228:231], a[196:199], a[188:191], 0
    v_cndmask_b32 v180, 0, v188, s[14:15]
    v_cndmask_b32 v181, 0, v189, s[14:15]
    v_cndmask_b32 v182, 0, v190, s[14:15]
    v_cndmask_b32 v183, 0, v191, s[14:15]
    v_mfma_f32_16x16x32_bf16 v[200:203], a[200:203], v[168:171], v[200:203]
    v_mfma_f32_16x16x32_bf16 v[204:207], a[204:207], v[168:171], v[204:207]
    v_mfma_f32_16x16x32_bf16 v[208:211], a[200:203], v[172:175], v[208:211]
    v_mfma_f32_16x16x32_bf16 v[212:215], a[204:207], v[172:175], v[212:215]
    v_mfma_f32_16x16x32_bf16 v[216:219], a[200:203], v[176:179], v[216:219]
    v_mfma_f32_16x16x32_bf16 v[220:223], a[204:207], v[176:179], v[220:223]
    v_mfma_f32_16x16x32_bf16 v[224:227], a[200:203], v[180:183], v[224:227]
    v_mfma_f32_16x16x32_bf16 v[228:231], a[204:207], v[180:183], v[228:231]
    v_mfma_f32_16x16x32_bf16 v[88:91], a[60:63], v[144:147], v[88:91]
    v_mfma_f32_16x16x32_bf16 v[108:111], a[60:63], v[148:151], v[108:111]
    v_mfma_f32_16x16x32_bf16 v[52:55], a[64:67], v[136:139], v[52:55]
    v_add_f32 v206, 0x358637bd, v205
    v_add_f32 v214, 0x358637bd, v213
    s_nop 0
    v_add_f32 v222, 0x358637bd, v221
    s_nop 0
    v_add_f32 v230, 0x358637bd, v229
    v_mfma_f32_16x16x32_bf16 v[72:75], a[64:67], v[140:143], v[72:75]
    v_rcp_f32 v206, v206
    v_rcp_f32 v214, v214
    v_rcp_f32 v222, v222
    v_rcp_f32 v230, v230
    v_mfma_f32_16x16x32_bf16 v[92:95], a[64:67], v[144:147], v[92:95]
    v_mul_f32 v206, v206, v28
    v_mul_f32 v214, v214, v29
    v_mul_f32 v222, v222, v30
    v_mul_f32 v230, v230, v31
    v_mfma_f32_16x16x32_bf16 v[112:115], a[64:67], v[148:151], v[112:115]
    v_pk_mul_f32 v[200:201], v[200:201], v[206:207] op_sel_hi:[1,0]
    v_pk_mul_f32 v[202:203], v[202:203], v[206:207] op_sel_hi:[1,0]
    v_mul_f32 v204, v204, v206
    v_pk_mul_f32 v[208:209], v[208:209], v[214:215] op_sel_hi:[1,0]
    v_mfma_f32_16x16x32_bf16 v[56:59], a[68:71], v[136:139], v[56:59]
    v_pk_mul_f32 v[210:211], v[210:211], v[214:215] op_sel_hi:[1,0]
    v_mul_f32 v212, v212, v214
    v_pk_mul_f32 v[216:217], v[216:217], v[222:223] op_sel_hi:[1,0]
    v_pk_mul_f32 v[218:219], v[218:219], v[222:223] op_sel_hi:[1,0]
    v_mfma_f32_16x16x32_bf16 v[76:79], a[68:71], v[140:143], v[76:79]
    v_mul_f32 v220, v220, v222
    v_pk_mul_f32 v[224:225], v[224:225], v[230:231] op_sel_hi:[1,0]
    v_pk_mul_f32 v[226:227], v[226:227], v[230:231] op_sel_hi:[1,0]
    v_mul_f32 v228, v228, v230
    v_mfma_f32_16x16x32_bf16 v[96:99], a[68:71], v[144:147], v[96:99]
    v_cvt_pk_bf16_f32 v122, v200, v201
    v_cvt_pk_bf16_f32 v123, v202, v203
    v_cvt_pk_bf16_f32 v154, v232, v204
    v_cvt_pk_bf16_f32 v126, v208, v209
    v_mfma_f32_16x16x32_bf16 v[116:119], a[68:71], v[148:151], v[116:119]
    v_cvt_pk_bf16_f32 v127, v210, v211
    v_cvt_pk_bf16_f32 v158, v233, v212
    v_cvt_pk_bf16_f32 v130, v216, v217
    v_cvt_pk_bf16_f32 v131, v218, v219
    v_cvt_pk_bf16_f32 v162, v234, v220
    v_cvt_pk_bf16_f32 v134, v224, v225
    v_cvt_pk_bf16_f32 v135, v226, v227
    v_cvt_pk_bf16_f32 v166, v235, v228
    s_waitcnt vmcnt(19)
    v_mfma_f32_16x16x32_bf16 v[200:203], a[224:227], a[208:211], 0
    v_mfma_f32_16x16x32_bf16 v[204:207], a[228:231], a[208:211], 0
    v_cndmask_b32 v168, 0, v192, s[8:9]
    v_cndmask_b32 v169, 0, v193, s[8:9]
    v_cndmask_b32 v170, 0, v194, s[8:9]
    v_cndmask_b32 v171, 0, v195, s[8:9]
    v_mfma_f32_16x16x32_bf16 v[208:211], a[224:227], a[212:215], 0
    v_mfma_f32_16x16x32_bf16 v[212:215], a[228:231], a[212:215], 0
    v_cndmask_b32 v172, 0, v192, s[10:11]
    v_cndmask_b32 v173, 0, v193, s[10:11]
    v_cndmask_b32 v174, 0, v194, s[10:11]
    v_cndmask_b32 v175, 0, v195, s[10:11]
    v_mfma_f32_16x16x32_bf16 v[216:219], a[224:227], a[216:219], 0
    v_mfma_f32_16x16x32_bf16 v[220:223], a[228:231], a[216:219], 0
    v_cndmask_b32 v176, 0, v192, s[12:13]
    v_cndmask_b32 v177, 0, v193, s[12:13]
    v_cndmask_b32 v178, 0, v194, s[12:13]
    v_cndmask_b32 v179, 0, v195, s[12:13]
    v_mfma_f32_16x16x32_bf16 v[224:227], a[224:227], a[220:223], 0
    v_mfma_f32_16x16x32_bf16 v[228:231], a[228:231], a[220:223], 0
    v_cndmask_b32 v180, 0, v192, s[14:15]
    v_cndmask_b32 v181, 0, v193, s[14:15]
    v_cndmask_b32 v182, 0, v194, s[14:15]
    v_cndmask_b32 v183, 0, v195, s[14:15]
    v_mfma_f32_16x16x32_bf16 v[200:203], a[232:235], v[168:171], v[200:203]
    v_mfma_f32_16x16x32_bf16 v[204:207], a[236:239], v[168:171], v[204:207]
    v_mfma_f32_16x16x32_bf16 v[208:211], a[232:235], v[172:175], v[208:211]
    v_mfma_f32_16x16x32_bf16 v[212:215], a[236:239], v[172:175], v[212:215]
    v_mfma_f32_16x16x32_bf16 v[216:219], a[232:235], v[176:179], v[216:219]
    v_mfma_f32_16x16x32_bf16 v[220:223], a[236:239], v[176:179], v[220:223]
    v_mfma_f32_16x16x32_bf16 v[224:227], a[232:235], v[180:183], v[224:227]
    v_mfma_f32_16x16x32_bf16 v[228:231], a[236:239], v[180:183], v[228:231]
    v_mfma_f32_16x16x32_bf16 v[40:43], a[72:75], v[120:123], v[40:43]
    v_mfma_f32_16x16x32_bf16 v[60:63], a[72:75], v[124:127], v[60:63]
    v_mfma_f32_16x16x32_bf16 v[80:83], a[72:75], v[128:131], v[80:83]
    v_add_f32 v206, 0x358637bd, v205
    v_add_f32 v214, 0x358637bd, v213
    s_nop 0
    v_add_f32 v222, 0x358637bd, v221
    s_nop 0
    v_add_f32 v230, 0x358637bd, v229
    v_mfma_f32_16x16x32_bf16 v[100:103], a[72:75], v[132:135], v[100:103]
    v_rcp_f32 v206, v206
    v_rcp_f32 v214, v214
    v_rcp_f32 v222, v222
    v_rcp_f32 v230, v230
    v_mfma_f32_16x16x32_bf16 v[44:47], a[76:79], v[120:123], v[44:47]
    v_mul_f32 v206, v206, v28
    v_mul_f32 v214, v214, v29
    v_mul_f32 v222, v222, v30
    v_mul_f32 v230, v230, v31
    v_mfma_f32_16x16x32_bf16 v[64:67], a[76:79], v[124:127], v[64:67]
    v_pk_mul_f32 v[200:201], v[200:201], v[206:207] op_sel_hi:[1,0]
    v_pk_mul_f32 v[202:203], v[202:203], v[206:207] op_sel_hi:[1,0]
    v_mul_f32 v232, v204, v206
    v_pk_mul_f32 v[208:209], v[208:209], v[214:215] op_sel_hi:[1,0]
    v_mfma_f32_16x16x32_bf16 v[84:87], a[76:79], v[128:131], v[84:87]
    v_pk_mul_f32 v[210:211], v[210:211], v[214:215] op_sel_hi:[1,0]
    v_mul_f32 v233, v212, v214
    v_pk_mul_f32 v[216:217], v[216:217], v[222:223] op_sel_hi:[1,0]
    v_pk_mul_f32 v[218:219], v[218:219], v[222:223] op_sel_hi:[1,0]
    v_mfma_f32_16x16x32_bf16 v[104:107], a[76:79], v[132:135], v[104:107]
    v_mul_f32 v234, v220, v222
    v_pk_mul_f32 v[224:225], v[224:225], v[230:231] op_sel_hi:[1,0]
    v_pk_mul_f32 v[226:227], v[226:227], v[230:231] op_sel_hi:[1,0]
    v_mul_f32 v235, v228, v230
    v_mfma_f32_16x16x32_bf16 v[48:51], a[80:83], v[120:123], v[48:51]
    v_cvt_pk_bf16_f32 v136, v200, v201
    v_cvt_pk_bf16_f32 v137, v202, v203
    v_cvt_pk_bf16_f32 v140, v208, v209
    v_cvt_pk_bf16_f32 v141, v210, v211
    v_mfma_f32_16x16x32_bf16 v[68:71], a[80:83], v[124:127], v[68:71]
    v_cvt_pk_bf16_f32 v144, v216, v217
    v_cvt_pk_bf16_f32 v145, v218, v219
    v_cvt_pk_bf16_f32 v148, v224, v225
    v_cvt_pk_bf16_f32 v149, v226, v227
    s_waitcnt vmcnt(5)
    v_mfma_f32_16x16x32_bf16 v[200:203], a[16:19], a[0:3], 0
    v_mfma_f32_16x16x32_bf16 v[204:207], a[20:23], a[0:3], 0
    v_cndmask_b32 v168, 0, v196, s[8:9]
    v_cndmask_b32 v169, 0, v197, s[8:9]
    v_cndmask_b32 v170, 0, v198, s[8:9]
    v_cndmask_b32 v171, 0, v199, s[8:9]
    v_mfma_f32_16x16x32_bf16 v[208:211], a[16:19], a[4:7], 0
    v_mfma_f32_16x16x32_bf16 v[212:215], a[20:23], a[4:7], 0
    v_cndmask_b32 v172, 0, v196, s[10:11]
    v_cndmask_b32 v173, 0, v197, s[10:11]
    v_cndmask_b32 v174, 0, v198, s[10:11]
    v_cndmask_b32 v175, 0, v199, s[10:11]
    v_mfma_f32_16x16x32_bf16 v[216:219], a[16:19], a[8:11], 0
    v_mfma_f32_16x16x32_bf16 v[220:223], a[20:23], a[8:11], 0
    v_cndmask_b32 v176, 0, v196, s[12:13]
    v_cndmask_b32 v177, 0, v197, s[12:13]
    v_cndmask_b32 v178, 0, v198, s[12:13]
    v_cndmask_b32 v179, 0, v199, s[12:13]
    v_mfma_f32_16x16x32_bf16 v[224:227], a[16:19], a[12:15], 0
    v_mfma_f32_16x16x32_bf16 v[228:231], a[20:23], a[12:15], 0
    v_cndmask_b32 v180, 0, v196, s[14:15]
    v_cndmask_b32 v181, 0, v197, s[14:15]
    v_cndmask_b32 v182, 0, v198, s[14:15]
    v_cndmask_b32 v183, 0, v199, s[14:15]
    v_mfma_f32_16x16x32_bf16 v[200:203], a[24:27], v[168:171], v[200:203]
    v_mfma_f32_16x16x32_bf16 v[204:207], a[28:31], v[168:171], v[204:207]
    v_mfma_f32_16x16x32_bf16 v[208:211], a[24:27], v[172:175], v[208:211]
    v_mfma_f32_16x16x32_bf16 v[212:215], a[28:31], v[172:175], v[212:215]
    v_mfma_f32_16x16x32_bf16 v[216:219], a[24:27], v[176:179], v[216:219]
    v_mfma_f32_16x16x32_bf16 v[220:223], a[28:31], v[176:179], v[220:223]
    v_mfma_f32_16x16x32_bf16 v[224:227], a[24:27], v[180:183], v[224:227]
    v_mfma_f32_16x16x32_bf16 v[228:231], a[28:31], v[180:183], v[228:231]
    v_mfma_f32_16x16x32_bf16 v[88:91], a[80:83], v[128:131], v[88:91]
    v_mfma_f32_16x16x32_bf16 v[108:111], a[80:83], v[132:135], v[108:111]
    v_mfma_f32_16x16x32_bf16 v[52:55], a[84:87], v[120:123], v[52:55]
    v_add_f32 v206, 0x358637bd, v205
    v_add_f32 v214, 0x358637bd, v213
    s_nop 0
    v_add_f32 v222, 0x358637bd, v221
    s_nop 0
    v_add_f32 v230, 0x358637bd, v229
    v_mfma_f32_16x16x32_bf16 v[72:75], a[84:87], v[124:127], v[72:75]
    v_rcp_f32 v206, v206
    v_rcp_f32 v214, v214
    v_rcp_f32 v222, v222
    v_rcp_f32 v230, v230
    v_mfma_f32_16x16x32_bf16 v[92:95], a[84:87], v[128:131], v[92:95]
    v_mul_f32 v206, v206, v28
    v_mul_f32 v214, v214, v29
    v_mul_f32 v222, v222, v30
    v_mul_f32 v230, v230, v31
    v_mfma_f32_16x16x32_bf16 v[112:115], a[84:87], v[132:135], v[112:115]
    v_pk_mul_f32 v[200:201], v[200:201], v[206:207] op_sel_hi:[1,0]
    v_pk_mul_f32 v[202:203], v[202:203], v[206:207] op_sel_hi:[1,0]
    v_mul_f32 v204, v204, v206
    v_pk_mul_f32 v[208:209], v[208:209], v[214:215] op_sel_hi:[1,0]
    v_mfma_f32_16x16x32_bf16 v[56:59], a[88:91], v[120:123], v[56:59]
    v_pk_mul_f32 v[210:211], v[210:211], v[214:215] op_sel_hi:[1,0]
    v_mul_f32 v212, v212, v214
    v_pk_mul_f32 v[216:217], v[216:217], v[222:223] op_sel_hi:[1,0]
    v_pk_mul_f32 v[218:219], v[218:219], v[222:223] op_sel_hi:[1,0]
    v_mfma_f32_16x16x32_bf16 v[76:79], a[88:91], v[124:127], v[76:79]
    v_mul_f32 v220, v220, v222
    v_pk_mul_f32 v[224:225], v[224:225], v[230:231] op_sel_hi:[1,0]
    v_pk_mul_f32 v[226:227], v[226:227], v[230:231] op_sel_hi:[1,0]
    v_mul_f32 v228, v228, v230
    v_mfma_f32_16x16x32_bf16 v[96:99], a[88:91], v[128:131], v[96:99]
    v_cvt_pk_bf16_f32 v138, v200, v201
    v_cvt_pk_bf16_f32 v139, v202, v203
    v_cvt_pk_bf16_f32 v155, v232, v204
    v_cvt_pk_bf16_f32 v142, v208, v209
    v_mfma_f32_16x16x32_bf16 v[116:119], a[88:91], v[132:135], v[116:119]
    v_cvt_pk_bf16_f32 v143, v210, v211
    v_cvt_pk_bf16_f32 v159, v233, v212
    v_cvt_pk_bf16_f32 v146, v216, v217
    v_cvt_pk_bf16_f32 v147, v218, v219
    v_cvt_pk_bf16_f32 v163, v234, v220
    v_cvt_pk_bf16_f32 v150, v224, v225
    v_cvt_pk_bf16_f32 v151, v226, v227
    v_cvt_pk_bf16_f32 v167, v235, v228
    v_mfma_f32_16x16x32_bf16 v[40:43], a[92:95], v[136:139], v[40:43]
    v_mfma_f32_16x16x32_bf16 v[60:63], a[92:95], v[140:143], v[60:63]
    v_mfma_f32_16x16x32_bf16 v[80:83], a[92:95], v[144:147], v[80:83]
    v_mfma_f32_16x16x32_bf16 v[100:103], a[92:95], v[148:151], v[100:103]
    v_mfma_f32_16x16x32_bf16 v[44:47], a[96:99], v[136:139], v[44:47]
    v_mfma_f32_16x16x32_bf16 v[64:67], a[96:99], v[140:143], v[64:67]
    v_mfma_f32_16x16x32_bf16 v[84:87], a[96:99], v[144:147], v[84:87]
    v_mfma_f32_16x16x32_bf16 v[104:107], a[96:99], v[148:151], v[104:107]
    v_mfma_f32_16x16x32_bf16 v[48:51], a[100:103], v[136:139], v[48:51]
    v_mfma_f32_16x16x32_bf16 v[68:71], a[100:103], v[140:143], v[68:71]
    v_mfma_f32_16x16x32_bf16 v[88:91], a[100:103], v[144:147], v[88:91]
    v_mfma_f32_16x16x32_bf16 v[108:111], a[100:103], v[148:151], v[108:111]
    v_mfma_f32_16x16x32_bf16 v[52:55], a[104:107], v[136:139], v[52:55]
    v_mfma_f32_16x16x32_bf16 v[72:75], a[104:107], v[140:143], v[72:75]
    v_mfma_f32_16x16x32_bf16 v[92:95], a[104:107], v[144:147], v[92:95]
    v_mfma_f32_16x16x32_bf16 v[112:115], a[104:107], v[148:151], v[112:115]
    v_mfma_f32_16x16x32_bf16 v[56:59], a[108:111], v[136:139], v[56:59]
    v_mfma_f32_16x16x32_bf16 v[76:79], a[108:111], v[140:143], v[76:79]
    v_mfma_f32_16x16x32_bf16 v[96:99], a[108:111], v[144:147], v[96:99]
    v_mfma_f32_16x16x32_bf16 v[116:119], a[108:111], v[148:151], v[116:119]
    s_waitcnt vmcnt(0)
    v_mfma_f32_16x16x32_bf16 v[40:43], a[112:115], v[152:155], v[40:43]
    v_mfma_f32_16x16x32_bf16 v[60:63], a[112:115], v[156:159], v[60:63]
    v_mfma_f32_16x16x32_bf16 v[80:83], a[112:115], v[160:163], v[80:83]
    v_mfma_f32_16x16x32_bf16 v[100:103], a[112:115], v[164:167], v[100:103]
    v_mfma_f32_16x16x32_bf16 v[44:47], a[116:119], v[152:155], v[44:47]
    v_mfma_f32_16x16x32_bf16 v[64:67], a[116:119], v[156:159], v[64:67]
    v_mfma_f32_16x16x32_bf16 v[84:87], a[116:119], v[160:163], v[84:87]
    v_mfma_f32_16x16x32_bf16 v[104:107], a[116:119], v[164:167], v[104:107]
    v_mfma_f32_16x16x32_bf16 v[48:51], a[120:123], v[152:155], v[48:51]
    v_mfma_f32_16x16x32_bf16 v[68:71], a[120:123], v[156:159], v[68:71]
    v_mfma_f32_16x16x32_bf16 v[88:91], a[120:123], v[160:163], v[88:91]
    v_mfma_f32_16x16x32_bf16 v[108:111], a[120:123], v[164:167], v[108:111]
    v_mfma_f32_16x16x32_bf16 v[52:55], a[124:127], v[152:155], v[52:55]
    v_mfma_f32_16x16x32_bf16 v[72:75], a[124:127], v[156:159], v[72:75]
    v_mfma_f32_16x16x32_bf16 v[92:95], a[124:127], v[160:163], v[92:95]
    v_mfma_f32_16x16x32_bf16 v[112:115], a[124:127], v[164:167], v[112:115]
    v_mfma_f32_16x16x32_bf16 v[56:59], a[128:131], v[152:155], v[56:59]
    v_mfma_f32_16x16x32_bf16 v[76:79], a[128:131], v[156:159], v[76:79]
    v_mfma_f32_16x16x32_bf16 v[96:99], a[128:131], v[160:163], v[96:99]
    v_mfma_f32_16x16x32_bf16 v[116:119], a[128:131], v[164:167], v[116:119]
    s_mul_i32 s80, s6, 15360
    v_add_u32 v6, s80, v18
    s_lshl_b32 s80, s6, 4
    s_lshl_b32 s81, s4, 6
    s_add_u32 s81, s81, s80
    v_add_u32 v32, s81, v1
    v_mul_u32_u24 v32, 1280, v32
    s_mul_i32 s82, s5, 160
    v_add_u32 v32, s82, v32
    v_lshl_add_u32 v7, v2, 4, v32
    v_lshl_add_u32 v8, v2, 3, v32
    s_nop 7
    s_nop 3
    s_cmp_eq_u32 s6, 1
    s_cbranch_scc1 L_k2_red1
    s_cmp_eq_u32 s6, 2
    s_cbranch_scc1 L_k2_red2
    s_cmp_eq_u32 s6, 3
    s_cbranch_scc1 L_k2_red3
    ds_write_b128 v18, v[60:63] offset:25600
    ds_write_b128 v18, v[64:67] offset:26624
    ds_write_b128 v18, v[68:71] offset:27648
    ds_write_b128 v18, v[72:75] offset:28672
    ds_write_b128 v18, v[76:79] offset:29696
    ds_write_b128 v18, v[80:83] offset:35840
    ds_write_b128 v18, v[84:87] offset:36864
    ds_write_b128 v18, v[88:91] offset:37888
    ds_write_b128 v18, v[92:95] offset:38912
    ds_write_b128 v18, v[96:99] offset:39936
    ds_write_b128 v18, v[100:103] offset:46080
    ds_write_b128 v18, v[104:107] offset:47104
    ds_write_b128 v18, v[108:111] offset:48128
    ds_write_b128 v18, v[112:115] offset:49152
    ds_write_b128 v18, v[116:119] offset:50176
    s_waitcnt lgkmcnt(0)
    s_barrier
    ds_read_b128 v[120:123], v6 offset:0
    ds_read_b128 v[124:127], v6 offset:1024
    ds_read_b128 v[128:131], v6 offset:2048
    ds_read_b128 v[132:135], v6 offset:3072
    ds_read_b128 v[136:139], v6 offset:4096
    ds_read_b128 v[140:143], v6 offset:5120
    ds_read_b128 v[144:147], v6 offset:6144
    ds_read_b128 v[148:151], v6 offset:7168
    ds_read_b128 v[152:155], v6 offset:8192
    ds_read_b128 v[156:159], v6 offset:9216
    ds_read_b128 v[160:163], v6 offset:10240
    ds_read_b128 v[164:167], v6 offset:11264
    ds_read_b128 v[168:171], v6 offset:12288
    ds_read_b128 v[172:175], v6 offset:13312
    ds_read_b128 v[176:179], v6 offset:14336
    s_waitcnt lgkmcnt(14)
    v_pk_add_f32 v[40:41], v[40:41], v[120:121]
    v_pk_add_f32 v[42:43], v[42:43], v[122:123]
    s_waitcnt lgkmcnt(13)
    v_pk_add_f32 v[44:45], v[44:45], v[124:125]
    v_pk_add_f32 v[46:47], v[46:47], v[126:127]
    s_waitcnt lgkmcnt(12)
    v_pk_add_f32 v[48:49], v[48:49], v[128:129]
    v_pk_add_f32 v[50:51], v[50:51], v[130:131]
    s_waitcnt lgkmcnt(11)
    v_pk_add_f32 v[52:53], v[52:53], v[132:133]
    v_pk_add_f32 v[54:55], v[54:55], v[134:135]
    s_waitcnt lgkmcnt(10)
    v_pk_add_f32 v[56:57], v[56:57], v[136:137]
    v_pk_add_f32 v[58:59], v[58:59], v[138:139]
    s_waitcnt lgkmcnt(9)
    v_pk_add_f32 v[40:41], v[40:41], v[140:141]
    v_pk_add_f32 v[42:43], v[42:43], v[142:143]
    s_waitcnt lgkmcnt(8)
    v_pk_add_f32 v[44:45], v[44:45], v[144:145]
    v_pk_add_f32 v[46:47], v[46:47], v[146:147]
    s_waitcnt lgkmcnt(7)
    v_pk_add_f32 v[48:49], v[48:49], v[148:149]
    v_pk_add_f32 v[50:51], v[50:51], v[150:151]
    s_waitcnt lgkmcnt(6)
    v_pk_add_f32 v[52:53], v[52:53], v[152:153]
    v_pk_add_f32 v[54:55], v[54:55], v[154:155]
    s_waitcnt lgkmcnt(5)
    v_pk_add_f32 v[56:57], v[56:57], v[156:157]
    v_pk_add_f32 v[58:59], v[58:59], v[158:159]
    s_waitcnt lgkmcnt(4)
    v_pk_add_f32 v[40:41], v[40:41], v[160:161]
    v_pk_add_f32 v[42:43], v[42:43], v[162:163]
    s_waitcnt lgkmcnt(3)
    v_pk_add_f32 v[44:45], v[44:45], v[164:165]
    v_pk_add_f32 v[46:47], v[46:47], v[166:167]
    s_waitcnt lgkmcnt(2)
    v_pk_add_f32 v[48:49], v[48:49], v[168:169]
    v_pk_add_f32 v[50:51], v[50:51], v[170:171]
    s_waitcnt lgkmcnt(1)
    v_pk_add_f32 v[52:53], v[52:53], v[172:173]
    v_pk_add_f32 v[54:55], v[54:55], v[174:175]
    s_waitcnt lgkmcnt(0)
    v_pk_add_f32 v[56:57], v[56:57], v[176:177]
    v_pk_add_f32 v[58:59], v[58:59], v[178:179]
    v_cvt_pk_bf16_f32 v200, v40, v41
    v_cvt_pk_bf16_f32 v201, v42, v43
    v_cvt_pk_bf16_f32 v202, v44, v45
    v_cvt_pk_bf16_f32 v203, v46, v47
    v_cvt_pk_bf16_f32 v204, v48, v49
    v_cvt_pk_bf16_f32 v205, v50, v51
    v_cvt_pk_bf16_f32 v206, v52, v53
    v_cvt_pk_bf16_f32 v207, v54, v55
    v_cvt_pk_bf16_f32 v208, v56, v57
    v_cvt_pk_bf16_f32 v209, v58, v59
    buffer_store_dwordx4 v[200:203], v7, s[72:75], 0 offen
    buffer_store_dwordx4 v[204:207], v7, s[72:75], 0 offen offset:64
    buffer_store_dwordx2 v[208:209], v8, s[72:75], 0 offen offset:128
    s_branch L_k2_fin
L_k2_red1:
    ds_write_b128 v18, v[80:83] offset:40960
    ds_write_b128 v18, v[84:87] offset:41984
    ds_write_b128 v18, v[88:91] offset:43008
    ds_write_b128 v18, v[92:95] offset:44032
    ds_write_b128 v18, v[96:99] offset:45056
    ds_write_b128 v18, v[100:103] offset:51200
    ds_write_b128 v18, v[104:107] offset:52224
    ds_write_b128 v18, v[108:111] offset:53248
    ds_write_b128 v18, v[112:115] offset:54272
    ds_write_b128 v18, v[116:119] offset:55296
    ds_write_b128 v18, v[40:43] offset:0
    ds_write_b128 v18, v[44:47] offset:1024
    ds_write_b128 v18, v[48:51] offset:2048
    ds_write_b128 v18, v[52:55] offset:3072
    ds_write_b128 v18, v[56:59] offset:4096
    s_waitcnt lgkmcnt(0)
    s_barrier
    ds_read_b128 v[120:123], v6 offset:0
    ds_read_b128 v[124:127], v6 offset:1024
    ds_read_b128 v[128:131], v6 offset:2048
    ds_read_b128 v[132:135], v6 offset:3072
    ds_read_b128 v[136:139], v6 offset:4096
    ds_read_b128 v[140:143], v6 offset:5120
    ds_read_b128 v[144:147], v6 offset:6144
    ds_read_b128 v[148:151], v6 offset:7168
    ds_read_b128 v[152:155], v6 offset:8192
    ds_read_b128 v[156:159], v6 offset:9216
    ds_read_b128 v[160:163], v6 offset:10240
    ds_read_b128 v[164:167], v6 offset:11264
    ds_read_b128 v[168:171], v6 offset:12288
    ds_read_b128 v[172:175], v6 offset:13312
    ds_read_b128 v[176:179], v6 offset:14336
    s_waitcnt lgkmcnt(14)
    v_pk_add_f32 v[60:61], v[60:61], v[120:121]
    v_pk_add_f32 v[62:63], v[62:63], v[122:123]
    s_waitcnt lgkmcnt(13)
    v_pk_add_f32 v[64:65], v[64:65], v[124:125]
    v_pk_add_f32 v[66:67], v[66:67], v[126:127]
    s_waitcnt lgkmcnt(12)
    v_pk_add_f32 v[68:69], v[68:69], v[128:129]
    v_pk_add_f32 v[70:71], v[70:71], v[130:131]
    s_waitcnt lgkmcnt(11)
    v_pk_add_f32 v[72:73], v[72:73], v[132:133]
    v_pk_add_f32 v[74:75], v[74:75], v[134:135]
    s_waitcnt lgkmcnt(10)
    v_pk_add_f32 v[76:77], v[76:77], v[136:137]
    v_pk_add_f32 v[78:79], v[78:79], v[138:139]
    s_waitcnt lgkmcnt(9)
    v_pk_add_f32 v[60:61], v[60:61], v[140:141]
    v_pk_add_f32 v[62:63], v[62:63], v[142:143]
    s_waitcnt lgkmcnt(8)
    v_pk_add_f32 v[64:65], v[64:65], v[144:145]
    v_pk_add_f32 v[66:67], v[66:67], v[146:147]
    s_waitcnt lgkmcnt(7)
    v_pk_add_f32 v[68:69], v[68:69], v[148:149]
    v_pk_add_f32 v[70:71], v[70:71], v[150:151]
    s_waitcnt lgkmcnt(6)
    v_pk_add_f32 v[72:73], v[72:73], v[152:153]
    v_pk_add_f32 v[74:75], v[74:75], v[154:155]
    s_waitcnt lgkmcnt(5)
    v_pk_add_f32 v[76:77], v[76:77], v[156:157]
    v_pk_add_f32 v[78:79], v[78:79], v[158:159]
    s_waitcnt lgkmcnt(4)
    v_pk_add_f32 v[60:61], v[60:61], v[160:161]
    v_pk_add_f32 v[62:63], v[62:63], v[162:163]
    s_waitcnt lgkmcnt(3)
    v_pk_add_f32 v[64:65], v[64:65], v[164:165]
    v_pk_add_f32 v[66:67], v[66:67], v[166:167]
    s_waitcnt lgkmcnt(2)
    v_pk_add_f32 v[68:69], v[68:69], v[168:169]
    v_pk_add_f32 v[70:71], v[70:71], v[170:171]
    s_waitcnt lgkmcnt(1)
    v_pk_add_f32 v[72:73], v[72:73], v[172:173]
    v_pk_add_f32 v[74:75], v[74:75], v[174:175]
    s_waitcnt lgkmcnt(0)
    v_pk_add_f32 v[76:77], v[76:77], v[176:177]
    v_pk_add_f32 v[78:79], v[78:79], v[178:179]
    v_cvt_pk_bf16_f32 v200, v60, v61
    v_cvt_pk_bf16_f32 v201, v62, v63
    v_cvt_pk_bf16_f32 v202, v64, v65
    v_cvt_pk_bf16_f32 v203, v66, v67
    v_cvt_pk_bf16_f32 v204, v68, v69
    v_cvt_pk_bf16_f32 v205, v70, v71
    v_cvt_pk_bf16_f32 v206, v72, v73
    v_cvt_pk_bf16_f32 v207, v74, v75
    v_cvt_pk_bf16_f32 v208, v76, v77
    v_cvt_pk_bf16_f32 v209, v78, v79
    buffer_store_dwordx4 v[200:203], v7, s[72:75], 0 offen
    buffer_store_dwordx4 v[204:207], v7, s[72:75], 0 offen offset:64
    buffer_store_dwordx2 v[208:209], v8, s[72:75], 0 offen offset:128
    s_branch L_k2_fin
L_k2_red2:
    ds_write_b128 v18, v[100:103] offset:56320
    ds_write_b128 v18, v[104:107] offset:57344
    ds_write_b128 v18, v[108:111] offset:58368
    ds_write_b128 v18, v[112:115] offset:59392
    ds_write_b128 v18, v[116:119] offset:60416
    ds_write_b128 v18, v[40:43] offset:5120
    ds_write_b128 v18, v[44:47] offset:6144
    ds_write_b128 v18, v[48:51] offset:7168
    ds_write_b128 v18, v[52:55] offset:8192
    ds_write_b128 v18, v[56:59] offset:9216
    ds_write_b128 v18, v[60:63] offset:15360
    ds_write_b128 v18, v[64:67] offset:16384
    ds_write_b128 v18, v[68:71] offset:17408
    ds_write_b128 v18, v[72:75] offset:18432
    ds_write_b128 v18, v[76:79] offset:19456
    s_waitcnt lgkmcnt(0)
    s_barrier
    ds_read_b128 v[120:123], v6 offset:0
    ds_read_b128 v[124:127], v6 offset:1024
    ds_read_b128 v[128:131], v6 offset:2048
    ds_read_b128 v[132:135], v6 offset:3072
    ds_read_b128 v[136:139], v6 offset:4096
    ds_read_b128 v[140:143], v6 offset:5120
    ds_read_b128 v[144:147], v6 offset:6144
    ds_read_b128 v[148:151], v6 offset:7168
    ds_read_b128 v[152:155], v6 offset:8192
    ds_read_b128 v[156:159], v6 offset:9216
    ds_read_b128 v[160:163], v6 offset:10240
    ds_read_b128 v[164:167], v6 offset:11264
    ds_read_b128 v[168:171], v6 offset:12288
    ds_read_b128 v[172:175], v6 offset:13312
    ds_read_b128 v[176:179], v6 offset:14336
    s_waitcnt lgkmcnt(14)
    v_pk_add_f32 v[80:81], v[80:81], v[120:121]
    v_pk_add_f32 v[82:83], v[82:83], v[122:123]
    s_waitcnt lgkmcnt(13)
    v_pk_add_f32 v[84:85], v[84:85], v[124:125]
    v_pk_add_f32 v[86:87], v[86:87], v[126:127]
    s_waitcnt lgkmcnt(12)
    v_pk_add_f32 v[88:89], v[88:89], v[128:129]
    v_pk_add_f32 v[90:91], v[90:91], v[130:131]
    s_waitcnt lgkmcnt(11)
    v_pk_add_f32 v[92:93], v[92:93], v[132:133]
    v_pk_add_f32 v[94:95], v[94:95], v[134:135]
    s_waitcnt lgkmcnt(10)
    v_pk_add_f32 v[96:97], v[96:97], v[136:137]
    v_pk_add_f32 v[98:99], v[98:99], v[138:139]
    s_waitcnt lgkmcnt(9)
    v_pk_add_f32 v[80:81], v[80:81], v[140:141]
    v_pk_add_f32 v[82:83], v[82:83], v[142:143]
    s_waitcnt lgkmcnt(8)
    v_pk_add_f32 v[84:85], v[84:85], v[144:145]
    v_pk_add_f32 v[86:87], v[86:87], v[146:147]
    s_waitcnt lgkmcnt(7)
    v_pk_add_f32 v[88:89], v[88:89], v[148:149]
    v_pk_add_f32 v[90:91], v[90:91], v[150:151]
    s_waitcnt lgkmcnt(6)
    v_pk_add_f32 v[92:93], v[92:93], v[152:153]
    v_pk_add_f32 v[94:95], v[94:95], v[154:155]
    s_waitcnt lgkmcnt(5)
    v_pk_add_f32 v[96:97], v[96:97], v[156:157]
    v_pk_add_f32 v[98:99], v[98:99], v[158:159]
    s_waitcnt lgkmcnt(4)
    v_pk_add_f32 v[80:81], v[80:81], v[160:161]
    v_pk_add_f32 v[82:83], v[82:83], v[162:163]
    s_waitcnt lgkmcnt(3)
    v_pk_add_f32 v[84:85], v[84:85], v[164:165]
    v_pk_add_f32 v[86:87], v[86:87], v[166:167]
    s_waitcnt lgkmcnt(2)
    v_pk_add_f32 v[88:89], v[88:89], v[168:169]
    v_pk_add_f32 v[90:91], v[90:91], v[170:171]
    s_waitcnt lgkmcnt(1)
    v_pk_add_f32 v[92:93], v[92:93], v[172:173]
    v_pk_add_f32 v[94:95], v[94:95], v[174:175]
    s_waitcnt lgkmcnt(0)
    v_pk_add_f32 v[96:97], v[96:97], v[176:177]
    v_pk_add_f32 v[98:99], v[98:99], v[178:179]
    v_cvt_pk_bf16_f32 v200, v80, v81
    v_cvt_pk_bf16_f32 v201, v82, v83
    v_cvt_pk_bf16_f32 v202, v84, v85
    v_cvt_pk_bf16_f32 v203, v86, v87
    v_cvt_pk_bf16_f32 v204, v88, v89
    v_cvt_pk_bf16_f32 v205, v90, v91
    v_cvt_pk_bf16_f32 v206, v92, v93
    v_cvt_pk_bf16_f32 v207, v94, v95
    v_cvt_pk_bf16_f32 v208, v96, v97
    v_cvt_pk_bf16_f32 v209, v98, v99
    buffer_store_dwordx4 v[200:203], v7, s[72:75], 0 offen
    buffer_store_dwordx4 v[204:207], v7, s[72:75], 0 offen offset:64
    buffer_store_dwordx2 v[208:209], v8, s[72:75], 0 offen offset:128
    s_branch L_k2_fin
L_k2_red3:
    ds_write_b128 v18, v[40:43] offset:10240
    ds_write_b128 v18, v[44:47] offset:11264
    ds_write_b128 v18, v[48:51] offset:12288
    ds_write_b128 v18, v[52:55] offset:13312
    ds_write_b128 v18, v[56:59] offset:14336
    ds_write_b128 v18, v[60:63] offset:20480
    ds_write_b128 v18, v[64:67] offset:21504
    ds_write_b128 v18, v[68:71] offset:22528
    ds_write_b128 v18, v[72:75] offset:23552
    ds_write_b128 v18, v[76:79] offset:24576
    ds_write_b128 v18, v[80:83] offset:30720
    ds_write_b128 v18, v[84:87] offset:31744
    ds_write_b128 v18, v[88:91] offset:32768
    ds_write_b128 v18, v[92:95] offset:33792
    ds_write_b128 v18, v[96:99] offset:34816
    s_waitcnt lgkmcnt(0)
    s_barrier
    ds_read_b128 v[120:123], v6 offset:0
    ds_read_b128 v[124:127], v6 offset:1024
    ds_read_b128 v[128:131], v6 offset:2048
    ds_read_b128 v[132:135], v6 offset:3072
    ds_read_b128 v[136:139], v6 offset:4096
    ds_read_b128 v[140:143], v6 offset:5120
    ds_read_b128 v[144:147], v6 offset:6144
    ds_read_b128 v[148:151], v6 offset:7168
    ds_read_b128 v[152:155], v6 offset:8192
    ds_read_b128 v[156:159], v6 offset:9216
    ds_read_b128 v[160:163], v6 offset:10240
    ds_read_b128 v[164:167], v6 offset:11264
    ds_read_b128 v[168:171], v6 offset:12288
    ds_read_b128 v[172:175], v6 offset:13312
    ds_read_b128 v[176:179], v6 offset:14336
    s_waitcnt lgkmcnt(14)
    v_pk_add_f32 v[100:101], v[100:101], v[120:121]
    v_pk_add_f32 v[102:103], v[102:103], v[122:123]
    s_waitcnt lgkmcnt(13)
    v_pk_add_f32 v[104:105], v[104:105], v[124:125]
    v_pk_add_f32 v[106:107], v[106:107], v[126:127]
    s_waitcnt lgkmcnt(12)
    v_pk_add_f32 v[108:109], v[108:109], v[128:129]
    v_pk_add_f32 v[110:111], v[110:111], v[130:131]
    s_waitcnt lgkmcnt(11)
    v_pk_add_f32 v[112:113], v[112:113], v[132:133]
    v_pk_add_f32 v[114:115], v[114:115], v[134:135]
    s_waitcnt lgkmcnt(10)
    v_pk_add_f32 v[116:117], v[116:117], v[136:137]
    v_pk_add_f32 v[118:119], v[118:119], v[138:139]
    s_waitcnt lgkmcnt(9)
    v_pk_add_f32 v[100:101], v[100:101], v[140:141]
    v_pk_add_f32 v[102:103], v[102:103], v[142:143]
    s_waitcnt lgkmcnt(8)
    v_pk_add_f32 v[104:105], v[104:105], v[144:145]
    v_pk_add_f32 v[106:107], v[106:107], v[146:147]
    s_waitcnt lgkmcnt(7)
    v_pk_add_f32 v[108:109], v[108:109], v[148:149]
    v_pk_add_f32 v[110:111], v[110:111], v[150:151]
    s_waitcnt lgkmcnt(6)
    v_pk_add_f32 v[112:113], v[112:113], v[152:153]
    v_pk_add_f32 v[114:115], v[114:115], v[154:155]
    s_waitcnt lgkmcnt(5)
    v_pk_add_f32 v[116:117], v[116:117], v[156:157]
    v_pk_add_f32 v[118:119], v[118:119], v[158:159]
    s_waitcnt lgkmcnt(4)
    v_pk_add_f32 v[100:101], v[100:101], v[160:161]
    v_pk_add_f32 v[102:103], v[102:103], v[162:163]
    s_waitcnt lgkmcnt(3)
    v_pk_add_f32 v[104:105], v[104:105], v[164:165]
    v_pk_add_f32 v[106:107], v[106:107], v[166:167]
    s_waitcnt lgkmcnt(2)
    v_pk_add_f32 v[108:109], v[108:109], v[168:169]
    v_pk_add_f32 v[110:111], v[110:111], v[170:171]
    s_waitcnt lgkmcnt(1)
    v_pk_add_f32 v[112:113], v[112:113], v[172:173]
    v_pk_add_f32 v[114:115], v[114:115], v[174:175]
    s_waitcnt lgkmcnt(0)
    v_pk_add_f32 v[116:117], v[116:117], v[176:177]
    v_pk_add_f32 v[118:119], v[118:119], v[178:179]
    v_cvt_pk_bf16_f32 v200, v100, v101
    v_cvt_pk_bf16_f32 v201, v102, v103
    v_cvt_pk_bf16_f32 v202, v104, v105
    v_cvt_pk_bf16_f32 v203, v106, v107
    v_cvt_pk_bf16_f32 v204, v108, v109
    v_cvt_pk_bf16_f32 v205, v110, v111
    v_cvt_pk_bf16_f32 v206, v112, v113
    v_cvt_pk_bf16_f32 v207, v114, v115
    v_cvt_pk_bf16_f32 v208, v116, v117
    v_cvt_pk_bf16_f32 v209, v118, v119
    buffer_store_dwordx4 v[200:203], v7, s[72:75], 0 offen
    buffer_store_dwordx4 v[204:207], v7, s[72:75], 0 offen offset:64
    buffer_store_dwordx2 v[208:209], v8, s[72:75], 0 offen offset:128
L_k2_fin:
L_k2_exit:
    s_endpgm
.section .rodata,"a"
.p2align 6
.amdhsa_kernel k1_kernel
  .amdhsa_next_free_vgpr 168
  .amdhsa_next_free_sgpr 102
  .amdhsa_accum_offset 168
  .amdhsa_group_segment_fixed_size 0
  .amdhsa_kernarg_size 96
  .amdhsa_user_sgpr_count 2
  .amdhsa_user_sgpr_kernarg_segment_ptr 1
  .amdhsa_system_sgpr_workgroup_id_x 1
.end_amdhsa_kernel

.p2align 6
.amdhsa_kernel k2_kernel
  .amdhsa_next_free_vgpr 512
  .amdhsa_next_free_sgpr 102
  .amdhsa_accum_offset 256
  .amdhsa_group_segment_fixed_size 0
  .amdhsa_kernarg_size 96
  .amdhsa_user_sgpr_count 2
  .amdhsa_user_sgpr_kernarg_segment_ptr 1
  .amdhsa_system_sgpr_workgroup_id_x 1
.end_amdhsa_kernel
```
